```python
import torch

def _softmax(x, axis=-1):
    return torch.softmax(x, dim=axis)
def _gelu(x):
    return torch.nn.functional.gelu(x, approximate="tanh")
def _silu(x):
    return torch.nn.functional.silu(x)
def _sigmoid(x):
    return torch.sigmoid(x)
def _layernorm(x, axis=-1, eps=1e-5):
    m = x.mean(dim=axis, keepdim=True)
    v = x.var(dim=axis, keepdim=True, unbiased=False)
    return (x - m) / torch.sqrt(v + eps)
def _scatter_add(tgt, idx, src, axis=0):
    return tgt.clone().index_add_(axis, idx, src)
def _segment_sum(src, seg, n):
    out = torch.zeros((n,) + src.shape[1:], dtype=src.dtype)
    return out.index_add_(0, seg, src)
def _pad(x, pw):
    flat = tuple(v for pair in reversed(pw) for v in pair)
    return torch.nn.functional.pad(x, flat)

kernel_name = 'sequential_preLN__grouped_kv_mqa__dense_activation_squared_relu__prompt'

def setup_inputs():

    _w = (lambda a: (lambda t: t.to(torch.bfloat16) if t.is_floating_point() else t)(torch.as_tensor(a)))
    def _A_setup():
        B, S, D, H = 1, 2048, 576, 32
        Dh = D // H
        return {
            "x": _w((lambda *s: torch.randn(*s, dtype=torch.bfloat16) * 0.05)(B, S, D)),
            "wq": _w((lambda *s: torch.randn(*s, dtype=torch.bfloat16) * 0.05)(D, H * Dh)),
            "wk": _w((lambda *s: torch.randn(*s, dtype=torch.bfloat16) * 0.05)(D, Dh)),
            "wv": _w((lambda *s: torch.randn(*s, dtype=torch.bfloat16) * 0.05)(D, Dh)),
            "wo": _w((lambda *s: torch.randn(*s, dtype=torch.bfloat16) * 0.05)(H * Dh, D)),
        }
    _A_in = _A_setup()

    def _B_setup():
        B, S, D, F = 1, 2048, 576, 4608
        return {
            "x": _w((lambda *s: torch.randn(*s, dtype=torch.bfloat16) * 0.05)(B, S, D)),
            "w1": _w((lambda *s: torch.randn(*s, dtype=torch.bfloat16) * 0.05)(D, F)),
            "b1": _w((lambda *s: torch.randn(*s, dtype=torch.bfloat16) * 0.4)(F)),
            "w2": _w((lambda *s: torch.randn(*s, dtype=torch.bfloat16) * 0.05)(F, D)),
            "b2": _w((lambda *s: torch.randn(*s, dtype=torch.bfloat16) * 3.2)(D)),
        }
    _B_in = _B_setup()

    return {
        "A_x": _A_in["x"],
        "A_wq": _A_in["wq"],
        "A_wk": _A_in["wk"],
        "A_wv": _A_in["wv"],
        "A_wo": _A_in["wo"],
        "B_x": _B_in["x"],
        "B_w1": _B_in["w1"],
        "B_b1": _B_in["b1"],
        "B_w2": _B_in["w2"],
        "B_b2": _B_in["b2"],
    }

def reference(A_x, A_wq, A_wk, A_wv, A_wo, B_x, B_w1, B_b1, B_w2, B_b2):
    def _A_ref(x, wq, wk, wv, wo):
        B, S, D = x.shape
        H = 32
        Dh = D // H
        q = (lambda x, *d: x.permute(*d))((x @ wq).reshape(B, S, H, Dh), 0, 2, 1, 3)
        k = x @ wk
        v = x @ wv
        scores = torch.einsum("bhqd,bkd->bhqk", q, k) * (Dh ** -0.5)
        p = _softmax(scores, axis=-1)
        o = torch.einsum("bhqk,bkd->bhqd", p, v)
        return (lambda x, *d: x.permute(*d))(o, 0, 2, 1, 3).reshape(B, S, H * Dh) @ wo

    def _B_ref(x, w1, b1, w2, b2):
        h = torch.einsum("bsd,df->bsf", x, w1) + b1
        zero = torch.zeros_like(h)
        r = torch.where(h > zero, h, zero)
        h = r * r
        out = torch.einsum("bsf,fd->bsd", h, w2) + b2
        return out

    x = A_x
    h = x + _A_ref(_layernorm(x, axis=-1), A_wq, A_wk, A_wv, A_wo)
    h2 = h + _B_ref(_layernorm(h, axis=-1), B_w1, B_b1, B_w2, B_b2)
    return h2
```

```asm
; @launch kernel=k1_kernel grid=(256,1,1) block=(512,1,1) lds=161856
; @launch kernel=k2_kernel grid=(256,1,1) block=(512,1,1) lds=155904
; @launch kernel=k3_kernel grid=(256,1,1) block=(256,1,1) lds=147456
.amdgcn_target "amdgcn-amd-amdhsa--gfx950"
.text
.globl k1_kernel
.p2align 8
.type k1_kernel,@function
k1_kernel:
    s_cmp_ge_u32 s2, 256
    s_cbranch_scc1 K1_end
    s_load_dwordx4 s[4:7], s[0:1], 0
    s_load_dwordx4 s[8:11], s[0:1], 16
    s_load_dwordx2 s[12:13], s[0:1], 96
    s_load_dwordx2 s[52:53], s[0:1], 32
    v_lshrrev_b32 v1, 6, v0
    v_and_b32 v2, 63, v0
    v_readfirstlane_b32 s3, v1
    v_and_b32 v3, 15, v0
    v_bfe_u32 v4, v0, 4, 2
    s_and_b32 s14, s2, 31
    s_lshr_b32 s15, s2, 5
    s_lshr_b32 s48, s14, 3
    s_lshl_b32 s48, s48, 1
    s_add_u32 s48, s48, s15
    s_cmp_ge_u32 s48, 9
    s_cselect_b32 s49, 9, 0
    s_sub_u32 s48, s48, s49
    s_cmp_lt_u32 s3, 4
    s_cbranch_scc1 K1_compute
    s_setprio 3
    s_sub_u32 s50, s3, 4
    s_lshl_b32 s34, s50, 2
    s_add_u32 s34, s34, 161792
    v_mov_b32 v21, s34
    v_mov_b32 v22, 0
    ds_write_b32 v21, v22
    ds_write_b32 v21, v22 offset:16
    v_and_b32 v9, 255, v0
    v_mul_u32_u24 v10, 7282, v9
    v_lshrrev_b32 v10, 16, v10
    v_mul_u32_u24 v11, 9, v10
    v_sub_u32 v11, v9, v11
    v_and_b32 v12, 1, v10
    v_bfe_u32 v13, v10, 1, 2
    v_lshl_or_b32 v12, v12, 2, v13
    v_and_or_b32 v10, v10, -8, v12
    v_mul_u32_u24 v6, 1152, v10
    v_lshl_add_u32 v6, v11, 4, v6
    v_add_u32 v9, 256, v9
    v_mul_u32_u24 v10, 7282, v9
    v_lshrrev_b32 v10, 16, v10
    v_mul_u32_u24 v11, 9, v10
    v_sub_u32 v11, v9, v11
    v_and_b32 v12, 1, v10
    v_bfe_u32 v13, v10, 1, 2
    v_lshl_or_b32 v12, v12, 2, v13
    v_and_or_b32 v10, v10, -8, v12
    v_mul_u32_u24 v7, 1152, v10
    v_lshl_add_u32 v7, v11, 4, v7
    v_add_u32 v9, 512, v2
    v_mul_u32_u24 v10, 7282, v9
    v_lshrrev_b32 v10, 16, v10
    v_mul_u32_u24 v11, 9, v10
    v_sub_u32 v11, v9, v11
    v_and_b32 v12, 1, v10
    v_bfe_u32 v13, v10, 1, 2
    v_lshl_or_b32 v12, v12, 2, v13
    v_and_or_b32 v10, v10, -8, v12
    v_mul_u32_u24 v8, 1152, v10
    v_lshl_add_u32 v8, v11, 4, v8
    v_mov_b32 v10, v2
    v_and_b32 v12, 1, v10
    v_bfe_u32 v13, v10, 1, 2
    v_lshl_or_b32 v12, v12, 2, v13
    v_and_or_b32 v10, v10, -8, v12
    v_mul_u32_u24 v9, 36, v10
    s_and_b32 s51, s50, 1
    s_cmp_eq_u32 s51, 1
    s_cselect_b64 vcc, -1, 0
    v_lshrrev_b32 v5, 2, v2
    v_mul_u32_u24 v5, 1152, v5
    v_sub_u32 v10, 0, v4
    v_xor_b32 v10, v10, v2
    v_and_b32 v10, 3, v10
    v_lshl_add_u32 v5, v10, 4, v5
    v_cndmask_b32 v8, v8, v9, vcc
    s_mul_i32 s33, s15, 144
    s_lshl_b32 s32, s14, 2
    s_add_u32 s32, s32, s50
    s_mul_i32 s32, s32, 18432
    s_mul_i32 s44, s50, 17408
    s_add_u32 s44, s44, 92160
    s_lshl_b32 s35, s50, 10
    s_mov_b32 s42, 0
    s_cmp_lt_u32 s15, 3
    s_cselect_b32 s36, 0, 3
    s_waitcnt lgkmcnt(0)
    s_cselect_b32 s24, s8, s10
    s_cselect_b32 s25, s9, s11
    s_barrier
    s_mov_b32 s16, s4
    s_mov_b32 s17, s5
    s_mov_b32 s18, 2359296
    s_mov_b32 s19, 0x00020000
    s_mov_b32 s20, s6
    s_mov_b32 s21, s7
    s_mov_b32 s22, 663552
    s_mov_b32 s23, 0x00020000
    s_sub_u32 s36, s15, s36
    s_lshl_b32 s37, s36, 4
    s_cmp_ge_u32 s36, 2
    s_cselect_b32 s37, 20, s37
    s_lshr_b32 s47, s50, 1
    s_cmp_eq_u32 s51, 1
    s_cselect_b32 s24, s24, s6
    s_cselect_b32 s25, s25, s7
    s_cselect_b32 s26, 20736, s22
    s_mov_b32 s27, 0x00020000
    s_cselect_b32 s37, s37, s33
    s_mov_b32 s41, 73728
    s_cselect_b32 s41, 2304, s41
    s_mov_b32 s38, 8192
    s_cselect_b32 s38, 82944, s38
    s_mov_b32 s39, 9216
    s_cselect_b32 s39, 1024, s39
    s_lshl_b32 s45, s48, 7
    s_mov_b32 s46, 9
K1_xl:
    s_add_u32 s34, s45, s32
    s_mov_b32 m0, s44
    s_add_u32 s40, s44, 960
    buffer_load_dwordx4 v5, s[16:19], s34 offen lds
    s_sub_u32 s46, s46, 1
    s_cmp_eq_u32 s46, 0
    s_cbranch_scc1 K1_dma
    s_mov_b32 m0, s40
    s_add_u32 s44, s44, 2048
    buffer_load_dwordx4 v5, s[16:19], s34 offen offset:64 lds
    s_add_u32 s45, s45, 128
    s_cmp_ge_u32 s45, 1152
    s_cselect_b32 s45, 0, s45
    s_branch K1_xl
K1_dma:
    s_mul_i32 s34, s48, 73728
    s_add_u32 s34, s34, s33
    s_mov_b32 m0, s35
    s_add_u32 s40, s35, 4096
    buffer_load_dwordx4 v6, s[20:23], s34 offen lds
    s_mov_b32 m0, s40
    s_add_u32 s35, s35, 9216
    buffer_load_dwordx4 v7, s[20:23], s34 offen lds
    s_cmp_lg_u32 s42, 0
    s_cbranch_scc1 K1_nxf
    v_mov_b32 v22, 2
    s_waitcnt vmcnt(2)
    ds_write_b32 v21, v22 offset:16
    ds_write_b32 v21, v22
K1_nxf:
    s_mov_b32 m0, s38
    s_add_u32 s38, s38, s39
    s_xor_b32 s34, s42, s47
    s_bitcmp1_b32 s34, 0
    s_cbranch_scc1 K1_two
    s_mul_i32 s34, s48, s41
    s_add_u32 s34, s34, s37
    buffer_load_dwordx4 v8, s[24:27], s34 offen lds
K1_two:
    s_add_u32 s48, s48, 1
    s_cmp_ge_u32 s48, 9
    s_cselect_b32 s48, 0, s48
    s_add_u32 s42, s42, 1
    s_add_u32 s40, s42, 0
    s_max_u32 s40, s40, 2
    v_mov_b32 v22, s40
    s_cmp_lt_u32 s42, 9
    s_waitcnt vmcnt(5)
    ds_write_b32 v21, v22
    s_cbranch_scc1 K1_dma
    v_mov_b32 v23, 10
    v_mov_b32 v24, 11
    s_waitcnt vmcnt(2)
    ds_write_b32 v21, v23
    s_waitcnt vmcnt(0)
    ds_write_b32 v21, v24
    s_endpgm
K1_compute:
    v_mul_u32_u24 v5, 1152, v3
    v_lshl_add_u32 v5, v4, 4, v5
    s_lshl_b32 s32, s14, 2
    s_add_u32 s32, s32, s3
    s_mul_i32 s33, s32, 18432
    s_lshl_b32 s34, s48, 7
    s_sub_u32 s34, s34, 64
    s_cmp_eq_u32 s48, 0
    s_cselect_b32 s34, 1088, s34
    s_add_u32 s36, s33, s34
    s_waitcnt lgkmcnt(0)
    s_barrier
    s_mov_b32 s16, s4
    s_mov_b32 s17, s5
    s_mov_b32 s18, 2359296
    s_mov_b32 s19, 0x00020000
    s_mov_b32 s28, s12
    s_mov_b32 s29, s13
    s_mov_b32 s30, 268435456
    s_mov_b32 s31, 0x00020000
    s_min_u32 s54, s2, 161
    s_mov_b32 s64, s52
    s_mov_b32 s65, s53
    s_mov_b32 s66, 663552
    s_mov_b32 s67, 0x00020000
    s_mul_i32 s63, s54, 7282
    s_lshr_b32 s63, s63, 16
    s_mul_i32 s62, s63, 9
    s_sub_u32 s62, s54, s62
    s_mul_i32 s61, s62, 72
    s_add_u32 s61, s61, s63
    s_lshl_b32 s61, s61, 10
    s_add_u32 s61, s61, 4898816
    s_lshl_b32 s62, s62, 7
    s_lshr_b32 s56, s63, 1
    s_mul_i32 s56, s56, 72
    s_and_b32 s57, s63, 1
    s_lshl_b32 s58, s57, 2
    s_add_u32 s56, s56, s58
    s_mul_i32 s57, s57, 288
    s_add_u32 s57, s57, 16
    s_cmp_lt_u32 s63, 16
    s_cselect_b32 s57, s56, s57
    s_cselect_b32 s56, 18, 72
    s_cselect_b32 s59, 2, 18
    s_cselect_b32 s60, 8, 36
    s_mul_i32 s57, s57, 1152
    s_add_u32 s57, s57, s62
    s_mul_i32 s56, s56, 1152
    s_mov_b32 s58, 1152
    s_mul_i32 s59, s59, 1152
    s_mul_i32 s60, s60, 1152
    v_bfe_u32 v198, v0, 3, 1
    v_mul_lo_u32 v196, v198, s58
    v_bfe_u32 v198, v0, 4, 1
    v_mul_lo_u32 v197, v198, s59
    v_add_u32 v196, v196, v197
    v_bfe_u32 v198, v0, 5, 1
    v_mul_lo_u32 v197, v198, s60
    v_add_u32 v196, v196, v197
    v_and_b32 v198, 7, v0
    v_lshl_add_u32 v196, v198, 4, v196
    v_bfe_u32 v198, v0, 2, 2
    v_lshl_add_u32 v197, v4, 3, v198
    v_lshlrev_b32 v197, 7, v197
    v_and_b32 v198, 3, v0
    v_lshl_add_u32 v197, v198, 3, v197
    v_add_u32 v197, 148480, v197
    s_cmp_lt_u32 s2, 162
    s_cselect_b32 s55, s3, 0
    buffer_load_dwordx4 v[132:135], v5, s[16:19], s36 offen
    v_lshrrev_b32 v7, 2, v3
    v_sub_u32 v7, 0, v7
    v_xor_b32 v7, v7, v4
    v_and_b32 v7, 3, v7
    v_lshlrev_b32 v7, 4, v7
    v_lshl_add_u32 v7, v3, 6, v7
    s_mul_i32 s35, s3, 17408
    s_add_u32 s35, s35, 92160
    v_add_u32 v7, s35, v7
    v_bfe_u32 v5, v0, 2, 2
    v_and_b32 v6, 3, v0
    v_lshlrev_b32 v12, 3, v4
    v_lshl_add_u32 v12, v5, 1, v12
    v_mul_u32_u24 v8, 144, v12
    v_lshl_add_u32 v8, v6, 3, v8
    s_add_u32 s76, s3, 0
    s_and_b32 s76, s76, 3
    s_lshl_b32 s80, s76, 5
    v_add_u32 v232, s80, v8
    v_add_u32 v236, 41472, v232
    s_add_u32 s77, s3, 1
    s_and_b32 s77, s77, 3
    s_lshl_b32 s80, s77, 5
    v_add_u32 v233, s80, v8
    v_add_u32 v237, 41472, v233
    s_add_u32 s78, s3, 2
    s_and_b32 s78, s78, 3
    s_lshl_b32 s80, s78, 5
    v_add_u32 v234, s80, v8
    v_add_u32 v238, 41472, v234
    s_add_u32 s79, s3, 3
    s_and_b32 s79, s79, 3
    s_lshl_b32 s80, s79, 5
    v_add_u32 v235, s80, v8
    v_add_u32 v239, 41472, v235
    v_lshlrev_b32 v10, 4, v12
    v_lshl_add_u32 v10, v6, 3, v10
    v_add_u32 v10, 82928, v10
    v_add_u32 v11, 16, v10
    v_add_u32 v15, 128, v8
    v_cmp_gt_u32 vcc, 2, v6
    v_mov_b32 v14, 512
    v_mov_b32 v5, 4608
    v_cndmask_b32 v10, v10, v15, vcc
    v_add_u32 v15, 144, v15
    v_cndmask_b32 v14, v14, v5, vcc
    v_cndmask_b32 v11, v11, v15, vcc
    v_mov_b32 v56, 0x3f803f80
    v_mov_b32 v57, 0x3f803f80
    v_mov_b32 v58, 0x3f803f80
    v_mov_b32 v59, 0x3f803f80
    v_mov_b32 v5, 161792
    s_mov_b32 s43, 0
    s_add_u32 s81, s35, 256
    v_mul_u32_u24 v16, 144, v3
    v_lshl_add_u32 v16, v4, 3, v16
    v_add_u32 v180, s81, v16
    s_lshl_b32 s80, s76, 5
    v_add_u32 v176, s80, v180
    s_lshl_b32 s80, s77, 5
    v_add_u32 v177, s80, v180
    s_lshl_b32 s80, s78, 5
    v_add_u32 v178, s80, v180
    s_lshl_b32 s80, s79, 5
    v_add_u32 v179, s80, v180
    v_and_b32 v16, 7, v0
    v_mul_u32_u24 v16, 144, v16
    v_bfe_u32 v17, v0, 3, 2
    v_mul_u32_u24 v17, 36, v17
    v_bfe_u32 v18, v0, 5, 1
    v_lshl_add_u32 v16, v18, 4, v16
    v_add3_u32 v181, v16, v17, s81
    v_add_u32 v182, 1152, v181
    v_bfe_u32 v16, v0, 3, 1
    v_and_b32 v17, 1, v0
    v_lshl_add_u32 v17, v16, 1, v17
    v_mul_u32_u24 v17, 576, v17
    v_bfe_u32 v18, v0, 1, 2
    v_mul_u32_u24 v18, 36, v18
    v_add3_u32 v183, v17, v18, s81
    v_mul_u32_u24 v16, 9088, v16
    v_lshlrev_b32 v17, 4, v3
    v_add_u32 v184, v16, v17
    v_add_u32 v185, s81, v17
    s_lshl_b32 s34, s32, 4
    s_add_u32 s34, s34, s15
    s_mul_i32 s34, s34, 1152
    s_add_u32 s34, s34, 0
    s_add_u32 s83, s34, 9216
    s_lshr_b32 s35, s32, 1
    s_mul_i32 s35, s35, 2304
    s_add_u32 s35, s35, 4718592
    s_and_b32 s37, s32, 1
    s_sub_u32 s36, s15, 3
    s_mul_i32 s38, s37, 640
    s_add_u32 s38, s38, s35
    s_add_u32 s38, s38, 1024
    v_lshl_add_u32 v243, v4, 3, v185
    v_mov_b32 v242, 2146435072
    s_mov_b32 s82, 0
    s_cmp_lt_u32 s36, 3
    s_cbranch_scc1 K1_av
    s_cmp_eq_u32 s15, 6
    s_cbranch_scc1 K1_ao
    s_cmp_eq_u32 s15, 2
    s_cbranch_scc1 K1_ak2
    s_cmp_eq_u32 s15, 7
    s_cbranch_scc1 K1_ad
    v_mov_b32 v242, v17
    s_lshl_b32 s82, s15, 9
    s_lshl_b32 s39, s37, 8
    s_add_u32 s82, s82, s39
    s_add_u32 s82, s82, s35
    s_branch K1_ad
K1_ak2:
    s_lshr_b32 s84, s32, 3
    s_lshl_b32 s84, s84, 9
    s_and_b32 s39, s32, 6
    s_lshl_b32 s39, s39, 1
    s_add_u32 s84, s84, s39
    s_lshl_b32 s39, s37, 8
    s_add_u32 s84, s84, s39
    s_add_u32 s84, s84, 4866048
    s_branch K1_ad
K1_ao:
    v_lshrrev_b32 v18, 1, v3
    v_mul_u32_u24 v18, 320, v18
    v_cmp_gt_u32 vcc, 4, v3
    v_and_b32 v19, 1, v3
    v_lshl_add_u32 v18, v19, 5, v18
    s_add_u32 s82, s38, 272
    v_cndmask_b32 v242, v242, v18, vcc
    s_branch K1_ad
K1_av:
    s_lshl_b32 s39, s36, 7
    s_cmp_eq_u32 s36, 2
    s_cselect_b32 s39, 160, s39
    s_cselect_b32 s80, 16, 0
    s_add_u32 s82, s39, s38
    v_lshrrev_b32 v19, 3, v3
    v_and_b32 v20, 7, v3
    v_cmp_eq_u32 vcc, 7, v20
    v_mul_u32_u24 v18, 192, v19
    v_add_u32 v18, v18, v17
    v_add_u32 v20, s80, v18
    v_cndmask_b32 v242, v18, v20, vcc
    v_bfe_u32 v20, v3, 2, 1
    v_lshlrev_b32 v20, 7, v20
    v_lshl_add_u32 v20, v4, 6, v20
    v_and_b32 v21, 3, v3
    v_lshl_add_u32 v20, v21, 1, v20
    v_lshl_add_u32 v20, v19, 3, v20
    v_add_u32 v243, s81, v20
K1_ad:
    v_mov_b32 v244, v17
    s_lshl_b32 s80, s3, 2
    v_add_u32 v6, s80, v5
K1_xw:
    ds_read_b32 v192, v6 offset:16
    s_waitcnt lgkmcnt(0)
    v_readfirstlane_b32 s80, v192
    s_cmp_eq_u32 s80, 0
    s_cbranch_scc1 K1_xw
    ds_read_b128 v[64:67], v7 offset:0
    ds_read_b128 v[68:71], v7 offset:1024
    ds_read_b128 v[72:75], v7 offset:2048
    ds_read_b128 v[76:79], v7 offset:3072
    ds_read_b128 v[80:83], v7 offset:4096
    ds_read_b128 v[84:87], v7 offset:5120
    ds_read_b128 v[88:91], v7 offset:6144
    ds_read_b128 v[92:95], v7 offset:7168
    ds_read_b128 v[96:99], v7 offset:8192
    ds_read_b128 v[100:103], v7 offset:9216
    ds_read_b128 v[104:107], v7 offset:10240
    ds_read_b128 v[108:111], v7 offset:11264
    ds_read_b128 v[112:115], v7 offset:12288
    ds_read_b128 v[116:119], v7 offset:13312
    ds_read_b128 v[120:123], v7 offset:14336
    ds_read_b128 v[124:127], v7 offset:15360
    ds_read_b128 v[128:131], v7 offset:16384
    s_waitcnt vmcnt(0)
    s_cmp_lg_u32 s55, 3
    s_cbranch_scc1 K1_nowo
    s_waitcnt lgkmcnt(0)
    s_mov_b32 m0, 148480
    s_nop 0
    buffer_load_dwordx4 v196, s[64:67], s57 offen lds
    s_add_u32 s57, s57, s56
    s_mov_b32 m0, 149504
    s_nop 0
    buffer_load_dwordx4 v196, s[64:67], s57 offen lds
    s_add_u32 s57, s57, s56
    s_mov_b32 m0, 150528
    s_nop 0
    buffer_load_dwordx4 v196, s[64:67], s57 offen lds
    s_add_u32 s57, s57, s56
    s_mov_b32 m0, 151552
    s_nop 0
    buffer_load_dwordx4 v196, s[64:67], s57 offen lds
    s_add_u32 s57, s57, s56
K1_nowo:
    v_lshlrev_b32 v199, 4, v2
    s_lshr_b32 s70, s2, 3
    s_lshl_b32 s71, s3, 5
    s_add_u32 s70, s70, s71
    s_cmp_ge_u32 s3, 3
    s_cbranch_scc1 K1_nopf
    s_getpc_b64 s[72:73]
Lpf1:
    s_lshl_b32 s74, s70, 10
    s_min_u32 s74, s74, K3_end-k1_kernel-1024
    s_add_u32 s72, s72, s74
    s_addc_u32 s73, s73, 0
    s_add_u32 s72, s72, k1_kernel-Lpf1
    s_addc_u32 s73, s73, (k1_kernel-Lpf1)>>32
    global_load_dwordx4 v[200:203], v199, s[72:73]
K1_nopf:
    s_waitcnt lgkmcnt(13)
    v_mfma_f32_16x16x32_bf16 v[60:63], v[56:59], v[64:67], 0
    v_mfma_f32_16x16x32_bf16 v[188:191], v[64:67], v[64:67], 0
    v_mfma_f32_16x16x32_bf16 v[60:63], v[56:59], v[68:71], v[60:63]
    v_mfma_f32_16x16x32_bf16 v[188:191], v[68:71], v[68:71], v[188:191]
    v_mfma_f32_16x16x32_bf16 v[60:63], v[56:59], v[72:75], v[60:63]
    v_mfma_f32_16x16x32_bf16 v[188:191], v[72:75], v[72:75], v[188:191]
    v_mfma_f32_16x16x32_bf16 v[60:63], v[56:59], v[76:79], v[60:63]
    v_mfma_f32_16x16x32_bf16 v[188:191], v[76:79], v[76:79], v[188:191]
    s_waitcnt lgkmcnt(9)
    v_mfma_f32_16x16x32_bf16 v[60:63], v[56:59], v[80:83], v[60:63]
    v_mfma_f32_16x16x32_bf16 v[188:191], v[80:83], v[80:83], v[188:191]
    v_mfma_f32_16x16x32_bf16 v[60:63], v[56:59], v[84:87], v[60:63]
    v_mfma_f32_16x16x32_bf16 v[188:191], v[84:87], v[84:87], v[188:191]
    v_mfma_f32_16x16x32_bf16 v[60:63], v[56:59], v[88:91], v[60:63]
    v_mfma_f32_16x16x32_bf16 v[188:191], v[88:91], v[88:91], v[188:191]
    v_mfma_f32_16x16x32_bf16 v[60:63], v[56:59], v[92:95], v[60:63]
    v_mfma_f32_16x16x32_bf16 v[188:191], v[92:95], v[92:95], v[188:191]
    s_waitcnt lgkmcnt(5)
    v_mfma_f32_16x16x32_bf16 v[60:63], v[56:59], v[96:99], v[60:63]
    v_mfma_f32_16x16x32_bf16 v[188:191], v[96:99], v[96:99], v[188:191]
    v_mfma_f32_16x16x32_bf16 v[60:63], v[56:59], v[100:103], v[60:63]
    v_mfma_f32_16x16x32_bf16 v[188:191], v[100:103], v[100:103], v[188:191]
    v_mfma_f32_16x16x32_bf16 v[60:63], v[56:59], v[104:107], v[60:63]
    v_mfma_f32_16x16x32_bf16 v[188:191], v[104:107], v[104:107], v[188:191]
    v_mfma_f32_16x16x32_bf16 v[60:63], v[56:59], v[108:111], v[60:63]
    v_mfma_f32_16x16x32_bf16 v[188:191], v[108:111], v[108:111], v[188:191]
    s_waitcnt lgkmcnt(1)
    v_mfma_f32_16x16x32_bf16 v[60:63], v[56:59], v[112:115], v[60:63]
    v_mfma_f32_16x16x32_bf16 v[188:191], v[112:115], v[112:115], v[188:191]
    v_mfma_f32_16x16x32_bf16 v[60:63], v[56:59], v[116:119], v[60:63]
    v_mfma_f32_16x16x32_bf16 v[188:191], v[116:119], v[116:119], v[188:191]
    v_mfma_f32_16x16x32_bf16 v[60:63], v[56:59], v[120:123], v[60:63]
    v_mfma_f32_16x16x32_bf16 v[188:191], v[120:123], v[120:123], v[188:191]
    v_mfma_f32_16x16x32_bf16 v[60:63], v[56:59], v[124:127], v[60:63]
    v_mfma_f32_16x16x32_bf16 v[188:191], v[124:127], v[124:127], v[188:191]
    s_waitcnt lgkmcnt(0)
    v_mfma_f32_16x16x32_bf16 v[60:63], v[56:59], v[128:131], v[60:63]
    v_mfma_f32_16x16x32_bf16 v[188:191], v[128:131], v[128:131], v[188:191]
    v_mfma_f32_16x16x32_bf16 v[60:63], v[56:59], v[132:135], v[60:63]
    v_mfma_f32_16x16x32_bf16 v[188:191], v[132:135], v[132:135], v[188:191]
    v_and_b32 v16, 3, v3
    v_lshrrev_b32 v17, 2, v3
    v_cmp_eq_u32 vcc, 1, v16
    v_cmp_eq_u32 s[44:45], 2, v16
    v_cmp_eq_u32 s[46:47], 3, v16
    v_lshlrev_b32 v6, 4, v4
    v_add_u32 v6, 92160, v6
    s_nop 1
    v_mul_f32 v12, 0xbae38e39, v60
    v_cndmask_b32 v188, v188, v189, vcc
    v_cmp_eq_u32 vcc, v17, v4
    v_cndmask_b32_e64 v188, v188, v190, s[44:45]
    v_cndmask_b32_e64 v188, v188, v191, s[46:47]
    v_cndmask_b32 v188, 0, v188, vcc
    v_mov_b32 v189, v188
    s_nop 1
    v_permlane16_swap_b32 v188, v189
    s_nop 1
    v_add_f32 v188, v188, v189
    v_mov_b32 v189, v188
    s_nop 1
    v_permlane32_swap_b32 v188, v189
    s_nop 1
    v_add_f32 v188, v188, v189
    v_mov_b32 v189, 0x3727c5ac
    v_fmac_f32 v189, 0x3ae38e39, v188
    v_fma_f32 v189, -v12, v12, v189
    v_max_f32 v189, 0x3727c5ac, v189
    v_rsq_f32 v13, v189
    v_cmp_gt_u32 vcc, 2, v4
    v_mul_f32 v245, 0x3eae1a93, v13
    s_nop 0
    v_cndmask_b32 v15, v13, v245, vcc
    s_mul_i32 s80, s76, 17408
    v_add_u32 v60, s80, v6
    s_mul_i32 s80, s77, 17408
    v_add_u32 v61, s80, v6
    s_mul_i32 s80, s78, 17408
    v_add_u32 v62, s80, v6
    s_mul_i32 s80, s79, 17408
    v_add_u32 v63, s80, v6
K1_w1:
    s_cmp_ge_u32 s43, 3
    s_cbranch_scc1 K1_ok1
    ds_read_b128 v[192:195], v5
    s_waitcnt lgkmcnt(0)
    v_min3_u32 v192, v192, v193, v194
    v_min_u32 v192, v192, v195
    s_nop 0
    v_readfirstlane_b32 s43, v192
    s_branch K1_w1
K1_ok1:
    ds_read_b64_tr_b16 v[136:137], v232 offset:0
    ds_read_b64_tr_b16 v[138:139], v232 offset:144
    ds_read_b64_tr_b16 v[140:141], v233 offset:0
    ds_read_b64_tr_b16 v[142:143], v233 offset:144
    ds_read_b64_tr_b16 v[144:145], v234 offset:0
    ds_read_b64_tr_b16 v[146:147], v234 offset:144
    ds_read_b64_tr_b16 v[148:149], v235 offset:0
    ds_read_b64_tr_b16 v[150:151], v235 offset:144
    ds_read_b64_tr_b16 v[152:153], v10
    v_add_u32 v10, v10, v14
    ds_read_b64_tr_b16 v[154:155], v11
    v_add_u32 v11, v11, v14
    s_waitcnt lgkmcnt(8)
    v_mfma_f32_16x16x32_bf16 v[36:39], v[136:139], v[56:59], 0
    ds_read_b64_tr_b16 v[156:157], v232 offset:4608
    v_mfma_f32_16x16x32_bf16 v[16:19], v[136:139], v[64:67], 0
    ds_read_b64_tr_b16 v[158:159], v232 offset:4752
    s_waitcnt lgkmcnt(8)
    v_mfma_f32_16x16x32_bf16 v[20:23], v[140:143], v[64:67], 0
    ds_read_b64_tr_b16 v[160:161], v233 offset:4608
    ds_read_b64_tr_b16 v[162:163], v233 offset:4752
    s_waitcnt lgkmcnt(8)
    v_mfma_f32_16x16x32_bf16 v[24:27], v[144:147], v[64:67], 0
    ds_read_b64_tr_b16 v[164:165], v234 offset:4608
    ds_read_b64_tr_b16 v[166:167], v234 offset:4752
    s_waitcnt lgkmcnt(8)
    v_mfma_f32_16x16x32_bf16 v[28:31], v[148:151], v[64:67], 0
    ds_read_b64_tr_b16 v[168:169], v235 offset:4608
    ds_read_b64_tr_b16 v[170:171], v235 offset:4752
    s_waitcnt lgkmcnt(8)
    v_mfma_f32_16x16x32_bf16 v[52:55], v[152:155], v[56:59], 0
    ds_read_b64_tr_b16 v[172:173], v10
    v_add_u32 v10, v10, v14
    v_mfma_f32_16x16x32_bf16 v[32:35], v[152:155], v[64:67], 0
    ds_read_b64_tr_b16 v[174:175], v11
    v_add_u32 v11, v11, v14
K1_w2:
    s_cmp_ge_u32 s43, 4
    s_cbranch_scc1 K1_ok2
    ds_read_b128 v[192:195], v5
    s_waitcnt lgkmcnt(0)
    v_min3_u32 v192, v192, v193, v194
    v_min_u32 v192, v192, v195
    s_nop 0
    v_readfirstlane_b32 s43, v192
    s_branch K1_w2
K1_ok2:
    s_waitcnt lgkmcnt(8)
    v_mfma_f32_16x16x32_bf16 v[36:39], v[156:159], v[56:59], v[36:39]
    ds_read_b64_tr_b16 v[136:137], v232 offset:9216
    v_mfma_f32_16x16x32_bf16 v[16:19], v[156:159], v[68:71], v[16:19]
    ds_read_b64_tr_b16 v[138:139], v232 offset:9360
    s_waitcnt lgkmcnt(8)
    v_mfma_f32_16x16x32_bf16 v[20:23], v[160:163], v[68:71], v[20:23]
    ds_read_b64_tr_b16 v[140:141], v233 offset:9216
    ds_read_b64_tr_b16 v[142:143], v233 offset:9360
    s_waitcnt lgkmcnt(8)
    v_mfma_f32_16x16x32_bf16 v[24:27], v[164:167], v[68:71], v[24:27]
    ds_read_b64_tr_b16 v[144:145], v234 offset:9216
    ds_read_b64_tr_b16 v[146:147], v234 offset:9360
    s_waitcnt lgkmcnt(8)
    v_mfma_f32_16x16x32_bf16 v[28:31], v[168:171], v[68:71], v[28:31]
    ds_read_b64_tr_b16 v[148:149], v235 offset:9216
    ds_read_b64_tr_b16 v[150:151], v235 offset:9360
    s_waitcnt lgkmcnt(8)
    v_mfma_f32_16x16x32_bf16 v[52:55], v[172:175], v[56:59], v[52:55]
    ds_read_b64_tr_b16 v[152:153], v10
    v_add_u32 v10, v10, v14
    v_mfma_f32_16x16x32_bf16 v[32:35], v[172:175], v[68:71], v[32:35]
    ds_read_b64_tr_b16 v[154:155], v11
    v_add_u32 v11, v11, v14
    s_waitcnt lgkmcnt(8)
    v_mfma_f32_16x16x32_bf16 v[36:39], v[136:139], v[56:59], v[36:39]
    ds_read_b64_tr_b16 v[156:157], v232 offset:13824
    v_mfma_f32_16x16x32_bf16 v[16:19], v[136:139], v[72:75], v[16:19]
    ds_read_b64_tr_b16 v[158:159], v232 offset:13968
    s_waitcnt lgkmcnt(8)
    v_mfma_f32_16x16x32_bf16 v[20:23], v[140:143], v[72:75], v[20:23]
    ds_read_b64_tr_b16 v[160:161], v233 offset:13824
    ds_read_b64_tr_b16 v[162:163], v233 offset:13968
    s_waitcnt lgkmcnt(8)
    v_mfma_f32_16x16x32_bf16 v[24:27], v[144:147], v[72:75], v[24:27]
    ds_read_b64_tr_b16 v[164:165], v234 offset:13824
    ds_read_b64_tr_b16 v[166:167], v234 offset:13968
    s_waitcnt lgkmcnt(8)
    v_mfma_f32_16x16x32_bf16 v[28:31], v[148:151], v[72:75], v[28:31]
    ds_read_b64_tr_b16 v[168:169], v235 offset:13824
    ds_read_b64_tr_b16 v[170:171], v235 offset:13968
    s_waitcnt lgkmcnt(8)
    v_mfma_f32_16x16x32_bf16 v[52:55], v[152:155], v[56:59], v[52:55]
    ds_read_b64_tr_b16 v[172:173], v10
    v_add_u32 v10, v10, v14
    v_mfma_f32_16x16x32_bf16 v[32:35], v[152:155], v[72:75], v[32:35]
    ds_read_b64_tr_b16 v[174:175], v11
    v_add_u32 v11, v11, v14
K1_w3:
    s_cmp_ge_u32 s43, 5
    s_cbranch_scc1 K1_ok3
    ds_read_b128 v[192:195], v5
    s_waitcnt lgkmcnt(0)
    v_min3_u32 v192, v192, v193, v194
    v_min_u32 v192, v192, v195
    s_nop 0
    v_readfirstlane_b32 s43, v192
    s_branch K1_w3
K1_ok3:
    s_waitcnt lgkmcnt(8)
    v_mfma_f32_16x16x32_bf16 v[36:39], v[156:159], v[56:59], v[36:39]
    ds_read_b64_tr_b16 v[136:137], v232 offset:18432
    v_mfma_f32_16x16x32_bf16 v[16:19], v[156:159], v[76:79], v[16:19]
    ds_read_b64_tr_b16 v[138:139], v232 offset:18576
    s_waitcnt lgkmcnt(8)
    v_mfma_f32_16x16x32_bf16 v[20:23], v[160:163], v[76:79], v[20:23]
    ds_read_b64_tr_b16 v[140:141], v233 offset:18432
    ds_read_b64_tr_b16 v[142:143], v233 offset:18576
    s_waitcnt lgkmcnt(8)
    v_mfma_f32_16x16x32_bf16 v[24:27], v[164:167], v[76:79], v[24:27]
    ds_read_b64_tr_b16 v[144:145], v234 offset:18432
    ds_read_b64_tr_b16 v[146:147], v234 offset:18576
    s_waitcnt lgkmcnt(8)
    v_mfma_f32_16x16x32_bf16 v[28:31], v[168:171], v[76:79], v[28:31]
    ds_read_b64_tr_b16 v[148:149], v235 offset:18432
    ds_read_b64_tr_b16 v[150:151], v235 offset:18576
    s_waitcnt lgkmcnt(8)
    v_mfma_f32_16x16x32_bf16 v[52:55], v[172:175], v[56:59], v[52:55]
    ds_read_b64_tr_b16 v[152:153], v10
    v_add_u32 v10, v10, v14
    v_mfma_f32_16x16x32_bf16 v[32:35], v[172:175], v[76:79], v[32:35]
    ds_read_b64_tr_b16 v[154:155], v11
    v_add_u32 v11, v11, v14
    s_waitcnt lgkmcnt(8)
    v_mfma_f32_16x16x32_bf16 v[36:39], v[136:139], v[56:59], v[36:39]
    ds_read_b64_tr_b16 v[156:157], v232 offset:23040
    v_mfma_f32_16x16x32_bf16 v[16:19], v[136:139], v[80:83], v[16:19]
    ds_read_b64_tr_b16 v[158:159], v232 offset:23184
    s_waitcnt lgkmcnt(8)
    v_mfma_f32_16x16x32_bf16 v[20:23], v[140:143], v[80:83], v[20:23]
    ds_read_b64_tr_b16 v[160:161], v233 offset:23040
    ds_read_b64_tr_b16 v[162:163], v233 offset:23184
    s_waitcnt lgkmcnt(8)
    v_mfma_f32_16x16x32_bf16 v[24:27], v[144:147], v[80:83], v[24:27]
    ds_read_b64_tr_b16 v[164:165], v234 offset:23040
    ds_read_b64_tr_b16 v[166:167], v234 offset:23184
    s_waitcnt lgkmcnt(8)
    v_mfma_f32_16x16x32_bf16 v[28:31], v[148:151], v[80:83], v[28:31]
    ds_read_b64_tr_b16 v[168:169], v235 offset:23040
    ds_read_b64_tr_b16 v[170:171], v235 offset:23184
    s_waitcnt lgkmcnt(8)
    v_mfma_f32_16x16x32_bf16 v[52:55], v[152:155], v[56:59], v[52:55]
    ds_read_b64_tr_b16 v[172:173], v10
    v_add_u32 v10, v10, v14
    v_mfma_f32_16x16x32_bf16 v[32:35], v[152:155], v[80:83], v[32:35]
    ds_read_b64_tr_b16 v[174:175], v11
    v_add_u32 v11, v11, v14
K1_w4:
    s_cmp_ge_u32 s43, 6
    s_cbranch_scc1 K1_ok4
    ds_read_b128 v[192:195], v5
    s_waitcnt lgkmcnt(0)
    v_min3_u32 v192, v192, v193, v194
    v_min_u32 v192, v192, v195
    s_nop 0
    v_readfirstlane_b32 s43, v192
    s_branch K1_w4
K1_ok4:
    s_waitcnt lgkmcnt(8)
    v_mfma_f32_16x16x32_bf16 v[36:39], v[156:159], v[56:59], v[36:39]
    ds_read_b64_tr_b16 v[136:137], v232 offset:27648
    v_mfma_f32_16x16x32_bf16 v[16:19], v[156:159], v[84:87], v[16:19]
    ds_read_b64_tr_b16 v[138:139], v232 offset:27792
    s_waitcnt lgkmcnt(8)
    v_mfma_f32_16x16x32_bf16 v[20:23], v[160:163], v[84:87], v[20:23]
    ds_read_b64_tr_b16 v[140:141], v233 offset:27648
    ds_read_b64_tr_b16 v[142:143], v233 offset:27792
    s_waitcnt lgkmcnt(8)
    v_mfma_f32_16x16x32_bf16 v[24:27], v[164:167], v[84:87], v[24:27]
    ds_read_b64_tr_b16 v[144:145], v234 offset:27648
    ds_read_b64_tr_b16 v[146:147], v234 offset:27792
    s_waitcnt lgkmcnt(8)
    v_mfma_f32_16x16x32_bf16 v[28:31], v[168:171], v[84:87], v[28:31]
    ds_read_b64_tr_b16 v[148:149], v235 offset:27648
    ds_read_b64_tr_b16 v[150:151], v235 offset:27792
    s_waitcnt lgkmcnt(8)
    v_mfma_f32_16x16x32_bf16 v[52:55], v[172:175], v[56:59], v[52:55]
    ds_read_b64_tr_b16 v[152:153], v10
    v_add_u32 v10, v10, v14
    v_mfma_f32_16x16x32_bf16 v[32:35], v[172:175], v[84:87], v[32:35]
    ds_read_b64_tr_b16 v[154:155], v11
    v_add_u32 v11, v11, v14
    s_waitcnt lgkmcnt(8)
    v_mfma_f32_16x16x32_bf16 v[36:39], v[136:139], v[56:59], v[36:39]
    ds_read_b64_tr_b16 v[156:157], v232 offset:32256
    v_mfma_f32_16x16x32_bf16 v[16:19], v[136:139], v[88:91], v[16:19]
    ds_read_b64_tr_b16 v[158:159], v232 offset:32400
    s_waitcnt lgkmcnt(8)
    v_mfma_f32_16x16x32_bf16 v[20:23], v[140:143], v[88:91], v[20:23]
    ds_read_b64_tr_b16 v[160:161], v233 offset:32256
    ds_read_b64_tr_b16 v[162:163], v233 offset:32400
    s_waitcnt lgkmcnt(8)
    v_mfma_f32_16x16x32_bf16 v[24:27], v[144:147], v[88:91], v[24:27]
    ds_read_b64_tr_b16 v[164:165], v234 offset:32256
    ds_read_b64_tr_b16 v[166:167], v234 offset:32400
    s_waitcnt lgkmcnt(8)
    v_mfma_f32_16x16x32_bf16 v[28:31], v[148:151], v[88:91], v[28:31]
    ds_read_b64_tr_b16 v[168:169], v235 offset:32256
    ds_read_b64_tr_b16 v[170:171], v235 offset:32400
    s_waitcnt lgkmcnt(8)
    v_mfma_f32_16x16x32_bf16 v[52:55], v[152:155], v[56:59], v[52:55]
    ds_read_b64_tr_b16 v[172:173], v10
    v_add_u32 v10, v10, v14
    v_mfma_f32_16x16x32_bf16 v[32:35], v[152:155], v[88:91], v[32:35]
    ds_read_b64_tr_b16 v[174:175], v11
    v_add_u32 v11, v11, v14
    s_cmp_lg_u32 s55, 3
    s_cbranch_scc1 K1_aend
    s_waitcnt vmcnt(0)
    ds_read_b64_tr_b16 v[200:201], v197 offset:0
    ds_read_b64_tr_b16 v[202:203], v197 offset:512
    ds_read_b64_tr_b16 v[204:205], v197 offset:32
    ds_read_b64_tr_b16 v[206:207], v197 offset:544
    ds_read_b64_tr_b16 v[208:209], v197 offset:64
    ds_read_b64_tr_b16 v[210:211], v197 offset:576
    ds_read_b64_tr_b16 v[212:213], v197 offset:96
    ds_read_b64_tr_b16 v[214:215], v197 offset:608
    s_waitcnt lgkmcnt(0)
    buffer_store_dwordx4 v[200:203], v199, s[28:31], s61 offen sc1
    s_add_u32 s61, s61, 18432
    buffer_store_dwordx4 v[204:207], v199, s[28:31], s61 offen sc1
    s_add_u32 s61, s61, 18432
    buffer_store_dwordx4 v[208:211], v199, s[28:31], s61 offen sc1
    s_add_u32 s61, s61, 18432
    buffer_store_dwordx4 v[212:215], v199, s[28:31], s61 offen sc1
    s_add_u32 s61, s61, 18432
K1_aend:
K1_w5:
    s_cmp_ge_u32 s43, 7
    s_cbranch_scc1 K1_ok5
    ds_read_b128 v[192:195], v5
    s_waitcnt lgkmcnt(0)
    v_min3_u32 v192, v192, v193, v194
    v_min_u32 v192, v192, v195
    s_nop 0
    v_readfirstlane_b32 s43, v192
    s_branch K1_w5
K1_ok5:
    s_waitcnt lgkmcnt(8)
    v_mfma_f32_16x16x32_bf16 v[36:39], v[156:159], v[56:59], v[36:39]
    ds_read_b64_tr_b16 v[136:137], v232 offset:36864
    v_mfma_f32_16x16x32_bf16 v[16:19], v[156:159], v[92:95], v[16:19]
    ds_read_b64_tr_b16 v[138:139], v232 offset:37008
    s_waitcnt lgkmcnt(8)
    v_mfma_f32_16x16x32_bf16 v[20:23], v[160:163], v[92:95], v[20:23]
    ds_read_b64_tr_b16 v[140:141], v233 offset:36864
    ds_read_b64_tr_b16 v[142:143], v233 offset:37008
    s_waitcnt lgkmcnt(8)
    v_mfma_f32_16x16x32_bf16 v[24:27], v[164:167], v[92:95], v[24:27]
    ds_read_b64_tr_b16 v[144:145], v234 offset:36864
    ds_read_b64_tr_b16 v[146:147], v234 offset:37008
    s_waitcnt lgkmcnt(8)
    v_mfma_f32_16x16x32_bf16 v[28:31], v[168:171], v[92:95], v[28:31]
    ds_read_b64_tr_b16 v[148:149], v235 offset:36864
    ds_read_b64_tr_b16 v[150:151], v235 offset:37008
    s_waitcnt lgkmcnt(8)
    v_mfma_f32_16x16x32_bf16 v[52:55], v[172:175], v[56:59], v[52:55]
    ds_read_b64_tr_b16 v[152:153], v10
    v_add_u32 v10, v10, v14
    v_mfma_f32_16x16x32_bf16 v[32:35], v[172:175], v[92:95], v[32:35]
    ds_read_b64_tr_b16 v[154:155], v11
    v_add_u32 v11, v11, v14
    s_waitcnt lgkmcnt(8)
    v_mfma_f32_16x16x32_bf16 v[36:39], v[136:139], v[56:59], v[36:39]
    ds_read_b64_tr_b16 v[156:157], v236 offset:0
    v_mfma_f32_16x16x32_bf16 v[16:19], v[136:139], v[96:99], v[16:19]
    ds_read_b64_tr_b16 v[158:159], v236 offset:144
    s_waitcnt lgkmcnt(8)
    v_mfma_f32_16x16x32_bf16 v[20:23], v[140:143], v[96:99], v[20:23]
    ds_read_b64_tr_b16 v[160:161], v237 offset:0
    ds_read_b64_tr_b16 v[162:163], v237 offset:144
    s_waitcnt lgkmcnt(8)
    v_mfma_f32_16x16x32_bf16 v[24:27], v[144:147], v[96:99], v[24:27]
    ds_read_b64_tr_b16 v[164:165], v238 offset:0
    ds_read_b64_tr_b16 v[166:167], v238 offset:144
    s_waitcnt lgkmcnt(8)
    v_mfma_f32_16x16x32_bf16 v[28:31], v[148:151], v[96:99], v[28:31]
    ds_read_b64_tr_b16 v[168:169], v239 offset:0
    ds_read_b64_tr_b16 v[170:171], v239 offset:144
    s_waitcnt lgkmcnt(8)
    v_mfma_f32_16x16x32_bf16 v[52:55], v[152:155], v[56:59], v[52:55]
    ds_read_b64_tr_b16 v[172:173], v10
    v_add_u32 v10, v10, v14
    v_mfma_f32_16x16x32_bf16 v[32:35], v[152:155], v[96:99], v[32:35]
    ds_read_b64_tr_b16 v[174:175], v11
    v_add_u32 v11, v11, v14
K1_w6:
    s_cmp_ge_u32 s43, 8
    s_cbranch_scc1 K1_ok6
    ds_read_b128 v[192:195], v5
    s_waitcnt lgkmcnt(0)
    v_min3_u32 v192, v192, v193, v194
    v_min_u32 v192, v192, v195
    s_nop 0
    v_readfirstlane_b32 s43, v192
    s_branch K1_w6
K1_ok6:
    s_waitcnt lgkmcnt(8)
    v_mfma_f32_16x16x32_bf16 v[36:39], v[156:159], v[56:59], v[36:39]
    ds_read_b64_tr_b16 v[136:137], v236 offset:4608
    v_mfma_f32_16x16x32_bf16 v[16:19], v[156:159], v[100:103], v[16:19]
    ds_read_b64_tr_b16 v[138:139], v236 offset:4752
    s_waitcnt lgkmcnt(8)
    v_mfma_f32_16x16x32_bf16 v[20:23], v[160:163], v[100:103], v[20:23]
    ds_read_b64_tr_b16 v[140:141], v237 offset:4608
    ds_read_b64_tr_b16 v[142:143], v237 offset:4752
    s_waitcnt lgkmcnt(8)
    v_mfma_f32_16x16x32_bf16 v[24:27], v[164:167], v[100:103], v[24:27]
    ds_read_b64_tr_b16 v[144:145], v238 offset:4608
    ds_read_b64_tr_b16 v[146:147], v238 offset:4752
    s_waitcnt lgkmcnt(8)
    v_mfma_f32_16x16x32_bf16 v[28:31], v[168:171], v[100:103], v[28:31]
    ds_read_b64_tr_b16 v[148:149], v239 offset:4608
    ds_read_b64_tr_b16 v[150:151], v239 offset:4752
    s_waitcnt lgkmcnt(8)
    v_mfma_f32_16x16x32_bf16 v[52:55], v[172:175], v[56:59], v[52:55]
    ds_read_b64_tr_b16 v[152:153], v10
    v_add_u32 v10, v10, v14
    v_mfma_f32_16x16x32_bf16 v[32:35], v[172:175], v[100:103], v[32:35]
    ds_read_b64_tr_b16 v[154:155], v11
    v_add_u32 v11, v11, v14
    s_waitcnt lgkmcnt(8)
    v_mfma_f32_16x16x32_bf16 v[36:39], v[136:139], v[56:59], v[36:39]
    ds_read_b64_tr_b16 v[156:157], v236 offset:9216
    v_mfma_f32_16x16x32_bf16 v[16:19], v[136:139], v[104:107], v[16:19]
    ds_read_b64_tr_b16 v[158:159], v236 offset:9360
    s_waitcnt lgkmcnt(8)
    v_mfma_f32_16x16x32_bf16 v[20:23], v[140:143], v[104:107], v[20:23]
    ds_read_b64_tr_b16 v[160:161], v237 offset:9216
    ds_read_b64_tr_b16 v[162:163], v237 offset:9360
    s_waitcnt lgkmcnt(8)
    v_mfma_f32_16x16x32_bf16 v[24:27], v[144:147], v[104:107], v[24:27]
    ds_read_b64_tr_b16 v[164:165], v238 offset:9216
    ds_read_b64_tr_b16 v[166:167], v238 offset:9360
    s_waitcnt lgkmcnt(8)
    v_mfma_f32_16x16x32_bf16 v[28:31], v[148:151], v[104:107], v[28:31]
    ds_read_b64_tr_b16 v[168:169], v239 offset:9216
    ds_read_b64_tr_b16 v[170:171], v239 offset:9360
    s_waitcnt lgkmcnt(8)
    v_mfma_f32_16x16x32_bf16 v[52:55], v[152:155], v[56:59], v[52:55]
    ds_read_b64_tr_b16 v[172:173], v10
    v_add_u32 v10, v10, v14
    v_mfma_f32_16x16x32_bf16 v[32:35], v[152:155], v[104:107], v[32:35]
    ds_read_b64_tr_b16 v[174:175], v11
    v_add_u32 v11, v11, v14
K1_w7:
    s_cmp_ge_u32 s43, 9
    s_cbranch_scc1 K1_ok7
    ds_read_b128 v[192:195], v5
    s_waitcnt lgkmcnt(0)
    v_min3_u32 v192, v192, v193, v194
    v_min_u32 v192, v192, v195
    s_nop 0
    v_readfirstlane_b32 s43, v192
    s_branch K1_w7
K1_ok7:
    s_waitcnt lgkmcnt(8)
    v_mfma_f32_16x16x32_bf16 v[36:39], v[156:159], v[56:59], v[36:39]
    ds_read_b64_tr_b16 v[136:137], v236 offset:13824
    v_mfma_f32_16x16x32_bf16 v[16:19], v[156:159], v[108:111], v[16:19]
    ds_read_b64_tr_b16 v[138:139], v236 offset:13968
    s_waitcnt lgkmcnt(8)
    v_mfma_f32_16x16x32_bf16 v[20:23], v[160:163], v[108:111], v[20:23]
    ds_read_b64_tr_b16 v[140:141], v237 offset:13824
    ds_read_b64_tr_b16 v[142:143], v237 offset:13968
    s_waitcnt lgkmcnt(8)
    v_mfma_f32_16x16x32_bf16 v[24:27], v[164:167], v[108:111], v[24:27]
    ds_read_b64_tr_b16 v[144:145], v238 offset:13824
    ds_read_b64_tr_b16 v[146:147], v238 offset:13968
    s_waitcnt lgkmcnt(8)
    v_mfma_f32_16x16x32_bf16 v[28:31], v[168:171], v[108:111], v[28:31]
    ds_read_b64_tr_b16 v[148:149], v239 offset:13824
    ds_read_b64_tr_b16 v[150:151], v239 offset:13968
    s_waitcnt lgkmcnt(8)
    v_mfma_f32_16x16x32_bf16 v[52:55], v[172:175], v[56:59], v[52:55]
    ds_read_b64_tr_b16 v[152:153], v10
    v_add_u32 v10, v10, v14
    v_mfma_f32_16x16x32_bf16 v[32:35], v[172:175], v[108:111], v[32:35]
    ds_read_b64_tr_b16 v[154:155], v11
    v_add_u32 v11, v11, v14
    s_waitcnt lgkmcnt(8)
    v_mfma_f32_16x16x32_bf16 v[36:39], v[136:139], v[56:59], v[36:39]
    ds_read_b64_tr_b16 v[156:157], v236 offset:18432
    v_mfma_f32_16x16x32_bf16 v[16:19], v[136:139], v[112:115], v[16:19]
    ds_read_b64_tr_b16 v[158:159], v236 offset:18576
    s_waitcnt lgkmcnt(8)
    v_mfma_f32_16x16x32_bf16 v[20:23], v[140:143], v[112:115], v[20:23]
    ds_read_b64_tr_b16 v[160:161], v237 offset:18432
    ds_read_b64_tr_b16 v[162:163], v237 offset:18576
    s_waitcnt lgkmcnt(8)
    v_mfma_f32_16x16x32_bf16 v[24:27], v[144:147], v[112:115], v[24:27]
    ds_read_b64_tr_b16 v[164:165], v238 offset:18432
    ds_read_b64_tr_b16 v[166:167], v238 offset:18576
    s_waitcnt lgkmcnt(8)
    v_mfma_f32_16x16x32_bf16 v[28:31], v[148:151], v[112:115], v[28:31]
    ds_read_b64_tr_b16 v[168:169], v239 offset:18432
    ds_read_b64_tr_b16 v[170:171], v239 offset:18576
    s_waitcnt lgkmcnt(8)
    v_mfma_f32_16x16x32_bf16 v[52:55], v[152:155], v[56:59], v[52:55]
    ds_read_b64_tr_b16 v[172:173], v10
    v_add_u32 v10, v10, v14
    v_mfma_f32_16x16x32_bf16 v[32:35], v[152:155], v[112:115], v[32:35]
    ds_read_b64_tr_b16 v[174:175], v11
    v_add_u32 v11, v11, v14
K1_w8:
    s_cmp_ge_u32 s43, 10
    s_cbranch_scc1 K1_ok8
    ds_read_b128 v[192:195], v5
    s_waitcnt lgkmcnt(0)
    v_min3_u32 v192, v192, v193, v194
    v_min_u32 v192, v192, v195
    s_nop 0
    v_readfirstlane_b32 s43, v192
    s_branch K1_w8
K1_ok8:
    s_waitcnt lgkmcnt(8)
    v_mfma_f32_16x16x32_bf16 v[36:39], v[156:159], v[56:59], v[36:39]
    ds_read_b64_tr_b16 v[136:137], v236 offset:23040
    v_mfma_f32_16x16x32_bf16 v[16:19], v[156:159], v[116:119], v[16:19]
    ds_read_b64_tr_b16 v[138:139], v236 offset:23184
    s_waitcnt lgkmcnt(8)
    v_mfma_f32_16x16x32_bf16 v[20:23], v[160:163], v[116:119], v[20:23]
    ds_read_b64_tr_b16 v[140:141], v237 offset:23040
    ds_read_b64_tr_b16 v[142:143], v237 offset:23184
    s_waitcnt lgkmcnt(8)
    v_mfma_f32_16x16x32_bf16 v[24:27], v[164:167], v[116:119], v[24:27]
    ds_read_b64_tr_b16 v[144:145], v238 offset:23040
    ds_read_b64_tr_b16 v[146:147], v238 offset:23184
    s_waitcnt lgkmcnt(8)
    v_mfma_f32_16x16x32_bf16 v[28:31], v[168:171], v[116:119], v[28:31]
    ds_read_b64_tr_b16 v[148:149], v239 offset:23040
    ds_read_b64_tr_b16 v[150:151], v239 offset:23184
    s_waitcnt lgkmcnt(8)
    v_mfma_f32_16x16x32_bf16 v[52:55], v[172:175], v[56:59], v[52:55]
    ds_read_b64_tr_b16 v[152:153], v10
    v_add_u32 v10, v10, v14
    v_mfma_f32_16x16x32_bf16 v[32:35], v[172:175], v[116:119], v[32:35]
    ds_read_b64_tr_b16 v[154:155], v11
    v_add_u32 v11, v11, v14
    s_waitcnt lgkmcnt(8)
    v_mfma_f32_16x16x32_bf16 v[36:39], v[136:139], v[56:59], v[36:39]
    ds_read_b64_tr_b16 v[156:157], v236 offset:27648
    v_mfma_f32_16x16x32_bf16 v[16:19], v[136:139], v[120:123], v[16:19]
    ds_read_b64_tr_b16 v[158:159], v236 offset:27792
    s_waitcnt lgkmcnt(8)
    v_mfma_f32_16x16x32_bf16 v[20:23], v[140:143], v[120:123], v[20:23]
    ds_read_b64_tr_b16 v[160:161], v237 offset:27648
    ds_read_b64_tr_b16 v[162:163], v237 offset:27792
    s_waitcnt lgkmcnt(8)
    v_mfma_f32_16x16x32_bf16 v[24:27], v[144:147], v[120:123], v[24:27]
    ds_read_b64_tr_b16 v[164:165], v238 offset:27648
    ds_read_b64_tr_b16 v[166:167], v238 offset:27792
    s_waitcnt lgkmcnt(8)
    v_mfma_f32_16x16x32_bf16 v[28:31], v[148:151], v[120:123], v[28:31]
    ds_read_b64_tr_b16 v[168:169], v239 offset:27648
    ds_read_b64_tr_b16 v[170:171], v239 offset:27792
    s_waitcnt lgkmcnt(8)
    v_mfma_f32_16x16x32_bf16 v[52:55], v[152:155], v[56:59], v[52:55]
    ds_read_b64_tr_b16 v[172:173], v10
    v_add_u32 v10, v10, v14
    v_mfma_f32_16x16x32_bf16 v[32:35], v[152:155], v[120:123], v[32:35]
    ds_read_b64_tr_b16 v[174:175], v11
    v_add_u32 v11, v11, v14
K1_w9:
    s_cmp_ge_u32 s43, 11
    s_cbranch_scc1 K1_ok9
    ds_read_b128 v[192:195], v5
    s_waitcnt lgkmcnt(0)
    v_min3_u32 v192, v192, v193, v194
    v_min_u32 v192, v192, v195
    s_nop 0
    v_readfirstlane_b32 s43, v192
    s_branch K1_w9
K1_ok9:
    s_waitcnt lgkmcnt(8)
    v_mfma_f32_16x16x32_bf16 v[36:39], v[156:159], v[56:59], v[36:39]
    ds_read_b64_tr_b16 v[136:137], v236 offset:32256
    v_mfma_f32_16x16x32_bf16 v[16:19], v[156:159], v[124:127], v[16:19]
    ds_read_b64_tr_b16 v[138:139], v236 offset:32400
    s_waitcnt lgkmcnt(8)
    v_mfma_f32_16x16x32_bf16 v[20:23], v[160:163], v[124:127], v[20:23]
    ds_read_b64_tr_b16 v[140:141], v237 offset:32256
    ds_read_b64_tr_b16 v[142:143], v237 offset:32400
    s_waitcnt lgkmcnt(8)
    v_mfma_f32_16x16x32_bf16 v[24:27], v[164:167], v[124:127], v[24:27]
    ds_read_b64_tr_b16 v[144:145], v238 offset:32256
    ds_read_b64_tr_b16 v[146:147], v238 offset:32400
    s_waitcnt lgkmcnt(8)
    v_mfma_f32_16x16x32_bf16 v[28:31], v[168:171], v[124:127], v[28:31]
    ds_read_b64_tr_b16 v[148:149], v239 offset:32256
    ds_read_b64_tr_b16 v[150:151], v239 offset:32400
    s_waitcnt lgkmcnt(8)
    v_mfma_f32_16x16x32_bf16 v[52:55], v[172:175], v[56:59], v[52:55]
    ds_read_b64_tr_b16 v[152:153], v10
    v_add_u32 v10, v10, v14
    v_mfma_f32_16x16x32_bf16 v[32:35], v[172:175], v[124:127], v[32:35]
    ds_read_b64_tr_b16 v[154:155], v11
    v_add_u32 v11, v11, v14
    s_waitcnt lgkmcnt(8)
    v_mfma_f32_16x16x32_bf16 v[36:39], v[136:139], v[56:59], v[36:39]
    ds_read_b64_tr_b16 v[156:157], v236 offset:36864
    v_mfma_f32_16x16x32_bf16 v[16:19], v[136:139], v[128:131], v[16:19]
    ds_read_b64_tr_b16 v[158:159], v236 offset:37008
    s_waitcnt lgkmcnt(8)
    v_mfma_f32_16x16x32_bf16 v[20:23], v[140:143], v[128:131], v[20:23]
    ds_read_b64_tr_b16 v[160:161], v237 offset:36864
    ds_read_b64_tr_b16 v[162:163], v237 offset:37008
    s_waitcnt lgkmcnt(8)
    v_mfma_f32_16x16x32_bf16 v[24:27], v[144:147], v[128:131], v[24:27]
    ds_read_b64_tr_b16 v[164:165], v238 offset:36864
    ds_read_b64_tr_b16 v[166:167], v238 offset:37008
    s_waitcnt lgkmcnt(8)
    v_mfma_f32_16x16x32_bf16 v[28:31], v[148:151], v[128:131], v[28:31]
    ds_read_b64_tr_b16 v[168:169], v239 offset:36864
    ds_read_b64_tr_b16 v[170:171], v239 offset:37008
    s_waitcnt lgkmcnt(8)
    v_mfma_f32_16x16x32_bf16 v[52:55], v[152:155], v[56:59], v[52:55]
    ds_read_b64_tr_b16 v[172:173], v10
    v_add_u32 v10, v10, v14
    v_mfma_f32_16x16x32_bf16 v[32:35], v[152:155], v[128:131], v[32:35]
    ds_read_b64_tr_b16 v[174:175], v11
    v_add_u32 v11, v11, v14
    s_waitcnt lgkmcnt(8)
    v_mfma_f32_16x16x32_bf16 v[36:39], v[156:159], v[56:59], v[36:39]
    v_mfma_f32_16x16x32_bf16 v[16:19], v[156:159], v[132:135], v[16:19]
    s_waitcnt lgkmcnt(6)
    v_mfma_f32_16x16x32_bf16 v[20:23], v[160:163], v[132:135], v[20:23]
    s_waitcnt lgkmcnt(4)
    v_mfma_f32_16x16x32_bf16 v[24:27], v[164:167], v[132:135], v[24:27]
    s_waitcnt lgkmcnt(2)
    v_mfma_f32_16x16x32_bf16 v[28:31], v[168:171], v[132:135], v[28:31]
    s_waitcnt lgkmcnt(0)
    v_mfma_f32_16x16x32_bf16 v[52:55], v[172:175], v[56:59], v[52:55]
    v_mfma_f32_16x16x32_bf16 v[32:35], v[172:175], v[132:135], v[32:35]
    ds_write_b128 v60, v[36:39]
    v_cmp_gt_u32 vcc, 2, v4
    s_waitcnt lgkmcnt(0)
    s_barrier
    ds_read_b128 v[40:43], v61
    ds_read_b128 v[44:47], v62
    ds_read_b128 v[48:51], v63
    v_fmac_f32 v16, v12, v36
    v_fmac_f32 v17, v12, v37
    v_fmac_f32 v18, v12, v38
    v_fmac_f32 v19, v12, v39
    v_fmac_f32 v32, v12, v52
    v_fmac_f32 v33, v12, v53
    v_fmac_f32 v34, v12, v54
    v_fmac_f32 v35, v12, v55
    v_mul_f32 v32, v15, v32
    v_mul_f32 v33, v15, v33
    v_mul_f32 v34, v15, v34
    v_mul_f32 v35, v15, v35
    v_cvt_pk_bf16_f32 v72, v32, v33
    v_cvt_pk_bf16_f32 v73, v34, v35
    s_mov_b64 exec, vcc
    ds_write_b64 v180, v[72:73] offset:128
    s_not_b64 exec, vcc
    s_cmp_lt_u32 s36, 3
    s_cbranch_scc1 K1_v
    s_cmp_eq_u32 s15, 6
    s_cbranch_scc1 K1_on
    ds_write_b64 v243, v[72:73] offset:2288
    s_cmp_lg_u32 s15, 2
    s_cbranch_scc1 K1_kvd
    s_mov_b32 exec_hi, 0xffff0000
    buffer_store_dword v73, v244, s[28:31], s84 offen sc1
    s_branch K1_kvd
K1_on:
    ds_write_b64 v243, v[56:57] offset:2288
    s_branch K1_kvd
K1_v:
    ds_write_b16 v243, v72 offset:2176
    ds_write_b16_d16_hi v243, v72 offset:2192
    ds_write_b16 v243, v73 offset:2208
    ds_write_b16_d16_hi v243, v73 offset:2224
K1_kvd:
    s_mov_b64 exec, -1
    ds_read_b128 v[148:151], v185 offset:2304
    v_mul_f32 v16, v245, v16
    v_mul_f32 v17, v245, v17
    v_mul_f32 v18, v245, v18
    v_mul_f32 v19, v245, v19
    v_cvt_pk_bf16_f32 v64, v16, v17
    v_cvt_pk_bf16_f32 v65, v18, v19
    ds_write_b64 v176, v[64:65]
    s_waitcnt lgkmcnt(0)
    v_fmac_f32 v20, v12, v40
    v_fmac_f32 v21, v12, v41
    v_fmac_f32 v22, v12, v42
    v_fmac_f32 v23, v12, v43
    v_mul_f32 v20, v245, v20
    v_mul_f32 v21, v245, v21
    v_mul_f32 v22, v245, v22
    v_mul_f32 v23, v245, v23
    v_cvt_pk_bf16_f32 v66, v20, v21
    v_cvt_pk_bf16_f32 v67, v22, v23
    ds_write_b64 v177, v[66:67]
    v_fmac_f32 v24, v12, v44
    v_fmac_f32 v25, v12, v45
    v_fmac_f32 v26, v12, v46
    v_fmac_f32 v27, v12, v47
    v_mul_f32 v24, v245, v24
    v_mul_f32 v25, v245, v25
    v_mul_f32 v26, v245, v26
    v_mul_f32 v27, v245, v27
    v_cvt_pk_bf16_f32 v68, v24, v25
    v_cvt_pk_bf16_f32 v69, v26, v27
    ds_write_b64 v178, v[68:69]
    v_fmac_f32 v28, v12, v48
    v_fmac_f32 v29, v12, v49
    v_fmac_f32 v30, v12, v50
    v_fmac_f32 v31, v12, v51
    v_mul_f32 v28, v245, v28
    v_mul_f32 v29, v245, v29
    v_mul_f32 v30, v245, v30
    v_mul_f32 v31, v245, v31
    v_cvt_pk_bf16_f32 v70, v28, v29
    v_cvt_pk_bf16_f32 v71, v30, v31
    ds_write_b64 v179, v[70:71]
    ds_read2_b32 v[136:137], v181 offset0:0 offset1:1
    ds_read2_b32 v[138:139], v181 offset0:2 offset1:3
    ds_read2_b32 v[140:141], v182 offset0:0 offset1:1
    ds_read2_b32 v[142:143], v182 offset0:2 offset1:3
    ds_read2_b32 v[144:145], v183 offset0:8 offset1:44
    ds_read2_b32 v[146:147], v183 offset0:80 offset1:116
    s_mov_b64 exec, 0xffff
    buffer_store_dwordx4 v[148:151], v242, s[28:31], s82 offen sc1
    s_mov_b64 exec, -1
    s_waitcnt lgkmcnt(4)
    buffer_store_dwordx4 v[136:139], v199, s[28:31], s34 offen sc1
    s_waitcnt lgkmcnt(2)
    buffer_store_dwordx4 v[140:143], v199, s[28:31], s83 offen sc1
    s_mov_b64 exec, 0xffff
    s_waitcnt lgkmcnt(0)
    buffer_store_dwordx4 v[144:147], v184, s[28:31], s34 offen offset:1024 sc1
K1_fin:
    s_endpgm
K1_end:
    s_endpgm
.globl k2_kernel
.p2align 8
.type k2_kernel,@function
k2_kernel:
    s_cmp_lt_u32 s2, 256
    s_cbranch_scc1 K2_run
    s_endpgm
K2_run:
    s_load_dwordx2 s[4:5], s[0:1], 96
    s_load_dwordx2 s[6:7], s[0:1], 0
    s_load_dwordx2 s[80:81], s[0:1], 48
    s_load_dwordx2 s[82:83], s[0:1], 64
    v_lshrrev_b32 v1, 6, v0
    v_and_b32 v2, 63, v0
    v_readfirstlane_b32 s3, v1
    s_mov_b32 s22, 0
K2_main:
    v_and_b32 v2, 63, v0
    v_and_b32 v5, 31, v0
    v_bfe_u32 v4, v0, 5, 1
    v_lshlrev_b32 v3, 4, v2
    v_lshlrev_b32 v8, 2, v2
    s_mul_i32 s16, s2, 9216
    s_add_u32 s16, s16, 0
    s_mul_i32 s54, s3, 1152
    s_add_u32 s54, s54, s16
    v_lshl_or_b32 v10, v4, 30, v8
    v_mul_u32_u24 v6, 320, v4
    v_lshl_add_u32 v6, v5, 4, v6
    v_add_u32 v6, 1024, v6
    v_subrev_u32 v18, 32, v6
    v_and_b32 v19, 30, v5
    v_cmp_eq_u32 vcc, 20, v19
    v_cmp_gt_u32 s[20:21], 18, v5
    v_mov_b32 v19, 2146435072
    v_cndmask_b32 v18, v19, v18, vcc
    v_cndmask_b32_e64 v6, v18, v6, s[20:21]
    v_lshl_or_b32 v7, v4, 30, v3
    v_cmp_eq_u32 s[20:21], 0, v4
    s_lshr_b32 s18, s2, 3
    s_lshl_b32 s19, s3, 1
    s_add_u32 s18, s18, s19
    s_and_b32 s18, s18, 15
    s_add_u32 s19, s18, 1
    s_and_b32 s19, s19, 15
    s_mul_i32 s24, s18, 9216
    s_mul_i32 s25, s18, 9216
    s_add_u32 s25, s25, 2304
    s_mul_i32 s26, s18, 9216
    s_add_u32 s26, s26, 4608
    s_mul_i32 s27, s18, 9216
    s_add_u32 s27, s27, 6912
    s_mul_i32 s28, s19, 9216
    s_mul_i32 s29, s19, 9216
    s_add_u32 s29, s29, 2304
    s_mul_i32 s30, s19, 9216
    s_add_u32 s30, s30, 4608
    s_mul_i32 s31, s19, 9216
    s_add_u32 s31, s31, 6912
    s_lshl_b32 s18, s18, 9
    s_add_u32 s18, s18, 147456
    s_lshl_b32 s19, s19, 9
    s_add_u32 s19, s19, 147456
    s_waitcnt lgkmcnt(0)
    s_mov_b32 s8, s4
    s_mov_b32 s9, s5
    s_mov_b32 s10, 268435456
    s_mov_b32 s11, 0x00020000
    s_add_u32 s12, s4, 4718592
    s_addc_u32 s13, s5, 0
    s_mov_b32 s14, 155648
    s_mov_b32 s15, 0x00020000
    buffer_load_dwordx4 v[196:199], v3, s[8:11], s16 offen
    buffer_load_dword v200, v10, s[8:11], s16 offen offset:1024
    buffer_load_dwordx4 v[20:23], v3, s[12:15], s24 offen
    buffer_load_dwordx4 v[52:55], v7, s[12:15], s18 offen
    buffer_load_dwordx4 v[24:27], v3, s[12:15], s25 offen
    buffer_load_dwordx4 v[60:63], v6, s[12:15], s24 offen
    buffer_load_dwordx4 v[64:67], v6, s[12:15], s24 offen offset:640
    s_mul_i32 s17, s3, 1536
    s_cmp_eq_u32 s22, 0
    s_cselect_b32 s17, s17, 64512
    s_mov_b32 m0, s17
    v_add_u32 v18, s17, v8
    buffer_load_dwordx4 v3, s[8:11], s54 offen lds
    buffer_load_dword v10, s[8:11], s54 offen offset:1024 lds
    v_mov_b32 v201, 0
    ds_write_b32 v18, v201 offset:1280
    ds_write_b32 v8, v201 offset:22144
    s_lshr_b32 s41, s2, 3
    s_and_b32 s42, s3, 1
    s_lshl_b32 s42, s42, 5
    s_add_u32 s41, s41, s42
    s_cmp_lt_u32 s3, 6
    s_cbranch_scc1 K2_nopf
    s_getpc_b64 s[42:43]
Lpf2:
    s_lshl_b32 s44, s41, 10
    s_min_u32 s44, s44, K2_end-k2_kernel-1024
    s_add_u32 s42, s42, s44
    s_addc_u32 s43, s43, 0
    s_add_u32 s42, s42, k2_kernel-Lpf2
    s_addc_u32 s43, s43, (k2_kernel-Lpf2)>>32
    global_load_dwordx4 v[232:235], v3, s[42:43]
K2_nopf:
    s_add_u32 s32, s4, 4898816
    s_addc_u32 s33, s5, 0
    s_mov_b32 s34, 663552
    s_mov_b32 s35, 0x00020000
    s_mov_b32 s36, s6
    s_mov_b32 s37, s7
    s_mov_b32 s38, 2359296
    s_mov_b32 s39, 0x00020000
    v_bfe_u32 v10, v0, 4, 2
    v_and_b32 v13, 7, v0
    v_lshlrev_b32 v9, 7, v10
    v_lshl_add_u32 v9, v13, 4, v9
    v_add_u32 v9, 12288, v9
    v_bfe_u32 v11, v0, 3, 2
    v_lshl_add_u32 v11, v11, 1, v4
    v_lshlrev_b32 v14, 4, v13
    v_lshl_add_u32 v14, v11, 1, v14
    v_add_u32 v14, 20480, v14
    v_mul_u32_u24 v15, 1184, v13
    v_lshl_add_u32 v15, v10, 3, v15
    s_lshl_b32 s17, s3, 5
    s_add_u32 s17, s17, 64512
    v_add_u32 v15, s17, v15
    s_mul_i32 s55, s3, 10240
    s_add_u32 s55, s55, 73984
    s_mul_i32 s17, s3, 2560
    s_add_u32 s17, s17, 23552
    v_add_u32 v16, s17, v3
    v_lshlrev_b32 v19, 3, v2
    v_add_u32 v17, s17, v19
    v_add_u32 v19, 23552, v19
    s_and_b32 s52, s3, 3
    s_lshr_b32 s53, s3, 2
    s_lshr_b32 s17, s52, 1
    s_lshl_b32 s17, s17, 10
    s_and_b32 s41, s52, 1
    s_lshl_b32 s41, s41, 3
    s_add_u32 s17, s17, s41
    s_add_u32 s17, s17, 23552
    v_add_u32 v18, s17, v3
    s_lshl_b32 s17, s52, 2
    v_add_u32 v1, s17, v3
    s_mov_b32 s23, 0
    s_mul_i32 s40, s3, 18432
    v_mov_b32 v202, 0
    v_mov_b32 v12, 0x3f803f80
    s_waitcnt vmcnt(5)
    v_cndmask_b32_e64 v52, v12, v52, s[20:21]
    v_cndmask_b32_e64 v53, v12, v53, s[20:21]
    v_cndmask_b32_e64 v54, v12, v54, s[20:21]
    v_cndmask_b32_e64 v55, v12, v55, s[20:21]
    v_mov_b32 v203, v200
    s_cmp_eq_u32 s22, 0
    s_cbranch_scc1 K2_go
    ds_read_b128 v[196:199], v3 offset:0
    ds_read2st64_b32 v[200:201], v8 offset0:4 offset1:5
    ds_read2st64_b32 v[202:203], v8 offset0:5 offset1:4
    s_waitcnt lgkmcnt(0)
K2_go:
    v_mfma_f32_32x32x16_bf16 v[124:139], v[20:23], v[196:199], 0
    v_mfma_f32_32x32x8_bf16 v[124:139], v[52:53], v[200:201], v[124:139]
    buffer_load_dwordx4 v[28:31], v3, s[12:15], s26 offen
    buffer_load_dwordx4 v[32:35], v3, s[12:15], s27 offen
    buffer_load_dwordx4 v[68:71], v6, s[12:15], s25 offen
    buffer_load_dwordx4 v[72:75], v6, s[12:15], s25 offen offset:640
    s_and_b32 s84, s2, 7
    s_andn2_b32 s85, s2, 7
    s_add_u32 s85, s85, s3
    s_cmp_lt_u32 s85, 162
    s_cselect_b32 s64, s80, s82
    s_cselect_b32 s65, s81, s83
    s_mov_b32 s66, 5308416
    s_mov_b32 s67, 0x00020000
    s_mov_b32 s62, 1152
    s_cselect_b32 s58, 9216, s62
    s_mov_b32 s62, 663552
    s_cselect_b32 s57, 1152, s62
    s_mov_b32 s62, 10870784
    s_cselect_b32 s61, 5562368, s62
    s_cselect_b32 s62, 0, 162
    s_sub_u32 s62, s85, s62
    s_mul_i32 s57, s57, s84
    s_mul_i32 s63, s62, 7282
    s_lshr_b32 s63, s63, 16
    s_mul_i32 s56, s63, 9
    s_sub_u32 s62, s62, s56
    s_lshl_b32 s56, s62, 7
    s_add_u32 s57, s57, s56
    s_lshl_b32 s56, s58, 5
    s_mul_i32 s56, s56, s63
    s_add_u32 s57, s57, s56
    s_mul_i32 s56, s84, 9
    s_add_u32 s56, s56, s62
    s_mul_i32 s56, s56, 72
    s_add_u32 s56, s56, s63
    s_lshl_b32 s56, s56, 10
    s_add_u32 s61, s61, s56
    s_lshl_b32 s56, s58, 2
    s_lshl_b32 s59, s58, 1
    s_lshl_b32 s60, s58, 4
    s_lshr_b32 s85, s2, 3
    s_lshl_b32 s17, s85, 1
    s_add_u32 s17, s17, s3
    s_add_u32 s17, s17, 256
    s_add_u32 s85, s85, 320
    s_cmp_lt_u32 s3, 2
    s_cselect_b32 s85, s17, s85
    s_cmp_gt_u32 s3, 2
    s_cselect_b32 s85, 999, s85
    s_cmp_lt_u32 s85, 162
    s_cselect_b32 s76, s80, s82
    s_cselect_b32 s77, s81, s83
    s_mov_b32 s78, 5308416
    s_mov_b32 s79, 0x00020000
    s_mov_b32 s74, 1152
    s_cselect_b32 s70, 9216, s74
    s_mov_b32 s74, 663552
    s_cselect_b32 s69, 1152, s74
    s_mov_b32 s74, 10870784
    s_cselect_b32 s73, 5562368, s74
    s_cselect_b32 s74, 0, 162
    s_sub_u32 s74, s85, s74
    s_mul_i32 s69, s69, s84
    s_mul_i32 s75, s74, 7282
    s_lshr_b32 s75, s75, 16
    s_mul_i32 s68, s75, 9
    s_sub_u32 s74, s74, s68
    s_lshl_b32 s68, s74, 7
    s_add_u32 s69, s69, s68
    s_lshl_b32 s68, s70, 5
    s_mul_i32 s68, s68, s75
    s_add_u32 s69, s69, s68
    s_mul_i32 s68, s84, 9
    s_add_u32 s68, s68, s74
    s_mul_i32 s68, s68, 72
    s_add_u32 s68, s68, s75
    s_lshl_b32 s68, s68, 10
    s_add_u32 s73, s73, s68
    s_lshl_b32 s68, s70, 2
    s_lshl_b32 s71, s70, 1
    s_lshl_b32 s72, s70, 4
    s_setprio 3
    v_exp_f32 v124, v124
    buffer_load_dwordx4 v[36:39], v3, s[12:15], s28 offen
    v_exp_f32 v125, v125
    s_nop 0
    v_exp_f32 v126, v126
    v_exp_f32 v127, v127
    v_exp_f32 v128, v128
    buffer_load_dwordx4 v[56:59], v7, s[12:15], s19 offen
    v_exp_f32 v129, v129
    v_exp_f32 v130, v130
    s_waitcnt vmcnt(10)
    v_mfma_f32_32x32x16_bf16 v[140:155], v[24:27], v[196:199], 0
    v_exp_f32 v131, v131
    v_cvt_pk_bf16_f32 v156, v124, v125
    buffer_load_dwordx4 v[40:43], v3, s[12:15], s29 offen
    v_cvt_pk_bf16_f32 v157, v126, v127
    v_cvt_pk_bf16_f32 v158, v128, v129
    v_cvt_pk_bf16_f32 v159, v130, v131
    v_exp_f32 v132, v132
    v_mfma_f32_32x32x8_bf16 v[140:155], v[52:53], v[202:203], v[140:155]
    buffer_load_dwordx4 v[76:79], v6, s[12:15], s26 offen
    v_exp_f32 v133, v133
    v_exp_f32 v134, v134
    v_exp_f32 v135, v135
    v_exp_f32 v136, v136
    v_exp_f32 v137, v137
    buffer_load_dwordx4 v[80:83], v6, s[12:15], s26 offen offset:640
    v_exp_f32 v138, v138
    s_waitcnt vmcnt(11)
    v_mfma_f32_32x32x16_bf16 v[164:179], v[60:63], v[156:159], 0
    v_exp_f32 v139, v139
    v_cvt_pk_bf16_f32 v160, v132, v133
    v_cvt_pk_bf16_f32 v161, v134, v135
    v_cvt_pk_bf16_f32 v162, v136, v137
    v_cvt_pk_bf16_f32 v163, v138, v139
    v_exp_f32 v140, v140
    buffer_load_dwordx4 v[84:87], v6, s[12:15], s27 offen
    v_exp_f32 v141, v141
    v_mfma_f32_32x32x16_bf16 v[164:179], v[64:67], v[160:163], v[164:179]
    v_exp_f32 v142, v142
    v_exp_f32 v143, v143
    v_exp_f32 v144, v144
    v_exp_f32 v145, v145
    v_exp_f32 v146, v146
    s_waitcnt vmcnt(9)
    v_mfma_f32_32x32x16_bf16 v[124:139], v[28:31], v[196:199], 0
    v_exp_f32 v147, v147
    v_cvt_pk_bf16_f32 v156, v140, v141
    v_cvt_pk_bf16_f32 v157, v142, v143
    v_cvt_pk_bf16_f32 v158, v144, v145
    v_cvt_pk_bf16_f32 v159, v146, v147
    buffer_load_dwordx4 v[88:91], v6, s[12:15], s27 offen offset:640
    v_exp_f32 v148, v148
    v_mfma_f32_32x32x8_bf16 v[124:139], v[54:55], v[200:201], v[124:139]
    v_exp_f32 v149, v149
    v_exp_f32 v150, v150
    v_exp_f32 v151, v151
    v_exp_f32 v152, v152
    v_exp_f32 v153, v153
    v_exp_f32 v154, v154
    s_waitcnt vmcnt(7)
    v_mfma_f32_32x32x16_bf16 v[164:179], v[68:71], v[156:159], v[164:179]
    v_exp_f32 v155, v155
    v_cvt_pk_bf16_f32 v160, v148, v149
    v_cvt_pk_bf16_f32 v161, v150, v151
    v_cvt_pk_bf16_f32 v162, v152, v153
    v_cvt_pk_bf16_f32 v163, v154, v155
    s_setprio 1
    v_exp_f32 v124, v124
    buffer_load_dwordx4 v[44:47], v3, s[12:15], s30 offen
    v_exp_f32 v125, v125
    v_mfma_f32_32x32x16_bf16 v[164:179], v[72:75], v[160:163], v[164:179]
    v_exp_f32 v126, v126
    v_exp_f32 v127, v127
    v_exp_f32 v128, v128
    v_exp_f32 v129, v129
    buffer_load_dwordx4 v[48:51], v3, s[12:15], s31 offen
    v_exp_f32 v130, v130
    s_waitcnt vmcnt(11)
    v_mfma_f32_32x32x16_bf16 v[140:155], v[32:35], v[196:199], 0
    v_exp_f32 v131, v131
    v_cvt_pk_bf16_f32 v156, v124, v125
    v_cvt_pk_bf16_f32 v157, v126, v127
    v_cvt_pk_bf16_f32 v158, v128, v129
    v_cvt_pk_bf16_f32 v159, v130, v131
    buffer_load_dwordx4 v[92:95], v6, s[12:15], s28 offen
    v_exp_f32 v132, v132
    v_mfma_f32_32x32x8_bf16 v[140:155], v[54:55], v[202:203], v[140:155]
    v_exp_f32 v133, v133
    v_exp_f32 v134, v134
    v_exp_f32 v135, v135
    v_exp_f32 v136, v136
    buffer_load_dwordx4 v[96:99], v6, s[12:15], s28 offen offset:640
    v_exp_f32 v137, v137
    v_exp_f32 v138, v138
    s_waitcnt vmcnt(6)
    v_mfma_f32_32x32x16_bf16 v[164:179], v[76:79], v[156:159], v[164:179]
    v_exp_f32 v139, v139
    v_cvt_pk_bf16_f32 v160, v132, v133
    v_cvt_pk_bf16_f32 v161, v134, v135
    v_cvt_pk_bf16_f32 v162, v136, v137
    v_cvt_pk_bf16_f32 v163, v138, v139
    s_setprio 0
    v_exp_f32 v140, v140
    buffer_load_dwordx4 v[100:103], v6, s[12:15], s29 offen
    v_exp_f32 v141, v141
    v_mfma_f32_32x32x16_bf16 v[164:179], v[80:83], v[160:163], v[164:179]
    v_exp_f32 v142, v142
    v_exp_f32 v143, v143
    v_exp_f32 v144, v144
    v_exp_f32 v145, v145
    v_exp_f32 v146, v146
    s_waitcnt vmcnt(10)
    v_cndmask_b32_e64 v56, v12, v56, s[20:21]
    v_cndmask_b32_e64 v57, v12, v57, s[20:21]
    v_cndmask_b32_e64 v58, v12, v58, s[20:21]
    v_cndmask_b32_e64 v59, v12, v59, s[20:21]
    v_mfma_f32_32x32x16_bf16 v[124:139], v[36:39], v[196:199], 0
    v_exp_f32 v147, v147
    v_cvt_pk_bf16_f32 v156, v140, v141
    v_cvt_pk_bf16_f32 v157, v142, v143
    v_cvt_pk_bf16_f32 v158, v144, v145
    v_cvt_pk_bf16_f32 v159, v146, v147
    buffer_load_dwordx4 v[104:107], v6, s[12:15], s29 offen offset:640
    v_exp_f32 v148, v148
    v_mfma_f32_32x32x8_bf16 v[124:139], v[56:57], v[200:201], v[124:139]
    v_exp_f32 v149, v149
    v_exp_f32 v150, v150
    v_exp_f32 v151, v151
    v_exp_f32 v152, v152
    v_exp_f32 v153, v153
    v_exp_f32 v154, v154
    s_waitcnt vmcnt(6)
    v_mfma_f32_32x32x16_bf16 v[164:179], v[84:87], v[156:159], v[164:179]
    v_exp_f32 v155, v155
    v_cvt_pk_bf16_f32 v160, v148, v149
    v_cvt_pk_bf16_f32 v161, v150, v151
    v_cvt_pk_bf16_f32 v162, v152, v153
    v_cvt_pk_bf16_f32 v163, v154, v155
    s_waitcnt lgkmcnt(0)
    s_barrier
    s_setprio 3
    v_exp_f32 v124, v124
    buffer_load_dwordx4 v[108:111], v6, s[12:15], s30 offen
    v_exp_f32 v125, v125
    v_mfma_f32_32x32x16_bf16 v[164:179], v[88:91], v[160:163], v[164:179]
    ds_read_b128 v[204:207], v3 offset:1536
    ds_read2st64_b32 v[208:209], v8 offset0:10 offset1:11
    ds_read2st64_b32 v[210:211], v8 offset0:11 offset1:10
    v_exp_f32 v126, v126
    v_exp_f32 v127, v127
    v_exp_f32 v128, v128
    v_exp_f32 v129, v129
    v_exp_f32 v130, v130
    s_waitcnt vmcnt(11)
    v_mfma_f32_32x32x16_bf16 v[140:155], v[40:43], v[196:199], 0
    v_exp_f32 v131, v131
    v_cvt_pk_bf16_f32 v156, v124, v125
    v_cvt_pk_bf16_f32 v157, v126, v127
    v_cvt_pk_bf16_f32 v158, v128, v129
    v_cvt_pk_bf16_f32 v159, v130, v131
    buffer_load_dwordx4 v[112:115], v6, s[12:15], s30 offen offset:640
    v_exp_f32 v132, v132
    v_mfma_f32_32x32x8_bf16 v[140:155], v[56:57], v[202:203], v[140:155]
    v_exp_f32 v133, v133
    v_exp_f32 v134, v134
    v_exp_f32 v135, v135
    v_exp_f32 v136, v136
    v_exp_f32 v137, v137
    v_exp_f32 v138, v138
    s_waitcnt vmcnt(4)
    v_mfma_f32_32x32x16_bf16 v[164:179], v[92:95], v[156:159], v[164:179]
    v_exp_f32 v139, v139
    v_cvt_pk_bf16_f32 v160, v132, v133
    v_cvt_pk_bf16_f32 v161, v134, v135
    v_cvt_pk_bf16_f32 v162, v136, v137
    v_cvt_pk_bf16_f32 v163, v138, v139
    v_exp_f32 v140, v140
    buffer_load_dwordx4 v[116:119], v6, s[12:15], s31 offen
    v_exp_f32 v141, v141
    v_mfma_f32_32x32x16_bf16 v[164:179], v[96:99], v[160:163], v[164:179]
    v_exp_f32 v142, v142
    v_exp_f32 v143, v143
    v_exp_f32 v144, v144
    v_exp_f32 v145, v145
    v_exp_f32 v146, v146
    s_waitcnt vmcnt(8)
    v_mfma_f32_32x32x16_bf16 v[124:139], v[44:47], v[196:199], 0
    v_exp_f32 v147, v147
    v_cvt_pk_bf16_f32 v156, v140, v141
    v_cvt_pk_bf16_f32 v157, v142, v143
    v_cvt_pk_bf16_f32 v158, v144, v145
    v_cvt_pk_bf16_f32 v159, v146, v147
    buffer_load_dwordx4 v[120:123], v6, s[12:15], s31 offen offset:640
    v_exp_f32 v148, v148
    v_lshrrev_b32 v212, 3, v2
    v_mul_lo_u32 v212, v212, s70
    v_and_b32 v7, 7, v2
    v_lshl_add_u32 v212, v7, 4, v212
    s_lshl_b32 s74, s70, 3
    s_cmp_ge_u32 s85, 324
    s_cbranch_scc1 K2_rlb0
    s_add_u32 s41, s55, 4096
    s_mov_b32 m0, s41
    s_nop 0
    buffer_load_dwordx4 v212, s[76:79], s69 offen lds
    s_add_u32 s69, s69, s74
K2_rlb0:
    v_mfma_f32_32x32x8_bf16 v[124:139], v[58:59], v[200:201], v[124:139]
    v_exp_f32 v149, v149
    v_exp_f32 v150, v150
    v_exp_f32 v151, v151
    v_exp_f32 v152, v152
    v_exp_f32 v153, v153
    v_exp_f32 v154, v154
    s_waitcnt vmcnt(4)
    v_mfma_f32_32x32x16_bf16 v[164:179], v[100:103], v[156:159], v[164:179]
    v_exp_f32 v155, v155
    v_cvt_pk_bf16_f32 v160, v148, v149
    v_cvt_pk_bf16_f32 v161, v150, v151
    v_cvt_pk_bf16_f32 v162, v152, v153
    v_cvt_pk_bf16_f32 v163, v154, v155
    s_setprio 2
    v_exp_f32 v124, v124
    v_exp_f32 v125, v125
    v_mfma_f32_32x32x16_bf16 v[164:179], v[104:107], v[160:163], v[164:179]
    v_exp_f32 v126, v126
    v_exp_f32 v127, v127
    v_exp_f32 v128, v128
    v_exp_f32 v129, v129
    v_exp_f32 v130, v130
    s_waitcnt vmcnt(8)
    v_mfma_f32_32x32x16_bf16 v[140:155], v[48:51], v[196:199], 0
    v_exp_f32 v131, v131
    v_cvt_pk_bf16_f32 v156, v124, v125
    v_cvt_pk_bf16_f32 v157, v126, v127
    v_cvt_pk_bf16_f32 v158, v128, v129
    v_cvt_pk_bf16_f32 v159, v130, v131
    v_exp_f32 v132, v132
    v_lshrrev_b32 v6, 3, v2
    v_mul_lo_u32 v6, v6, s58
    v_and_b32 v7, 7, v2
    v_lshl_add_u32 v6, v7, 4, v6
    s_lshl_b32 s62, s58, 3
    s_add_u32 s41, s55, 0
    s_mov_b32 m0, s41
    s_nop 0
    buffer_load_dwordx4 v6, s[64:67], s57 offen lds
    s_add_u32 s57, s57, s62
    v_mfma_f32_32x32x8_bf16 v[140:155], v[58:59], v[202:203], v[140:155]
    v_exp_f32 v133, v133
    v_exp_f32 v134, v134
    v_exp_f32 v135, v135
    v_exp_f32 v136, v136
    v_exp_f32 v137, v137
    v_exp_f32 v138, v138
    s_waitcnt vmcnt(3)
    v_mfma_f32_32x32x16_bf16 v[164:179], v[108:111], v[156:159], v[164:179]
    v_exp_f32 v139, v139
    v_cvt_pk_bf16_f32 v160, v132, v133
    v_cvt_pk_bf16_f32 v161, v134, v135
    v_cvt_pk_bf16_f32 v162, v136, v137
    v_cvt_pk_bf16_f32 v163, v138, v139
    v_exp_f32 v140, v140
    v_exp_f32 v141, v141
    v_mfma_f32_32x32x16_bf16 v[164:179], v[112:115], v[160:163], v[164:179]
    v_exp_f32 v142, v142
    v_exp_f32 v143, v143
    v_exp_f32 v144, v144
    v_exp_f32 v145, v145
    v_exp_f32 v146, v146
    s_waitcnt lgkmcnt(0)
    v_mfma_f32_32x32x16_bf16 v[124:139], v[20:23], v[204:207], 0
    v_exp_f32 v147, v147
    v_cvt_pk_bf16_f32 v156, v140, v141
    v_cvt_pk_bf16_f32 v157, v142, v143
    v_cvt_pk_bf16_f32 v158, v144, v145
    v_cvt_pk_bf16_f32 v159, v146, v147
    v_exp_f32 v148, v148
    s_cmp_ge_u32 s85, 324
    s_cbranch_scc1 K2_rlb1
    s_add_u32 s41, s55, 5120
    s_mov_b32 m0, s41
    s_nop 0
    buffer_load_dwordx4 v212, s[76:79], s69 offen lds
    s_add_u32 s69, s69, s74
K2_rlb1:
    v_mfma_f32_32x32x8_bf16 v[124:139], v[52:53], v[208:209], v[124:139]
    v_exp_f32 v149, v149
    v_exp_f32 v150, v150
    v_exp_f32 v151, v151
    v_exp_f32 v152, v152
    v_exp_f32 v153, v153
    v_exp_f32 v154, v154
    s_waitcnt vmcnt(1)
    v_mfma_f32_32x32x16_bf16 v[164:179], v[116:119], v[156:159], v[164:179]
    v_exp_f32 v155, v155
    v_cvt_pk_bf16_f32 v160, v148, v149
    v_cvt_pk_bf16_f32 v161, v150, v151
    v_cvt_pk_bf16_f32 v162, v152, v153
    v_cvt_pk_bf16_f32 v163, v154, v155
    s_setprio 0
    v_exp_f32 v124, v124
    v_exp_f32 v125, v125
    v_mfma_f32_32x32x16_bf16 v[164:179], v[120:123], v[160:163], v[164:179]
    v_exp_f32 v126, v126
    v_exp_f32 v127, v127
    v_exp_f32 v128, v128
    v_exp_f32 v129, v129
    v_exp_f32 v130, v130
    v_mfma_f32_32x32x16_bf16 v[140:155], v[24:27], v[204:207], 0
    v_exp_f32 v131, v131
    v_cvt_pk_bf16_f32 v156, v124, v125
    s_add_u32 s41, s55, 1024
    s_mov_b32 m0, s41
    s_nop 0
    buffer_load_dwordx4 v6, s[64:67], s57 offen lds
    s_add_u32 s57, s57, s62
    v_cvt_pk_bf16_f32 v157, v126, v127
    v_cvt_pk_bf16_f32 v158, v128, v129
    v_cvt_pk_bf16_f32 v159, v130, v131
    v_exp_f32 v132, v132
    v_mfma_f32_32x32x8_bf16 v[140:155], v[52:53], v[210:211], v[140:155]
    v_exp_f32 v133, v133
    ds_write_b128 v16, v[164:167] offset:0
    v_exp_f32 v134, v134
    v_exp_f32 v135, v135
    s_lshr_b32 s17, s2, 3
    s_add_u32 s43, s17, s2
    s_and_b32 s43, s43, 7
    s_lshl_b32 s43, s43, 1
    s_add_u32 s43, s43, s53
    s_lshl_b32 s43, s43, 10
    s_mul_i32 s17, s17, 36
    s_add_u32 s17, s17, s52
    s_lshl_b32 s17, s17, 14
    s_add_u32 s43, s43, s17
    s_add_u32 s43, s43, 16179200
    v_exp_f32 v136, v136
    v_exp_f32 v137, v137
    ds_write_b128 v16, v[168:171] offset:1024
    v_exp_f32 v138, v138
    v_mfma_f32_32x32x16_bf16 v[180:195], v[60:63], v[156:159], 0
    v_exp_f32 v139, v139
    v_cvt_pk_bf16_f32 v160, v132, v133
    ds_write_b64 v17, v[172:173] offset:2048
    v_cvt_pk_bf16_f32 v161, v134, v135
    s_mov_b64 exec, 1
    ds_add_u32 v8, v9 offset:22144
    s_mov_b64 exec, -1
    v_cvt_pk_bf16_f32 v162, v136, v137
    v_cvt_pk_bf16_f32 v163, v138, v139
    s_setprio 3
    v_exp_f32 v140, v140
    v_exp_f32 v141, v141
    v_mfma_f32_32x32x16_bf16 v[180:195], v[64:67], v[160:163], v[180:195]
    v_exp_f32 v142, v142
    v_exp_f32 v143, v143
    v_exp_f32 v144, v144
    v_exp_f32 v145, v145
    v_exp_f32 v146, v146
    v_mfma_f32_32x32x16_bf16 v[124:139], v[28:31], v[204:207], 0
    v_exp_f32 v147, v147
    v_cvt_pk_bf16_f32 v156, v140, v141
    v_cvt_pk_bf16_f32 v157, v142, v143
    v_cvt_pk_bf16_f32 v158, v144, v145
    v_cvt_pk_bf16_f32 v159, v146, v147
    v_exp_f32 v148, v148
    v_mfma_f32_32x32x8_bf16 v[124:139], v[54:55], v[208:209], v[124:139]
    v_exp_f32 v149, v149
    v_exp_f32 v150, v150
    v_exp_f32 v151, v151
    v_exp_f32 v152, v152
    v_exp_f32 v153, v153
    v_exp_f32 v154, v154
    v_mfma_f32_32x32x16_bf16 v[180:195], v[68:71], v[156:159], v[180:195]
    v_exp_f32 v155, v155
    v_cvt_pk_bf16_f32 v160, v148, v149
    v_cvt_pk_bf16_f32 v161, v150, v151
    v_cvt_pk_bf16_f32 v162, v152, v153
    v_cvt_pk_bf16_f32 v163, v154, v155
    v_exp_f32 v124, v124
    ds_read_b32 v179, v8 offset:22144
    v_exp_f32 v125, v125
    v_mfma_f32_32x32x16_bf16 v[180:195], v[72:75], v[160:163], v[180:195]
    v_exp_f32 v126, v126
    v_exp_f32 v127, v127
    v_exp_f32 v128, v128
    v_exp_f32 v129, v129
    v_exp_f32 v130, v130
    v_mfma_f32_32x32x16_bf16 v[140:155], v[32:35], v[204:207], 0
    v_exp_f32 v131, v131
    v_cvt_pk_bf16_f32 v156, v124, v125
    v_cvt_pk_bf16_f32 v157, v126, v127
    v_cvt_pk_bf16_f32 v158, v128, v129
    v_cvt_pk_bf16_f32 v159, v130, v131
    v_exp_f32 v132, v132
    s_cmp_lg_u32 s53, 0
    s_cbranch_scc1 K2_e2a0
    s_waitcnt lgkmcnt(0)
K2_cp0:
    v_readfirstlane_b32 s41, v179
    s_cmp_ge_u32 s41, 98304
    s_cbranch_scc1 K2_kp0
    s_sleep 2
    ds_read_b32 v179, v8 offset:22144
    s_waitcnt lgkmcnt(0)
    s_branch K2_cp0
K2_kp0:
    ds_read_b64 v[164:165], v18 offset:0
    ds_read_b64 v[166:167], v19 offset:2048
    ds_read_b64 v[168:169], v18 offset:2560
    ds_read_b64 v[170:171], v19 offset:4608
    ds_read_b64 v[172:173], v18 offset:5120
    ds_read_b64 v[174:175], v19 offset:7168
    ds_read_b64 v[176:177], v18 offset:7680
    ds_read_b64 v[178:179], v19 offset:9728
K2_e2a0:
    s_cmp_ge_u32 s85, 324
    s_cbranch_scc1 K2_rlb2
    s_add_u32 s41, s55, 6144
    s_mov_b32 m0, s41
    s_nop 0
    buffer_load_dwordx4 v212, s[76:79], s69 offen lds
    s_add_u32 s69, s69, s74
K2_rlb2:
    v_mfma_f32_32x32x8_bf16 v[140:155], v[54:55], v[210:211], v[140:155]
    v_exp_f32 v133, v133
    v_exp_f32 v134, v134
    v_exp_f32 v135, v135
    v_exp_f32 v136, v136
    v_exp_f32 v137, v137
    v_exp_f32 v138, v138
    v_mfma_f32_32x32x16_bf16 v[180:195], v[76:79], v[156:159], v[180:195]
    v_exp_f32 v139, v139
    v_cvt_pk_bf16_f32 v160, v132, v133
    v_cvt_pk_bf16_f32 v161, v134, v135
    v_cvt_pk_bf16_f32 v162, v136, v137
    v_cvt_pk_bf16_f32 v163, v138, v139
    v_exp_f32 v140, v140
    v_exp_f32 v141, v141
    v_mfma_f32_32x32x16_bf16 v[180:195], v[80:83], v[160:163], v[180:195]
    v_exp_f32 v142, v142
    v_exp_f32 v143, v143
    v_exp_f32 v144, v144
    v_exp_f32 v145, v145
    v_exp_f32 v146, v146
    v_mfma_f32_32x32x16_bf16 v[124:139], v[36:39], v[204:207], 0
    v_exp_f32 v147, v147
    s_cmp_lg_u32 s53, 0
    s_cbranch_scc1 K2_e2b0
    s_waitcnt lgkmcnt(0)
    v_pk_add_f32 v[164:165], v[164:165], v[168:169]
    v_pk_add_f32 v[172:173], v[172:173], v[176:177]
    v_pk_add_f32 v[166:167], v[166:167], v[170:171]
    v_pk_add_f32 v[174:175], v[174:175], v[178:179]
    v_pk_add_f32 v[10:11], v[164:165], v[172:173]
    v_pk_add_f32 v[12:13], v[166:167], v[174:175]
    ds_read_b64 v[164:165], v18 offset:10240
    ds_read_b64 v[166:167], v19 offset:12288
    ds_read_b64 v[168:169], v18 offset:12800
    ds_read_b64 v[170:171], v19 offset:14848
    ds_read_b64 v[172:173], v18 offset:15360
    ds_read_b64 v[174:175], v19 offset:17408
    ds_read_b64 v[176:177], v18 offset:17920
    ds_read_b64 v[178:179], v19 offset:19968
K2_e2b0:
    v_cvt_pk_bf16_f32 v156, v140, v141
    v_cvt_pk_bf16_f32 v157, v142, v143
    v_cvt_pk_bf16_f32 v158, v144, v145
    v_cvt_pk_bf16_f32 v159, v146, v147
    v_exp_f32 v148, v148
    s_add_u32 s41, s55, 2048
    s_mov_b32 m0, s41
    s_nop 0
    buffer_load_dwordx4 v6, s[64:67], s57 offen lds
    s_add_u32 s57, s57, s62
    v_mfma_f32_32x32x8_bf16 v[124:139], v[56:57], v[208:209], v[124:139]
    v_exp_f32 v149, v149
    v_exp_f32 v150, v150
    v_exp_f32 v151, v151
    v_exp_f32 v152, v152
    v_exp_f32 v153, v153
    v_exp_f32 v154, v154
    v_mfma_f32_32x32x16_bf16 v[180:195], v[84:87], v[156:159], v[180:195]
    v_exp_f32 v155, v155
    v_cvt_pk_bf16_f32 v160, v148, v149
    v_cvt_pk_bf16_f32 v161, v150, v151
    v_cvt_pk_bf16_f32 v162, v152, v153
    v_cvt_pk_bf16_f32 v163, v154, v155
    s_setprio 2
    v_exp_f32 v124, v124
    v_exp_f32 v125, v125
    v_mfma_f32_32x32x16_bf16 v[180:195], v[88:91], v[160:163], v[180:195]
    ds_read_b128 v[196:199], v3 offset:3072
    ds_read2st64_b32 v[200:201], v8 offset0:16 offset1:17
    ds_read2st64_b32 v[202:203], v8 offset0:17 offset1:16
    v_exp_f32 v126, v126
    s_cmp_lg_u32 s53, 0
    s_cbranch_scc1 K2_e2c0
    s_waitcnt lgkmcnt(0)
    v_pk_add_f32 v[166:167], v[166:167], v[170:171]
    v_pk_add_f32 v[174:175], v[174:175], v[178:179]
    v_pk_add_f32 v[12:13], v[12:13], v[166:167]
    v_pk_add_f32 v[12:13], v[12:13], v[174:175]
    v_rcp_f32 v170, v13
    v_pk_add_f32 v[164:165], v[164:165], v[168:169]
    v_pk_add_f32 v[172:173], v[172:173], v[176:177]
    v_pk_add_f32 v[10:11], v[10:11], v[164:165]
    v_pk_add_f32 v[10:11], v[10:11], v[172:173]
    v_subrev_u32 v171, 0x21800000, v13
    v_pk_mul_f32 v[10:11], v[10:11], v[170:171] op_sel_hi:[1,0]
    v_cmp_lt_u32 vcc, 1006632960, v171
    v_mul_f32 v12, v170, v12
    v_cvt_pk_bf16_f32 v10, v10, v11
    v_cvt_pk_bf16_f32 v12, v12, v12
    ds_write_b32 v1, v10 offset:12288
    ds_write_b16 v14, v12 offset:0
    s_or_b32 s23, s23, vcc_lo
    s_or_b32 s23, s23, vcc_hi
    s_mov_b64 exec, 1
    ds_add_u32 v8, v9 offset:22176
    s_mov_b64 exec, -1
K2_e2c0:
    v_exp_f32 v127, v127
    v_exp_f32 v128, v128
    v_exp_f32 v129, v129
    v_exp_f32 v130, v130
    v_mfma_f32_32x32x16_bf16 v[140:155], v[40:43], v[204:207], 0
    v_exp_f32 v131, v131
    v_cvt_pk_bf16_f32 v156, v124, v125
    v_cvt_pk_bf16_f32 v157, v126, v127
    v_cvt_pk_bf16_f32 v158, v128, v129
    v_cvt_pk_bf16_f32 v159, v130, v131
    v_exp_f32 v132, v132
    s_cmp_ge_u32 s85, 324
    s_cbranch_scc1 K2_rlb3
    s_add_u32 s41, s55, 7168
    s_mov_b32 m0, s41
    s_nop 0
    buffer_load_dwordx4 v212, s[76:79], s69 offen lds
    s_add_u32 s69, s69, s74
K2_rlb3:
    v_mfma_f32_32x32x8_bf16 v[140:155], v[56:57], v[210:211], v[140:155]
    v_exp_f32 v133, v133
    v_exp_f32 v134, v134
    v_exp_f32 v135, v135
    v_exp_f32 v136, v136
    v_exp_f32 v137, v137
    v_exp_f32 v138, v138
    v_mfma_f32_32x32x16_bf16 v[180:195], v[92:95], v[156:159], v[180:195]
    v_exp_f32 v139, v139
    v_cvt_pk_bf16_f32 v160, v132, v133
    v_cvt_pk_bf16_f32 v161, v134, v135
    v_cvt_pk_bf16_f32 v162, v136, v137
    v_cvt_pk_bf16_f32 v163, v138, v139
    v_exp_f32 v140, v140
    v_exp_f32 v141, v141
    v_mfma_f32_32x32x16_bf16 v[180:195], v[96:99], v[160:163], v[180:195]
    v_exp_f32 v142, v142
    v_exp_f32 v143, v143
    v_exp_f32 v144, v144
    v_exp_f32 v145, v145
    v_exp_f32 v146, v146
    v_mfma_f32_32x32x16_bf16 v[124:139], v[44:47], v[204:207], 0
    v_exp_f32 v147, v147
    v_cvt_pk_bf16_f32 v156, v140, v141
    v_cvt_pk_bf16_f32 v157, v142, v143
    v_cvt_pk_bf16_f32 v158, v144, v145
    v_cvt_pk_bf16_f32 v159, v146, v147
    v_exp_f32 v148, v148
    s_add_u32 s41, s55, 3072
    s_mov_b32 m0, s41
    s_nop 0
    buffer_load_dwordx4 v6, s[64:67], s57 offen lds
    s_add_u32 s57, s57, s62
    v_mfma_f32_32x32x8_bf16 v[124:139], v[58:59], v[208:209], v[124:139]
    v_exp_f32 v149, v149
    v_exp_f32 v150, v150
    v_exp_f32 v151, v151
    v_exp_f32 v152, v152
    v_exp_f32 v153, v153
    v_exp_f32 v154, v154
    v_mfma_f32_32x32x16_bf16 v[180:195], v[100:103], v[156:159], v[180:195]
    v_exp_f32 v155, v155
    v_cvt_pk_bf16_f32 v160, v148, v149
    v_cvt_pk_bf16_f32 v161, v150, v151
    v_cvt_pk_bf16_f32 v162, v152, v153
    v_cvt_pk_bf16_f32 v163, v154, v155
    s_setprio 1
    v_exp_f32 v124, v124
    v_exp_f32 v125, v125
    v_mfma_f32_32x32x16_bf16 v[180:195], v[104:107], v[160:163], v[180:195]
    v_exp_f32 v126, v126
    v_exp_f32 v127, v127
    v_exp_f32 v128, v128
    v_exp_f32 v129, v129
    v_exp_f32 v130, v130
    v_mfma_f32_32x32x16_bf16 v[140:155], v[48:51], v[204:207], 0
    v_exp_f32 v131, v131
    v_cvt_pk_bf16_f32 v156, v124, v125
    v_cvt_pk_bf16_f32 v157, v126, v127
    v_cvt_pk_bf16_f32 v158, v128, v129
    v_cvt_pk_bf16_f32 v159, v130, v131
    v_exp_f32 v132, v132
    v_mfma_f32_32x32x8_bf16 v[140:155], v[58:59], v[210:211], v[140:155]
    v_exp_f32 v133, v133
    v_exp_f32 v134, v134
    v_exp_f32 v135, v135
    v_exp_f32 v136, v136
    v_exp_f32 v137, v137
    v_exp_f32 v138, v138
    v_mfma_f32_32x32x16_bf16 v[180:195], v[108:111], v[156:159], v[180:195]
    v_exp_f32 v139, v139
    v_cvt_pk_bf16_f32 v160, v132, v133
    v_cvt_pk_bf16_f32 v161, v134, v135
    v_cvt_pk_bf16_f32 v162, v136, v137
    v_cvt_pk_bf16_f32 v163, v138, v139
    v_exp_f32 v140, v140
    v_exp_f32 v141, v141
    v_mfma_f32_32x32x16_bf16 v[180:195], v[112:115], v[160:163], v[180:195]
    v_and_b32 v7, 3, v2
    v_lshrrev_b32 v2, 2, v2
    v_lshlrev_b32 v2, 7, v2
    v_lshl_add_u32 v2, v7, 3, v2
    v_add_u32 v2, s55, v2
    v_exp_f32 v142, v142
    v_exp_f32 v143, v143
    v_exp_f32 v144, v144
    v_exp_f32 v145, v145
    v_exp_f32 v146, v146
    s_waitcnt lgkmcnt(0)
    v_mfma_f32_32x32x16_bf16 v[124:139], v[20:23], v[196:199], 0
    v_exp_f32 v147, v147
    v_cvt_pk_bf16_f32 v156, v140, v141
    v_cvt_pk_bf16_f32 v157, v142, v143
    v_cvt_pk_bf16_f32 v158, v144, v145
    v_cvt_pk_bf16_f32 v159, v146, v147
    v_exp_f32 v148, v148
    s_andn2_b32 s41, s2, 7
    s_add_u32 s41, s41, s3
    s_mul_i32 s41, s41, 2624
    s_add_u32 s41, s41, 0
    s_add_u32 s42, s55, 9216
    s_mov_b32 m0, s42
    s_nop 0
    buffer_load_dwordx4 v3, s[32:35], s41 offen lds
    v_mfma_f32_32x32x8_bf16 v[124:139], v[52:53], v[200:201], v[124:139]
    v_exp_f32 v149, v149
    v_exp_f32 v150, v150
    v_exp_f32 v151, v151
    v_exp_f32 v152, v152
    v_exp_f32 v153, v153
    v_exp_f32 v154, v154
    v_mfma_f32_32x32x16_bf16 v[180:195], v[116:119], v[156:159], v[180:195]
    v_exp_f32 v155, v155
    v_cvt_pk_bf16_f32 v160, v148, v149
    v_cvt_pk_bf16_f32 v161, v150, v151
    v_cvt_pk_bf16_f32 v162, v152, v153
    v_cvt_pk_bf16_f32 v163, v154, v155
    s_setprio 0
    v_exp_f32 v124, v124
    v_exp_f32 v125, v125
    v_mfma_f32_32x32x16_bf16 v[180:195], v[120:123], v[160:163], v[180:195]
    s_andn2_b32 s41, s2, 7
    s_add_u32 s41, s41, s3
    s_mul_i32 s41, s41, 2624
    s_add_u32 s41, s41, 1024
    s_add_u32 s42, s55, 9216
    s_mov_b32 m0, s42
    s_nop 0
    buffer_load_dwordx4 v3, s[32:35], s41 offen lds
    v_exp_f32 v126, v126
    v_exp_f32 v127, v127
    v_exp_f32 v128, v128
    v_exp_f32 v129, v129
    v_exp_f32 v130, v130
    v_mfma_f32_32x32x16_bf16 v[140:155], v[24:27], v[196:199], 0
    v_exp_f32 v131, v131
    v_cvt_pk_bf16_f32 v156, v124, v125
    v_cvt_pk_bf16_f32 v157, v126, v127
    v_cvt_pk_bf16_f32 v158, v128, v129
    v_cvt_pk_bf16_f32 v159, v130, v131
    v_exp_f32 v132, v132
    v_mov_b32 v4, 2139062143
    v_mov_b32 v5, 2139062143
    v_mov_b32 v6, 2139062143
    v_mov_b32 v7, 2139062143
    v_mfma_f32_32x32x8_bf16 v[140:155], v[52:53], v[202:203], v[140:155]
    v_exp_f32 v133, v133
    ds_write_b128 v16, v[180:183] offset:20480
    v_exp_f32 v134, v134
    v_exp_f32 v135, v135
    v_exp_f32 v136, v136
    v_exp_f32 v137, v137
    ds_write_b128 v16, v[184:187] offset:21504
    v_exp_f32 v138, v138
    v_mfma_f32_32x32x16_bf16 v[164:179], v[60:63], v[156:159], 0
    v_exp_f32 v139, v139
    v_cvt_pk_bf16_f32 v160, v132, v133
    ds_write_b64 v17, v[188:189] offset:22528
    v_cvt_pk_bf16_f32 v161, v134, v135
    s_mov_b64 exec, 1
    ds_add_u32 v8, v9 offset:22148
    s_mov_b64 exec, -1
    v_cvt_pk_bf16_f32 v162, v136, v137
    v_cvt_pk_bf16_f32 v163, v138, v139
    s_setprio 3
    v_exp_f32 v140, v140
    v_exp_f32 v141, v141
    v_mfma_f32_32x32x16_bf16 v[164:179], v[64:67], v[160:163], v[164:179]
    s_andn2_b32 s41, s2, 7
    s_add_u32 s41, s41, s3
    s_mul_i32 s41, s41, 2624
    s_add_u32 s41, s41, 2048
    s_add_u32 s42, s55, 9216
    s_mov_b32 m0, s42
    s_nop 0
    buffer_load_dwordx4 v3, s[32:35], s41 offen lds
    v_exp_f32 v142, v142
    v_exp_f32 v143, v143
    v_exp_f32 v144, v144
    v_exp_f32 v145, v145
    v_exp_f32 v146, v146
    v_mfma_f32_32x32x16_bf16 v[124:139], v[28:31], v[196:199], 0
    v_exp_f32 v147, v147
    v_cvt_pk_bf16_f32 v156, v140, v141
    v_cvt_pk_bf16_f32 v157, v142, v143
    v_cvt_pk_bf16_f32 v158, v144, v145
    v_cvt_pk_bf16_f32 v159, v146, v147
    v_exp_f32 v148, v148
    v_mfma_f32_32x32x8_bf16 v[124:139], v[54:55], v[200:201], v[124:139]
    v_exp_f32 v149, v149
    v_exp_f32 v150, v150
    v_exp_f32 v151, v151
    v_exp_f32 v152, v152
    v_exp_f32 v153, v153
    v_exp_f32 v154, v154
    v_mfma_f32_32x32x16_bf16 v[164:179], v[68:71], v[156:159], v[164:179]
    v_exp_f32 v155, v155
    v_cvt_pk_bf16_f32 v160, v148, v149
    v_cvt_pk_bf16_f32 v161, v150, v151
    v_cvt_pk_bf16_f32 v162, v152, v153
    v_cvt_pk_bf16_f32 v163, v154, v155
    v_exp_f32 v124, v124
    ds_read_b32 v195, v8 offset:22148
    v_exp_f32 v125, v125
    v_mfma_f32_32x32x16_bf16 v[164:179], v[72:75], v[160:163], v[164:179]
    v_exp_f32 v126, v126
    v_exp_f32 v127, v127
    v_exp_f32 v128, v128
    v_exp_f32 v129, v129
    v_exp_f32 v130, v130
    v_mfma_f32_32x32x16_bf16 v[140:155], v[32:35], v[196:199], 0
    v_exp_f32 v131, v131
    v_cvt_pk_bf16_f32 v156, v124, v125
    v_cvt_pk_bf16_f32 v157, v126, v127
    v_cvt_pk_bf16_f32 v158, v128, v129
    v_cvt_pk_bf16_f32 v159, v130, v131
    v_exp_f32 v132, v132
    s_cmp_lg_u32 s53, 1
    s_cbranch_scc1 K2_e2a1
    s_waitcnt lgkmcnt(0)
K2_cp1:
    v_readfirstlane_b32 s41, v195
    s_cmp_ge_u32 s41, 98304
    s_cbranch_scc1 K2_kp1
    s_sleep 2
    ds_read_b32 v195, v8 offset:22148
    s_waitcnt lgkmcnt(0)
    s_branch K2_cp1
K2_kp1:
    ds_read_b64 v[180:181], v18 offset:20480
    ds_read_b64 v[182:183], v19 offset:22528
    ds_read_b64 v[184:185], v18 offset:23040
    ds_read_b64 v[186:187], v19 offset:25088
    ds_read_b64 v[188:189], v18 offset:25600
    ds_read_b64 v[190:191], v19 offset:27648
    ds_read_b64 v[192:193], v18 offset:28160
    ds_read_b64 v[194:195], v19 offset:30208
K2_e2a1:
    v_mfma_f32_32x32x8_bf16 v[140:155], v[54:55], v[202:203], v[140:155]
    v_exp_f32 v133, v133
    v_exp_f32 v134, v134
    v_exp_f32 v135, v135
    v_exp_f32 v136, v136
    v_exp_f32 v137, v137
    v_exp_f32 v138, v138
    v_mfma_f32_32x32x16_bf16 v[164:179], v[76:79], v[156:159], v[164:179]
    v_exp_f32 v139, v139
    v_cvt_pk_bf16_f32 v160, v132, v133
    v_cvt_pk_bf16_f32 v161, v134, v135
    v_cvt_pk_bf16_f32 v162, v136, v137
    v_cvt_pk_bf16_f32 v163, v138, v139
    v_exp_f32 v140, v140
    v_exp_f32 v141, v141
    v_mfma_f32_32x32x16_bf16 v[164:179], v[80:83], v[160:163], v[164:179]
    s_waitcnt vmcnt(3)
    v_exp_f32 v142, v142
    v_exp_f32 v143, v143
    v_exp_f32 v144, v144
    v_exp_f32 v145, v145
    v_exp_f32 v146, v146
    v_mfma_f32_32x32x16_bf16 v[124:139], v[36:39], v[196:199], 0
    v_exp_f32 v147, v147
    s_cmp_lg_u32 s53, 1
    s_cbranch_scc1 K2_e2b1
    s_waitcnt lgkmcnt(0)
    v_pk_add_f32 v[180:181], v[180:181], v[184:185]
    v_pk_add_f32 v[188:189], v[188:189], v[192:193]
    v_pk_add_f32 v[182:183], v[182:183], v[186:187]
    v_pk_add_f32 v[190:191], v[190:191], v[194:195]
    v_pk_add_f32 v[10:11], v[180:181], v[188:189]
    v_pk_add_f32 v[12:13], v[182:183], v[190:191]
    ds_read_b64 v[180:181], v18 offset:30720
    ds_read_b64 v[182:183], v19 offset:32768
    ds_read_b64 v[184:185], v18 offset:33280
    ds_read_b64 v[186:187], v19 offset:35328
    ds_read_b64 v[188:189], v18 offset:35840
    ds_read_b64 v[190:191], v19 offset:37888
    ds_read_b64 v[192:193], v18 offset:38400
    ds_read_b64 v[194:195], v19 offset:40448
K2_e2b1:
    v_cvt_pk_bf16_f32 v156, v140, v141
    v_cvt_pk_bf16_f32 v157, v142, v143
    v_cvt_pk_bf16_f32 v158, v144, v145
    v_cvt_pk_bf16_f32 v159, v146, v147
    v_exp_f32 v148, v148
    s_cmp_ge_u32 s85, 324
    s_cbranch_scc1 K2_rlr
    ds_read_b64_tr_b16 v[216:217], v2 offset:4096
    ds_read_b64_tr_b16 v[218:219], v2 offset:6144
    ds_read_b64_tr_b16 v[220:221], v2 offset:4128
    ds_read_b64_tr_b16 v[222:223], v2 offset:6176
    ds_read_b64_tr_b16 v[224:225], v2 offset:4160
    ds_read_b64_tr_b16 v[226:227], v2 offset:6208
    ds_read_b64_tr_b16 v[228:229], v2 offset:4192
    ds_read_b64_tr_b16 v[230:231], v2 offset:6240
K2_rlr:
    v_mfma_f32_32x32x8_bf16 v[124:139], v[56:57], v[200:201], v[124:139]
    v_exp_f32 v149, v149
    v_exp_f32 v150, v150
    v_exp_f32 v151, v151
    v_exp_f32 v152, v152
    v_exp_f32 v153, v153
    v_exp_f32 v154, v154
    v_mfma_f32_32x32x16_bf16 v[164:179], v[84:87], v[156:159], v[164:179]
    v_exp_f32 v155, v155
    v_cvt_pk_bf16_f32 v160, v148, v149
    v_cvt_pk_bf16_f32 v161, v150, v151
    v_cvt_pk_bf16_f32 v162, v152, v153
    v_cvt_pk_bf16_f32 v163, v154, v155
    s_setprio 2
    v_exp_f32 v124, v124
    s_add_u32 s41, s40, 589824
    buffer_load_dwordx4 v[248:251], v3, s[32:35], s41 offen
    v_exp_f32 v125, v125
    v_mfma_f32_32x32x16_bf16 v[164:179], v[88:91], v[160:163], v[164:179]
    ds_read_b128 v[204:207], v3 offset:4608
    ds_read2st64_b32 v[208:209], v8 offset0:22 offset1:23
    ds_read2st64_b32 v[210:211], v8 offset0:23 offset1:22
    v_exp_f32 v126, v126
    s_cmp_lg_u32 s53, 1
    s_cbranch_scc1 K2_e2c1
    s_waitcnt lgkmcnt(0)
    v_pk_add_f32 v[182:183], v[182:183], v[186:187]
    v_pk_add_f32 v[190:191], v[190:191], v[194:195]
    v_pk_add_f32 v[12:13], v[12:13], v[182:183]
    v_pk_add_f32 v[12:13], v[12:13], v[190:191]
    v_rcp_f32 v186, v13
    v_pk_add_f32 v[180:181], v[180:181], v[184:185]
    v_pk_add_f32 v[188:189], v[188:189], v[192:193]
    v_pk_add_f32 v[10:11], v[10:11], v[180:181]
    v_pk_add_f32 v[10:11], v[10:11], v[188:189]
    v_subrev_u32 v187, 0x21800000, v13
    v_pk_mul_f32 v[10:11], v[10:11], v[186:187] op_sel_hi:[1,0]
    v_cmp_lt_u32 vcc, 1006632960, v187
    v_mul_f32 v12, v186, v12
    v_cvt_pk_bf16_f32 v10, v10, v11
    v_cvt_pk_bf16_f32 v12, v12, v12
    ds_write_b32 v1, v10 offset:13312
    ds_write_b16 v14, v12 offset:128
    s_or_b32 s23, s23, vcc_lo
    s_or_b32 s23, s23, vcc_hi
    s_mov_b64 exec, 1
    ds_add_u32 v8, v9 offset:22180
    s_mov_b64 exec, -1
K2_e2c1:
    v_exp_f32 v127, v127
    v_exp_f32 v128, v128
    s_add_u32 s41, s40, 0
    buffer_load_dwordx4 v[232:235], v3, s[32:35], s41 offen
    v_exp_f32 v129, v129
    v_exp_f32 v130, v130
    v_mfma_f32_32x32x16_bf16 v[140:155], v[40:43], v[196:199], 0
    v_exp_f32 v131, v131
    v_cvt_pk_bf16_f32 v156, v124, v125
    s_add_u32 s41, s40, 147456
    buffer_load_dwordx4 v[236:239], v3, s[32:35], s41 offen
    v_cvt_pk_bf16_f32 v157, v126, v127
    v_cvt_pk_bf16_f32 v158, v128, v129
    v_cvt_pk_bf16_f32 v159, v130, v131
    v_exp_f32 v132, v132
    v_mfma_f32_32x32x8_bf16 v[140:155], v[56:57], v[202:203], v[140:155]
    s_add_u32 s41, s40, 294912
    buffer_load_dwordx4 v[240:243], v3, s[32:35], s41 offen
    v_exp_f32 v133, v133
    v_exp_f32 v134, v134
    v_exp_f32 v135, v135
    v_exp_f32 v136, v136
    v_exp_f32 v137, v137
    s_add_u32 s41, s40, 442368
    buffer_load_dwordx4 v[244:247], v3, s[32:35], s41 offen
    v_exp_f32 v138, v138
    v_mfma_f32_32x32x16_bf16 v[164:179], v[92:95], v[156:159], v[164:179]
    v_exp_f32 v139, v139
    v_cvt_pk_bf16_f32 v160, v132, v133
    v_cvt_pk_bf16_f32 v161, v134, v135
    v_cvt_pk_bf16_f32 v162, v136, v137
    v_cvt_pk_bf16_f32 v163, v138, v139
    v_exp_f32 v140, v140
    v_exp_f32 v141, v141
    v_mfma_f32_32x32x16_bf16 v[164:179], v[96:99], v[160:163], v[164:179]
    s_cmp_ge_u32 s85, 324
    s_cbranch_scc1 K2_rls0
    s_waitcnt lgkmcnt(0)
    buffer_store_dwordx4 v[216:219], v3, s[8:11], s73 offen sc1
    s_add_u32 s73, s73, 18432
K2_rls0:
    v_exp_f32 v142, v142
    v_exp_f32 v143, v143
    v_exp_f32 v144, v144
    v_exp_f32 v145, v145
    v_exp_f32 v146, v146
    v_mfma_f32_32x32x16_bf16 v[124:139], v[44:47], v[196:199], 0
    s_cmp_ge_u32 s85, 324
    s_cbranch_scc1 K2_rls1
    s_waitcnt lgkmcnt(0)
    buffer_store_dwordx4 v[220:223], v3, s[8:11], s73 offen sc1
    s_add_u32 s73, s73, 18432
K2_rls1:
    v_exp_f32 v147, v147
    ds_read_b32 v252, v8 offset:22176
    v_cvt_pk_bf16_f32 v156, v140, v141
    v_cvt_pk_bf16_f32 v157, v142, v143
    v_cvt_pk_bf16_f32 v158, v144, v145
    v_cvt_pk_bf16_f32 v159, v146, v147
    v_exp_f32 v148, v148
    s_cmp_ge_u32 s85, 324
    s_cbranch_scc1 K2_rls2
    s_waitcnt lgkmcnt(0)
    buffer_store_dwordx4 v[224:227], v3, s[8:11], s73 offen sc1
    s_add_u32 s73, s73, 18432
K2_rls2:
    v_mfma_f32_32x32x8_bf16 v[124:139], v[58:59], v[200:201], v[124:139]
    v_exp_f32 v149, v149
    v_exp_f32 v150, v150
    v_exp_f32 v151, v151
    v_exp_f32 v152, v152
    v_exp_f32 v153, v153
    s_cmp_ge_u32 s85, 324
    s_cbranch_scc1 K2_rls3
    s_waitcnt lgkmcnt(0)
    buffer_store_dwordx4 v[228:231], v3, s[8:11], s73 offen sc1
    s_add_u32 s73, s73, 18432
K2_rls3:
    v_exp_f32 v154, v154
    v_mfma_f32_32x32x16_bf16 v[164:179], v[100:103], v[156:159], v[164:179]
    v_exp_f32 v155, v155
    s_waitcnt lgkmcnt(0)
K2_cr0:
    v_readfirstlane_b32 s41, v252
    s_cmp_ge_u32 s41, 49152
    s_cbranch_scc1 K2_kr0
    s_sleep 2
    ds_read_b32 v252, v8 offset:22176
    s_waitcnt lgkmcnt(0)
    s_branch K2_cr0
K2_kr0:
    ds_read_b128 v[252:255], v9 offset:0
    v_cvt_pk_bf16_f32 v160, v148, v149
    v_cvt_pk_bf16_f32 v161, v150, v151
    v_cvt_pk_bf16_f32 v162, v152, v153
    v_cvt_pk_bf16_f32 v163, v154, v155
    s_setprio 1
    v_exp_f32 v124, v124
    v_exp_f32 v125, v125
    v_mfma_f32_32x32x16_bf16 v[164:179], v[104:107], v[160:163], v[164:179]
    v_exp_f32 v126, v126
    v_exp_f32 v127, v127
    v_exp_f32 v128, v128
    s_waitcnt vmcnt(0) lgkmcnt(0)
    v_mfma_f32_16x16x32_bf16 v[212:215], v[232:235], v[252:255], 0
    v_exp_f32 v129, v129
    v_mfma_f32_16x16x32_bf16 v[216:219], v[236:239], v[252:255], 0
    v_exp_f32 v130, v130
    v_mfma_f32_32x32x16_bf16 v[140:155], v[48:51], v[196:199], 0
    v_exp_f32 v131, v131
    v_cvt_pk_bf16_f32 v156, v124, v125
    v_cvt_pk_bf16_f32 v157, v126, v127
    v_cvt_pk_bf16_f32 v158, v128, v129
    v_mfma_f32_16x16x32_bf16 v[220:223], v[240:243], v[252:255], 0
    v_cvt_pk_bf16_f32 v159, v130, v131
    v_exp_f32 v132, v132
    v_mfma_f32_32x32x8_bf16 v[140:155], v[58:59], v[202:203], v[140:155]
    v_exp_f32 v133, v133
    v_exp_f32 v134, v134
    v_exp_f32 v135, v135
    v_mfma_f32_16x16x32_bf16 v[224:227], v[244:247], v[252:255], 0
    v_exp_f32 v136, v136
    v_mfma_f32_16x16x32_bf16 v[228:231], v[248:251], v[252:255], 0
    v_exp_f32 v137, v137
    v_exp_f32 v138, v138
    v_mfma_f32_32x32x16_bf16 v[164:179], v[108:111], v[156:159], v[164:179]
    v_exp_f32 v139, v139
    v_cvt_pk_bf16_f32 v160, v132, v133
    v_cvt_pk_bf16_f32 v161, v134, v135
    v_cvt_pk_bf16_f32 v162, v136, v137
    v_cvt_pk_bf16_f32 v163, v138, v139
    v_exp_f32 v140, v140
    s_cmp_lg_u32 s53, 0
    s_cbranch_scc1 K2_l4_1
    s_add_u32 s41, s40, 590848
    buffer_load_dwordx4 v[248:251], v3, s[32:35], s41 offen
K2_l4_1:
    v_exp_f32 v141, v141
    v_mfma_f32_32x32x16_bf16 v[164:179], v[112:115], v[160:163], v[164:179]
    v_exp_f32 v142, v142
    v_exp_f32 v143, v143
    v_exp_f32 v144, v144
    s_add_u32 s41, s40, 1024
    buffer_load_dwordx4 v[232:235], v3, s[32:35], s41 offen
    v_exp_f32 v145, v145
    v_exp_f32 v146, v146
    s_waitcnt lgkmcnt(0)
    v_mfma_f32_32x32x16_bf16 v[124:139], v[20:23], v[204:207], 0
    v_exp_f32 v147, v147
    v_cvt_pk_bf16_f32 v156, v140, v141
    s_add_u32 s41, s40, 148480
    buffer_load_dwordx4 v[236:239], v3, s[32:35], s41 offen
    v_cvt_pk_bf16_f32 v157, v142, v143
    v_cvt_pk_bf16_f32 v158, v144, v145
    v_cvt_pk_bf16_f32 v159, v146, v147
    v_exp_f32 v148, v148
    ds_read_b64_tr_b16 v[10:11], v2 offset:0
    ds_read_b64_tr_b16 v[12:13], v2 offset:2048
    v_mfma_f32_32x32x8_bf16 v[124:139], v[52:53], v[208:209], v[124:139]
    s_add_u32 s41, s40, 295936
    buffer_load_dwordx4 v[240:243], v3, s[32:35], s41 offen
    v_exp_f32 v149, v149
    v_exp_f32 v150, v150
    v_exp_f32 v151, v151
    v_exp_f32 v152, v152
    v_exp_f32 v153, v153
    s_add_u32 s41, s40, 443392
    buffer_load_dwordx4 v[244:247], v3, s[32:35], s41 offen
    v_exp_f32 v154, v154
    v_mfma_f32_32x32x16_bf16 v[164:179], v[116:119], v[156:159], v[164:179]
    v_exp_f32 v155, v155
    v_cvt_pk_bf16_f32 v160, v148, v149
    v_cvt_pk_bf16_f32 v161, v150, v151
    v_cvt_pk_bf16_f32 v162, v152, v153
    v_cvt_pk_bf16_f32 v163, v154, v155
    s_setprio 0
    v_exp_f32 v124, v124
    v_exp_f32 v125, v125
    v_mfma_f32_32x32x16_bf16 v[164:179], v[120:123], v[160:163], v[164:179]
    s_waitcnt lgkmcnt(0)
    buffer_store_dwordx4 v[10:13], v3, s[8:11], s61 offen sc1
    s_add_u32 s61, s61, 18432
    v_exp_f32 v126, v126
    v_exp_f32 v127, v127
    v_exp_f32 v128, v128
    v_exp_f32 v129, v129
    v_exp_f32 v130, v130
    v_mfma_f32_32x32x16_bf16 v[140:155], v[24:27], v[204:207], 0
    v_exp_f32 v131, v131
    v_cvt_pk_bf16_f32 v156, v124, v125
    v_cvt_pk_bf16_f32 v157, v126, v127
    v_cvt_pk_bf16_f32 v158, v128, v129
    v_cvt_pk_bf16_f32 v159, v130, v131
    v_exp_f32 v132, v132
    v_mfma_f32_32x32x8_bf16 v[140:155], v[52:53], v[210:211], v[140:155]
    v_exp_f32 v133, v133
    ds_write_b128 v16, v[164:167] offset:0
    v_exp_f32 v134, v134
    v_exp_f32 v135, v135
    v_exp_f32 v136, v136
    v_exp_f32 v137, v137
    ds_write_b128 v16, v[168:171] offset:1024
    v_exp_f32 v138, v138
    v_mfma_f32_32x32x16_bf16 v[180:195], v[60:63], v[156:159], 0
    v_exp_f32 v139, v139
    ds_read_b128 v[252:255], v9 offset:512
    v_cvt_pk_bf16_f32 v160, v132, v133
    ds_write_b64 v17, v[172:173] offset:2048
    v_cvt_pk_bf16_f32 v161, v134, v135
    s_mov_b64 exec, 1
    ds_add_u32 v8, v9 offset:22152
    s_mov_b64 exec, -1
    v_cvt_pk_bf16_f32 v162, v136, v137
    v_cvt_pk_bf16_f32 v163, v138, v139
    s_setprio 3
    v_exp_f32 v140, v140
    v_exp_f32 v141, v141
    v_mfma_f32_32x32x16_bf16 v[180:195], v[64:67], v[160:163], v[180:195]
    v_exp_f32 v142, v142
    v_exp_f32 v143, v143
    v_exp_f32 v144, v144
    s_waitcnt vmcnt(1) lgkmcnt(0)
    v_mfma_f32_16x16x32_bf16 v[212:215], v[232:235], v[252:255], v[212:215]
    v_exp_f32 v145, v145
    v_mfma_f32_16x16x32_bf16 v[216:219], v[236:239], v[252:255], v[216:219]
    v_exp_f32 v146, v146
    v_mfma_f32_32x32x16_bf16 v[124:139], v[28:31], v[204:207], 0
    v_exp_f32 v147, v147
    v_cvt_pk_bf16_f32 v156, v140, v141
    v_cvt_pk_bf16_f32 v157, v142, v143
    v_cvt_pk_bf16_f32 v158, v144, v145
    v_mfma_f32_16x16x32_bf16 v[220:223], v[240:243], v[252:255], v[220:223]
    v_cvt_pk_bf16_f32 v159, v146, v147
    v_exp_f32 v148, v148
    ds_read_b64_tr_b16 v[10:11], v2 offset:32
    ds_read_b64_tr_b16 v[12:13], v2 offset:2080
    v_mfma_f32_32x32x8_bf16 v[124:139], v[54:55], v[208:209], v[124:139]
    v_exp_f32 v149, v149
    v_exp_f32 v150, v150
    v_exp_f32 v151, v151
    v_mfma_f32_16x16x32_bf16 v[224:227], v[244:247], v[252:255], v[224:227]
    v_exp_f32 v152, v152
    s_cmp_lg_u32 s53, 0
    s_cbranch_scc1 K2_m4_1
    v_mfma_f32_16x16x32_bf16 v[228:231], v[248:251], v[252:255], v[228:231]
K2_m4_1:
    v_exp_f32 v153, v153
    v_exp_f32 v154, v154
    v_mfma_f32_32x32x16_bf16 v[180:195], v[68:71], v[156:159], v[180:195]
    v_exp_f32 v155, v155
    v_cvt_pk_bf16_f32 v160, v148, v149
    v_cvt_pk_bf16_f32 v161, v150, v151
    v_cvt_pk_bf16_f32 v162, v152, v153
    v_cvt_pk_bf16_f32 v163, v154, v155
    v_exp_f32 v124, v124
    ds_read_b32 v179, v8 offset:22152
    s_cmp_lg_u32 s53, 0
    s_cbranch_scc1 K2_l4_2
    s_add_u32 s41, s40, 591872
    buffer_load_dwordx4 v[248:251], v3, s[32:35], s41 offen
K2_l4_2:
    v_exp_f32 v125, v125
    v_mfma_f32_32x32x16_bf16 v[180:195], v[72:75], v[160:163], v[180:195]
    s_waitcnt lgkmcnt(0)
    buffer_store_dwordx4 v[10:13], v3, s[8:11], s61 offen sc1
    s_add_u32 s61, s61, 18432
    v_exp_f32 v126, v126
    v_exp_f32 v127, v127
    v_exp_f32 v128, v128
    s_add_u32 s41, s40, 2048
    buffer_load_dwordx4 v[232:235], v3, s[32:35], s41 offen
    v_exp_f32 v129, v129
    v_exp_f32 v130, v130
    v_mfma_f32_32x32x16_bf16 v[140:155], v[32:35], v[204:207], 0
    v_exp_f32 v131, v131
    v_cvt_pk_bf16_f32 v156, v124, v125
    s_add_u32 s41, s40, 149504
    buffer_load_dwordx4 v[236:239], v3, s[32:35], s41 offen
    v_cvt_pk_bf16_f32 v157, v126, v127
    v_cvt_pk_bf16_f32 v158, v128, v129
    v_cvt_pk_bf16_f32 v159, v130, v131
    v_exp_f32 v132, v132
    s_cmp_lg_u32 s53, 0
    s_cbranch_scc1 K2_e2a2
    s_waitcnt lgkmcnt(0)
K2_cp2:
    v_readfirstlane_b32 s41, v179
    s_cmp_ge_u32 s41, 98304
    s_cbranch_scc1 K2_kp2
    s_sleep 2
    ds_read_b32 v179, v8 offset:22152
    s_waitcnt lgkmcnt(0)
    s_branch K2_cp2
K2_kp2:
    ds_read_b64 v[164:165], v18 offset:0
    ds_read_b64 v[166:167], v19 offset:2048
    ds_read_b64 v[168:169], v18 offset:2560
    ds_read_b64 v[170:171], v19 offset:4608
    ds_read_b64 v[172:173], v18 offset:5120
    ds_read_b64 v[174:175], v19 offset:7168
    ds_read_b64 v[176:177], v18 offset:7680
    ds_read_b64 v[178:179], v19 offset:9728
K2_e2a2:
    v_mfma_f32_32x32x8_bf16 v[140:155], v[54:55], v[210:211], v[140:155]
    s_add_u32 s41, s40, 296960
    buffer_load_dwordx4 v[240:243], v3, s[32:35], s41 offen
    v_exp_f32 v133, v133
    v_exp_f32 v134, v134
    v_exp_f32 v135, v135
    v_exp_f32 v136, v136
    v_exp_f32 v137, v137
    s_add_u32 s41, s40, 444416
    buffer_load_dwordx4 v[244:247], v3, s[32:35], s41 offen
    v_exp_f32 v138, v138
    v_mfma_f32_32x32x16_bf16 v[180:195], v[76:79], v[156:159], v[180:195]
    v_exp_f32 v139, v139
    v_cvt_pk_bf16_f32 v160, v132, v133
    v_cvt_pk_bf16_f32 v161, v134, v135
    v_cvt_pk_bf16_f32 v162, v136, v137
    v_cvt_pk_bf16_f32 v163, v138, v139
    v_exp_f32 v140, v140
    v_exp_f32 v141, v141
    v_mfma_f32_32x32x16_bf16 v[180:195], v[80:83], v[160:163], v[180:195]
    buffer_store_dwordx4 v[4:7], v3, s[8:11], s43 offen sc1
    s_add_u32 s43, s43, 65536
    v_exp_f32 v142, v142
    v_exp_f32 v143, v143
    v_exp_f32 v144, v144
    v_exp_f32 v145, v145
    v_exp_f32 v146, v146
    v_mfma_f32_32x32x16_bf16 v[124:139], v[36:39], v[204:207], 0
    v_exp_f32 v147, v147
    s_cmp_lg_u32 s53, 0
    s_cbranch_scc1 K2_e2b2
    s_waitcnt lgkmcnt(0)
    v_pk_add_f32 v[164:165], v[164:165], v[168:169]
    v_pk_add_f32 v[172:173], v[172:173], v[176:177]
    v_pk_add_f32 v[166:167], v[166:167], v[170:171]
    v_pk_add_f32 v[174:175], v[174:175], v[178:179]
    v_pk_add_f32 v[10:11], v[164:165], v[172:173]
    v_pk_add_f32 v[12:13], v[166:167], v[174:175]
    ds_read_b64 v[164:165], v18 offset:10240
    ds_read_b64 v[166:167], v19 offset:12288
    ds_read_b64 v[168:169], v18 offset:12800
    ds_read_b64 v[170:171], v19 offset:14848
    ds_read_b64 v[172:173], v18 offset:15360
    ds_read_b64 v[174:175], v19 offset:17408
    ds_read_b64 v[176:177], v18 offset:17920
    ds_read_b64 v[178:179], v19 offset:19968
K2_e2b2:
    ds_read_b32 v252, v8 offset:22180
    v_cvt_pk_bf16_f32 v156, v140, v141
    s_add_u32 s42, s55, 4096
    s_mov_b32 m0, s42
    s_add_u32 s41, s40, 604160
    buffer_load_dwordx4 v3, s[32:35], s41 offen lds
    v_cvt_pk_bf16_f32 v157, v142, v143
    v_cvt_pk_bf16_f32 v158, v144, v145
    v_cvt_pk_bf16_f32 v159, v146, v147
    v_exp_f32 v148, v148
    v_mfma_f32_32x32x8_bf16 v[124:139], v[56:57], v[208:209], v[124:139]
    v_exp_f32 v149, v149
    v_exp_f32 v150, v150
    v_exp_f32 v151, v151
    s_add_u32 s42, s55, 5120
    s_mov_b32 m0, s42
    s_add_u32 s41, s40, 15360
    buffer_load_dwordx4 v3, s[32:35], s41 offen lds
    v_exp_f32 v152, v152
    v_exp_f32 v153, v153
    v_exp_f32 v154, v154
    v_mfma_f32_32x32x16_bf16 v[180:195], v[84:87], v[156:159], v[180:195]
    v_exp_f32 v155, v155
    s_waitcnt lgkmcnt(0)
K2_cr2:
    v_readfirstlane_b32 s41, v252
    s_cmp_ge_u32 s41, 49152
    s_cbranch_scc1 K2_kr2
    s_sleep 2
    ds_read_b32 v252, v8 offset:22180
    s_waitcnt lgkmcnt(0)
    s_branch K2_cr2
K2_kr2:
    ds_read_b128 v[252:255], v9 offset:1024
    v_cvt_pk_bf16_f32 v160, v148, v149
    v_cvt_pk_bf16_f32 v161, v150, v151
    v_cvt_pk_bf16_f32 v162, v152, v153
    v_cvt_pk_bf16_f32 v163, v154, v155
    s_setprio 2
    v_exp_f32 v124, v124
    v_exp_f32 v125, v125
    v_mfma_f32_32x32x16_bf16 v[180:195], v[88:91], v[160:163], v[180:195]
    ds_read_b128 v[196:199], v3 offset:6144
    ds_read2st64_b32 v[200:201], v8 offset0:28 offset1:29
    ds_read2st64_b32 v[202:203], v8 offset0:29 offset1:28
    v_exp_f32 v126, v126
    s_cmp_lg_u32 s53, 0
    s_cbranch_scc1 K2_e2c2
    s_waitcnt lgkmcnt(0)
    v_pk_add_f32 v[166:167], v[166:167], v[170:171]
    v_pk_add_f32 v[174:175], v[174:175], v[178:179]
    v_pk_add_f32 v[12:13], v[12:13], v[166:167]
    v_pk_add_f32 v[12:13], v[12:13], v[174:175]
    v_rcp_f32 v170, v13
    v_pk_add_f32 v[164:165], v[164:165], v[168:169]
    v_pk_add_f32 v[172:173], v[172:173], v[176:177]
    v_pk_add_f32 v[10:11], v[10:11], v[164:165]
    v_pk_add_f32 v[10:11], v[10:11], v[172:173]
    v_subrev_u32 v171, 0x21800000, v13
    v_pk_mul_f32 v[10:11], v[10:11], v[170:171] op_sel_hi:[1,0]
    v_cmp_lt_u32 vcc, 1006632960, v171
    v_mul_f32 v12, v170, v12
    v_cvt_pk_bf16_f32 v10, v10, v11
    v_cvt_pk_bf16_f32 v12, v12, v12
    ds_write_b32 v1, v10 offset:14336
    ds_write_b16 v14, v12 offset:256
    s_or_b32 s23, s23, vcc_lo
    s_or_b32 s23, s23, vcc_hi
    s_mov_b64 exec, 1
    ds_add_u32 v8, v9 offset:22184
    s_mov_b64 exec, -1
K2_e2c2:
    v_exp_f32 v127, v127
    v_exp_f32 v128, v128
    s_waitcnt vmcnt(3) lgkmcnt(0)
    v_mfma_f32_16x16x32_bf16 v[212:215], v[232:235], v[252:255], v[212:215]
    v_exp_f32 v129, v129
    v_mfma_f32_16x16x32_bf16 v[216:219], v[236:239], v[252:255], v[216:219]
    v_exp_f32 v130, v130
    v_mfma_f32_32x32x16_bf16 v[140:155], v[40:43], v[204:207], 0
    v_exp_f32 v131, v131
    v_cvt_pk_bf16_f32 v156, v124, v125
    v_cvt_pk_bf16_f32 v157, v126, v127
    v_cvt_pk_bf16_f32 v158, v128, v129
    v_mfma_f32_16x16x32_bf16 v[220:223], v[240:243], v[252:255], v[220:223]
    v_cvt_pk_bf16_f32 v159, v130, v131
    v_exp_f32 v132, v132
    v_mfma_f32_32x32x8_bf16 v[140:155], v[56:57], v[210:211], v[140:155]
    v_exp_f32 v133, v133
    v_exp_f32 v134, v134
    v_exp_f32 v135, v135
    v_mfma_f32_16x16x32_bf16 v[224:227], v[244:247], v[252:255], v[224:227]
    v_exp_f32 v136, v136
    s_cmp_lg_u32 s53, 0
    s_cbranch_scc1 K2_m4_2
    v_mfma_f32_16x16x32_bf16 v[228:231], v[248:251], v[252:255], v[228:231]
K2_m4_2:
    v_exp_f32 v137, v137
    v_exp_f32 v138, v138
    v_mfma_f32_32x32x16_bf16 v[180:195], v[92:95], v[156:159], v[180:195]
    v_exp_f32 v139, v139
    v_cvt_pk_bf16_f32 v160, v132, v133
    v_cvt_pk_bf16_f32 v161, v134, v135
    v_cvt_pk_bf16_f32 v162, v136, v137
    v_cvt_pk_bf16_f32 v163, v138, v139
    v_exp_f32 v140, v140
    s_cmp_lg_u32 s53, 0
    s_cbranch_scc1 K2_l4_3
    s_add_u32 s41, s40, 592896
    buffer_load_dwordx4 v[248:251], v3, s[32:35], s41 offen
K2_l4_3:
    v_exp_f32 v141, v141
    v_mfma_f32_32x32x16_bf16 v[180:195], v[96:99], v[160:163], v[180:195]
    v_exp_f32 v142, v142
    v_exp_f32 v143, v143
    v_exp_f32 v144, v144
    s_add_u32 s41, s40, 3072
    buffer_load_dwordx4 v[232:235], v3, s[32:35], s41 offen
    v_exp_f32 v145, v145
    v_exp_f32 v146, v146
    v_mfma_f32_32x32x16_bf16 v[124:139], v[44:47], v[204:207], 0
    v_exp_f32 v147, v147
    v_cvt_pk_bf16_f32 v156, v140, v141
    s_add_u32 s41, s40, 150528
    buffer_load_dwordx4 v[236:239], v3, s[32:35], s41 offen
    v_cvt_pk_bf16_f32 v157, v142, v143
    v_cvt_pk_bf16_f32 v158, v144, v145
    v_cvt_pk_bf16_f32 v159, v146, v147
    v_exp_f32 v148, v148
    ds_read_b64_tr_b16 v[10:11], v2 offset:64
    ds_read_b64_tr_b16 v[12:13], v2 offset:2112
    v_mfma_f32_32x32x8_bf16 v[124:139], v[58:59], v[208:209], v[124:139]
    s_add_u32 s41, s40, 297984
    buffer_load_dwordx4 v[240:243], v3, s[32:35], s41 offen
    v_exp_f32 v149, v149
    v_exp_f32 v150, v150
    v_exp_f32 v151, v151
    v_exp_f32 v152, v152
    v_exp_f32 v153, v153
    s_add_u32 s41, s40, 445440
    buffer_load_dwordx4 v[244:247], v3, s[32:35], s41 offen
    v_exp_f32 v154, v154
    v_mfma_f32_32x32x16_bf16 v[180:195], v[100:103], v[156:159], v[180:195]
    v_exp_f32 v155, v155
    v_cvt_pk_bf16_f32 v160, v148, v149
    v_cvt_pk_bf16_f32 v161, v150, v151
    v_cvt_pk_bf16_f32 v162, v152, v153
    v_cvt_pk_bf16_f32 v163, v154, v155
    s_setprio 1
    v_exp_f32 v124, v124
    v_exp_f32 v125, v125
    v_mfma_f32_32x32x16_bf16 v[180:195], v[104:107], v[160:163], v[180:195]
    s_waitcnt lgkmcnt(0)
    buffer_store_dwordx4 v[10:13], v3, s[8:11], s61 offen sc1
    s_add_u32 s61, s61, 18432
    v_exp_f32 v126, v126
    v_exp_f32 v127, v127
    v_exp_f32 v128, v128
    v_exp_f32 v129, v129
    v_exp_f32 v130, v130
    v_mfma_f32_32x32x16_bf16 v[140:155], v[48:51], v[204:207], 0
    v_exp_f32 v131, v131
    v_cvt_pk_bf16_f32 v156, v124, v125
    v_cvt_pk_bf16_f32 v157, v126, v127
    v_cvt_pk_bf16_f32 v158, v128, v129
    v_cvt_pk_bf16_f32 v159, v130, v131
    v_exp_f32 v132, v132
    v_mfma_f32_32x32x8_bf16 v[140:155], v[58:59], v[210:211], v[140:155]
    v_exp_f32 v133, v133
    v_exp_f32 v134, v134
    v_exp_f32 v135, v135
    v_exp_f32 v136, v136
    v_exp_f32 v137, v137
    v_exp_f32 v138, v138
    v_mfma_f32_32x32x16_bf16 v[180:195], v[108:111], v[156:159], v[180:195]
    v_exp_f32 v139, v139
    ds_read_b128 v[252:255], v9 offset:1536
    v_cvt_pk_bf16_f32 v160, v132, v133
    v_cvt_pk_bf16_f32 v161, v134, v135
    v_cvt_pk_bf16_f32 v162, v136, v137
    v_cvt_pk_bf16_f32 v163, v138, v139
    v_exp_f32 v140, v140
    v_exp_f32 v141, v141
    v_mfma_f32_32x32x16_bf16 v[180:195], v[112:115], v[160:163], v[180:195]
    v_exp_f32 v142, v142
    v_exp_f32 v143, v143
    v_exp_f32 v144, v144
    s_waitcnt vmcnt(1) lgkmcnt(0)
    v_mfma_f32_16x16x32_bf16 v[212:215], v[232:235], v[252:255], v[212:215]
    v_exp_f32 v145, v145
    v_mfma_f32_16x16x32_bf16 v[216:219], v[236:239], v[252:255], v[216:219]
    v_exp_f32 v146, v146
    s_waitcnt lgkmcnt(0)
    v_mfma_f32_32x32x16_bf16 v[124:139], v[20:23], v[196:199], 0
    v_exp_f32 v147, v147
    v_cvt_pk_bf16_f32 v156, v140, v141
    v_cvt_pk_bf16_f32 v157, v142, v143
    v_cvt_pk_bf16_f32 v158, v144, v145
    v_mfma_f32_16x16x32_bf16 v[220:223], v[240:243], v[252:255], v[220:223]
    v_cvt_pk_bf16_f32 v159, v146, v147
    v_exp_f32 v148, v148
    v_mfma_f32_32x32x8_bf16 v[124:139], v[52:53], v[200:201], v[124:139]
    v_exp_f32 v149, v149
    v_exp_f32 v150, v150
    v_exp_f32 v151, v151
    v_mfma_f32_16x16x32_bf16 v[224:227], v[244:247], v[252:255], v[224:227]
    v_exp_f32 v152, v152
    s_cmp_lg_u32 s53, 0
    s_cbranch_scc1 K2_m4_3
    v_mfma_f32_16x16x32_bf16 v[228:231], v[248:251], v[252:255], v[228:231]
K2_m4_3:
    v_exp_f32 v153, v153
    v_exp_f32 v154, v154
    v_mfma_f32_32x32x16_bf16 v[180:195], v[116:119], v[156:159], v[180:195]
    v_exp_f32 v155, v155
    v_cvt_pk_bf16_f32 v160, v148, v149
    v_cvt_pk_bf16_f32 v161, v150, v151
    v_cvt_pk_bf16_f32 v162, v152, v153
    v_cvt_pk_bf16_f32 v163, v154, v155
    s_setprio 0
    v_exp_f32 v124, v124
    s_cmp_lg_u32 s53, 0
    s_cbranch_scc1 K2_l4_4
    s_add_u32 s41, s40, 593920
    buffer_load_dwordx4 v[248:251], v3, s[32:35], s41 offen
K2_l4_4:
    v_exp_f32 v125, v125
    v_mfma_f32_32x32x16_bf16 v[180:195], v[120:123], v[160:163], v[180:195]
    v_exp_f32 v126, v126
    v_exp_f32 v127, v127
    v_exp_f32 v128, v128
    s_add_u32 s41, s40, 4096
    buffer_load_dwordx4 v[232:235], v3, s[32:35], s41 offen
    v_exp_f32 v129, v129
    v_exp_f32 v130, v130
    v_mfma_f32_32x32x16_bf16 v[140:155], v[24:27], v[196:199], 0
    v_exp_f32 v131, v131
    v_cvt_pk_bf16_f32 v156, v124, v125
    s_add_u32 s41, s40, 151552
    buffer_load_dwordx4 v[236:239], v3, s[32:35], s41 offen
    v_cvt_pk_bf16_f32 v157, v126, v127
    v_cvt_pk_bf16_f32 v158, v128, v129
    v_cvt_pk_bf16_f32 v159, v130, v131
    v_exp_f32 v132, v132
    ds_read_b64_tr_b16 v[10:11], v2 offset:96
    ds_read_b64_tr_b16 v[12:13], v2 offset:2144
    v_mfma_f32_32x32x8_bf16 v[140:155], v[52:53], v[202:203], v[140:155]
    s_add_u32 s41, s40, 299008
    buffer_load_dwordx4 v[240:243], v3, s[32:35], s41 offen
    v_exp_f32 v133, v133
    ds_write_b128 v16, v[180:183] offset:20480
    v_exp_f32 v134, v134
    v_exp_f32 v135, v135
    v_exp_f32 v136, v136
    v_exp_f32 v137, v137
    ds_write_b128 v16, v[184:187] offset:21504
    s_add_u32 s41, s40, 446464
    buffer_load_dwordx4 v[244:247], v3, s[32:35], s41 offen
    v_exp_f32 v138, v138
    v_mfma_f32_32x32x16_bf16 v[164:179], v[60:63], v[156:159], 0
    v_exp_f32 v139, v139
    v_cvt_pk_bf16_f32 v160, v132, v133
    ds_write_b64 v17, v[188:189] offset:22528
    v_cvt_pk_bf16_f32 v161, v134, v135
    s_mov_b64 exec, 1
    ds_add_u32 v8, v9 offset:22156
    s_mov_b64 exec, -1
    v_cvt_pk_bf16_f32 v162, v136, v137
    v_cvt_pk_bf16_f32 v163, v138, v139
    s_setprio 3
    v_exp_f32 v140, v140
    v_exp_f32 v141, v141
    v_mfma_f32_32x32x16_bf16 v[164:179], v[64:67], v[160:163], v[164:179]
    s_waitcnt lgkmcnt(0)
    buffer_store_dwordx4 v[10:13], v3, s[8:11], s61 offen sc1
    s_add_u32 s61, s61, 18432
    v_exp_f32 v142, v142
    v_exp_f32 v143, v143
    v_exp_f32 v144, v144
    v_exp_f32 v145, v145
    v_exp_f32 v146, v146
    v_mfma_f32_32x32x16_bf16 v[124:139], v[28:31], v[196:199], 0
    v_exp_f32 v147, v147
    ds_read_b32 v252, v8 offset:22184
    v_cvt_pk_bf16_f32 v156, v140, v141
    v_cvt_pk_bf16_f32 v157, v142, v143
    v_cvt_pk_bf16_f32 v158, v144, v145
    v_cvt_pk_bf16_f32 v159, v146, v147
    v_exp_f32 v148, v148
    v_mfma_f32_32x32x8_bf16 v[124:139], v[54:55], v[200:201], v[124:139]
    v_exp_f32 v149, v149
    v_exp_f32 v150, v150
    v_exp_f32 v151, v151
    v_exp_f32 v152, v152
    v_exp_f32 v153, v153
    v_exp_f32 v154, v154
    v_mfma_f32_32x32x16_bf16 v[164:179], v[68:71], v[156:159], v[164:179]
    v_exp_f32 v155, v155
    s_waitcnt lgkmcnt(0)
K2_cr4:
    v_readfirstlane_b32 s41, v252
    s_cmp_ge_u32 s41, 49152
    s_cbranch_scc1 K2_kr4
    s_sleep 2
    ds_read_b32 v252, v8 offset:22184
    s_waitcnt lgkmcnt(0)
    s_branch K2_cr4
K2_kr4:
    ds_read_b128 v[252:255], v9 offset:2048
    v_cvt_pk_bf16_f32 v160, v148, v149
    v_cvt_pk_bf16_f32 v161, v150, v151
    v_cvt_pk_bf16_f32 v162, v152, v153
    v_cvt_pk_bf16_f32 v163, v154, v155
    v_exp_f32 v124, v124
    ds_read_b32 v195, v8 offset:22156
    v_exp_f32 v125, v125
    v_mfma_f32_32x32x16_bf16 v[164:179], v[72:75], v[160:163], v[164:179]
    v_exp_f32 v126, v126
    v_exp_f32 v127, v127
    v_exp_f32 v128, v128
    s_waitcnt vmcnt(1) lgkmcnt(0)
    v_mfma_f32_16x16x32_bf16 v[212:215], v[232:235], v[252:255], v[212:215]
    v_exp_f32 v129, v129
    v_mfma_f32_16x16x32_bf16 v[216:219], v[236:239], v[252:255], v[216:219]
    v_exp_f32 v130, v130
    v_mfma_f32_32x32x16_bf16 v[140:155], v[32:35], v[196:199], 0
    v_exp_f32 v131, v131
    v_cvt_pk_bf16_f32 v156, v124, v125
    v_cvt_pk_bf16_f32 v157, v126, v127
    v_cvt_pk_bf16_f32 v158, v128, v129
    v_mfma_f32_16x16x32_bf16 v[220:223], v[240:243], v[252:255], v[220:223]
    v_cvt_pk_bf16_f32 v159, v130, v131
    v_exp_f32 v132, v132
    s_cmp_lg_u32 s53, 1
    s_cbranch_scc1 K2_e2a3
    s_waitcnt lgkmcnt(0)
K2_cp3:
    v_readfirstlane_b32 s41, v195
    s_cmp_ge_u32 s41, 98304
    s_cbranch_scc1 K2_kp3
    s_sleep 2
    ds_read_b32 v195, v8 offset:22156
    s_waitcnt lgkmcnt(0)
    s_branch K2_cp3
K2_kp3:
    ds_read_b64 v[180:181], v18 offset:20480
    ds_read_b64 v[182:183], v19 offset:22528
    ds_read_b64 v[184:185], v18 offset:23040
    ds_read_b64 v[186:187], v19 offset:25088
    ds_read_b64 v[188:189], v18 offset:25600
    ds_read_b64 v[190:191], v19 offset:27648
    ds_read_b64 v[192:193], v18 offset:28160
    ds_read_b64 v[194:195], v19 offset:30208
K2_e2a3:
    v_mfma_f32_32x32x8_bf16 v[140:155], v[54:55], v[202:203], v[140:155]
    v_exp_f32 v133, v133
    v_exp_f32 v134, v134
    v_exp_f32 v135, v135
    v_mfma_f32_16x16x32_bf16 v[224:227], v[244:247], v[252:255], v[224:227]
    v_exp_f32 v136, v136
    s_cmp_lg_u32 s53, 0
    s_cbranch_scc1 K2_m4_4
    v_mfma_f32_16x16x32_bf16 v[228:231], v[248:251], v[252:255], v[228:231]
K2_m4_4:
    v_exp_f32 v137, v137
    v_exp_f32 v138, v138
    v_mfma_f32_32x32x16_bf16 v[164:179], v[76:79], v[156:159], v[164:179]
    v_exp_f32 v139, v139
    v_cvt_pk_bf16_f32 v160, v132, v133
    v_cvt_pk_bf16_f32 v161, v134, v135
    v_cvt_pk_bf16_f32 v162, v136, v137
    v_cvt_pk_bf16_f32 v163, v138, v139
    v_exp_f32 v140, v140
    s_cmp_lg_u32 s53, 0
    s_cbranch_scc1 K2_l4_5
    s_add_u32 s41, s40, 594944
    buffer_load_dwordx4 v[248:251], v3, s[32:35], s41 offen
K2_l4_5:
    v_exp_f32 v141, v141
    v_mfma_f32_32x32x16_bf16 v[164:179], v[80:83], v[160:163], v[164:179]
    v_exp_f32 v142, v142
    v_exp_f32 v143, v143
    v_exp_f32 v144, v144
    s_add_u32 s41, s40, 5120
    buffer_load_dwordx4 v[232:235], v3, s[32:35], s41 offen
    v_exp_f32 v145, v145
    v_exp_f32 v146, v146
    v_mfma_f32_32x32x16_bf16 v[124:139], v[36:39], v[196:199], 0
    v_exp_f32 v147, v147
    s_cmp_lg_u32 s53, 1
    s_cbranch_scc1 K2_e2b3
    s_waitcnt lgkmcnt(0)
    v_pk_add_f32 v[180:181], v[180:181], v[184:185]
    v_pk_add_f32 v[188:189], v[188:189], v[192:193]
    v_pk_add_f32 v[182:183], v[182:183], v[186:187]
    v_pk_add_f32 v[190:191], v[190:191], v[194:195]
    v_pk_add_f32 v[10:11], v[180:181], v[188:189]
    v_pk_add_f32 v[12:13], v[182:183], v[190:191]
    ds_read_b64 v[180:181], v18 offset:30720
    ds_read_b64 v[182:183], v19 offset:32768
    ds_read_b64 v[184:185], v18 offset:33280
    ds_read_b64 v[186:187], v19 offset:35328
    ds_read_b64 v[188:189], v18 offset:35840
    ds_read_b64 v[190:191], v19 offset:37888
    ds_read_b64 v[192:193], v18 offset:38400
    ds_read_b64 v[194:195], v19 offset:40448
K2_e2b3:
    v_cvt_pk_bf16_f32 v156, v140, v141
    s_add_u32 s41, s40, 152576
    buffer_load_dwordx4 v[236:239], v3, s[32:35], s41 offen
    v_cvt_pk_bf16_f32 v157, v142, v143
    v_cvt_pk_bf16_f32 v158, v144, v145
    v_cvt_pk_bf16_f32 v159, v146, v147
    v_exp_f32 v148, v148
    v_mfma_f32_32x32x8_bf16 v[124:139], v[56:57], v[200:201], v[124:139]
    s_add_u32 s41, s40, 300032
    buffer_load_dwordx4 v[240:243], v3, s[32:35], s41 offen
    v_exp_f32 v149, v149
    v_exp_f32 v150, v150
    v_exp_f32 v151, v151
    v_exp_f32 v152, v152
    v_exp_f32 v153, v153
    s_add_u32 s41, s40, 447488
    buffer_load_dwordx4 v[244:247], v3, s[32:35], s41 offen
    v_exp_f32 v154, v154
    v_mfma_f32_32x32x16_bf16 v[164:179], v[84:87], v[156:159], v[164:179]
    v_exp_f32 v155, v155
    v_cvt_pk_bf16_f32 v160, v148, v149
    v_cvt_pk_bf16_f32 v161, v150, v151
    v_cvt_pk_bf16_f32 v162, v152, v153
    v_cvt_pk_bf16_f32 v163, v154, v155
    s_setprio 2
    v_exp_f32 v124, v124
    v_exp_f32 v125, v125
    v_mfma_f32_32x32x16_bf16 v[164:179], v[88:91], v[160:163], v[164:179]
    ds_read_b128 v[204:207], v3 offset:7680
    ds_read2st64_b32 v[208:209], v8 offset0:34 offset1:35
    ds_read2st64_b32 v[210:211], v8 offset0:35 offset1:34
    s_lshl_b32 s41, s2, 3
    s_add_u32 s41, s41, s3
    s_mul_i32 s41, s41, 1152
    s_mul_i32 s42, s3, 1184
    s_add_u32 s42, s42, 64512
    s_mov_b32 m0, s42
    s_nop 0
    buffer_load_dwordx4 v3, s[36:39], s41 offen lds
    v_exp_f32 v126, v126
    s_cmp_lg_u32 s53, 1
    s_cbranch_scc1 K2_e2c3
    s_waitcnt lgkmcnt(0)
    v_pk_add_f32 v[182:183], v[182:183], v[186:187]
    v_pk_add_f32 v[190:191], v[190:191], v[194:195]
    v_pk_add_f32 v[12:13], v[12:13], v[182:183]
    v_pk_add_f32 v[12:13], v[12:13], v[190:191]
    v_rcp_f32 v186, v13
    v_pk_add_f32 v[180:181], v[180:181], v[184:185]
    v_pk_add_f32 v[188:189], v[188:189], v[192:193]
    v_pk_add_f32 v[10:11], v[10:11], v[180:181]
    v_pk_add_f32 v[10:11], v[10:11], v[188:189]
    v_subrev_u32 v187, 0x21800000, v13
    v_pk_mul_f32 v[10:11], v[10:11], v[186:187] op_sel_hi:[1,0]
    v_cmp_lt_u32 vcc, 1006632960, v187
    v_mul_f32 v12, v186, v12
    v_cvt_pk_bf16_f32 v10, v10, v11
    v_cvt_pk_bf16_f32 v12, v12, v12
    ds_write_b32 v1, v10 offset:15360
    ds_write_b16 v14, v12 offset:384
    s_or_b32 s23, s23, vcc_lo
    s_or_b32 s23, s23, vcc_hi
    s_mov_b64 exec, 1
    ds_add_u32 v8, v9 offset:22188
    s_mov_b64 exec, -1
K2_e2c3:
    v_exp_f32 v127, v127
    v_exp_f32 v128, v128
    v_exp_f32 v129, v129
    s_mov_b64 exec, 0xff
    buffer_load_dwordx4 v3, s[36:39], s41 offen offset:1024 lds
    s_mov_b64 exec, -1
    v_exp_f32 v130, v130
    v_mfma_f32_32x32x16_bf16 v[140:155], v[40:43], v[196:199], 0
    v_exp_f32 v131, v131
    v_cvt_pk_bf16_f32 v156, v124, v125
    v_cvt_pk_bf16_f32 v157, v126, v127
    buffer_store_dwordx4 v[4:7], v3, s[8:11], s43 offen sc1
    s_add_u32 s43, s43, 65536
    v_cvt_pk_bf16_f32 v158, v128, v129
    v_cvt_pk_bf16_f32 v159, v130, v131
    v_exp_f32 v132, v132
    v_mfma_f32_32x32x8_bf16 v[140:155], v[56:57], v[202:203], v[140:155]
    v_exp_f32 v133, v133
    s_add_u32 s42, s55, 6144
    s_mov_b32 m0, s42
    s_add_u32 s41, s40, 162816
    buffer_load_dwordx4 v3, s[32:35], s41 offen lds
    v_exp_f32 v134, v134
    v_exp_f32 v135, v135
    v_exp_f32 v136, v136
    v_exp_f32 v137, v137
    v_exp_f32 v138, v138
    s_add_u32 s42, s55, 7168
    s_mov_b32 m0, s42
    s_add_u32 s41, s40, 310272
    buffer_load_dwordx4 v3, s[32:35], s41 offen lds
    v_mfma_f32_32x32x16_bf16 v[164:179], v[92:95], v[156:159], v[164:179]
    v_exp_f32 v139, v139
    ds_read_b128 v[252:255], v9 offset:2560
    v_cvt_pk_bf16_f32 v160, v132, v133
    v_cvt_pk_bf16_f32 v161, v134, v135
    v_cvt_pk_bf16_f32 v162, v136, v137
    v_cvt_pk_bf16_f32 v163, v138, v139
    v_exp_f32 v140, v140
    v_exp_f32 v141, v141
    v_mfma_f32_32x32x16_bf16 v[164:179], v[96:99], v[160:163], v[164:179]
    v_exp_f32 v142, v142
    v_exp_f32 v143, v143
    v_exp_f32 v144, v144
    s_waitcnt vmcnt(5) lgkmcnt(0)
    v_mfma_f32_16x16x32_bf16 v[212:215], v[232:235], v[252:255], v[212:215]
    v_exp_f32 v145, v145
    v_mfma_f32_16x16x32_bf16 v[216:219], v[236:239], v[252:255], v[216:219]
    v_exp_f32 v146, v146
    v_mfma_f32_32x32x16_bf16 v[124:139], v[44:47], v[196:199], 0
    v_exp_f32 v147, v147
    v_cvt_pk_bf16_f32 v156, v140, v141
    v_cvt_pk_bf16_f32 v157, v142, v143
    v_cvt_pk_bf16_f32 v158, v144, v145
    v_mfma_f32_16x16x32_bf16 v[220:223], v[240:243], v[252:255], v[220:223]
    v_cvt_pk_bf16_f32 v159, v146, v147
    v_exp_f32 v148, v148
    v_mfma_f32_32x32x8_bf16 v[124:139], v[58:59], v[200:201], v[124:139]
    v_exp_f32 v149, v149
    v_exp_f32 v150, v150
    v_exp_f32 v151, v151
    v_mfma_f32_16x16x32_bf16 v[224:227], v[244:247], v[252:255], v[224:227]
    v_exp_f32 v152, v152
    s_cmp_lg_u32 s53, 0
    s_cbranch_scc1 K2_m4_5
    v_mfma_f32_16x16x32_bf16 v[228:231], v[248:251], v[252:255], v[228:231]
K2_m4_5:
    v_exp_f32 v153, v153
    v_exp_f32 v154, v154
    v_mfma_f32_32x32x16_bf16 v[164:179], v[100:103], v[156:159], v[164:179]
    v_exp_f32 v155, v155
    v_cvt_pk_bf16_f32 v160, v148, v149
    v_cvt_pk_bf16_f32 v161, v150, v151
    v_cvt_pk_bf16_f32 v162, v152, v153
    v_cvt_pk_bf16_f32 v163, v154, v155
    s_setprio 1
    v_exp_f32 v124, v124
    s_cmp_lg_u32 s53, 0
    s_cbranch_scc1 K2_l4_6
    s_add_u32 s41, s40, 595968
    buffer_load_dwordx4 v[248:251], v3, s[32:35], s41 offen
K2_l4_6:
    v_exp_f32 v125, v125
    v_mfma_f32_32x32x16_bf16 v[164:179], v[104:107], v[160:163], v[164:179]
    v_exp_f32 v126, v126
    v_exp_f32 v127, v127
    v_exp_f32 v128, v128
    s_add_u32 s41, s40, 6144
    buffer_load_dwordx4 v[232:235], v3, s[32:35], s41 offen
    v_exp_f32 v129, v129
    v_exp_f32 v130, v130
    v_mfma_f32_32x32x16_bf16 v[140:155], v[48:51], v[196:199], 0
    v_exp_f32 v131, v131
    v_cvt_pk_bf16_f32 v156, v124, v125
    s_add_u32 s41, s40, 153600
    buffer_load_dwordx4 v[236:239], v3, s[32:35], s41 offen
    v_cvt_pk_bf16_f32 v157, v126, v127
    v_cvt_pk_bf16_f32 v158, v128, v129
    v_cvt_pk_bf16_f32 v159, v130, v131
    v_exp_f32 v132, v132
    v_mfma_f32_32x32x8_bf16 v[140:155], v[58:59], v[202:203], v[140:155]
    s_add_u32 s41, s40, 301056
    buffer_load_dwordx4 v[240:243], v3, s[32:35], s41 offen
    v_exp_f32 v133, v133
    v_exp_f32 v134, v134
    v_exp_f32 v135, v135
    v_exp_f32 v136, v136
    v_exp_f32 v137, v137
    s_add_u32 s41, s40, 448512
    buffer_load_dwordx4 v[244:247], v3, s[32:35], s41 offen
    v_exp_f32 v138, v138
    v_mfma_f32_32x32x16_bf16 v[164:179], v[108:111], v[156:159], v[164:179]
    v_exp_f32 v139, v139
    v_cvt_pk_bf16_f32 v160, v132, v133
    v_cvt_pk_bf16_f32 v161, v134, v135
    v_cvt_pk_bf16_f32 v162, v136, v137
    v_cvt_pk_bf16_f32 v163, v138, v139
    v_exp_f32 v140, v140
    v_exp_f32 v141, v141
    v_mfma_f32_32x32x16_bf16 v[164:179], v[112:115], v[160:163], v[164:179]
    buffer_store_dwordx4 v[4:7], v3, s[8:11], s43 offen sc1
    s_add_u32 s43, s43, 65536
    v_exp_f32 v142, v142
    v_exp_f32 v143, v143
    v_exp_f32 v144, v144
    v_exp_f32 v145, v145
    v_exp_f32 v146, v146
    s_waitcnt lgkmcnt(0)
    v_mfma_f32_32x32x16_bf16 v[124:139], v[20:23], v[204:207], 0
    v_exp_f32 v147, v147
    ds_read_b32 v252, v8 offset:22188
    v_cvt_pk_bf16_f32 v156, v140, v141
    v_cvt_pk_bf16_f32 v157, v142, v143
    v_cvt_pk_bf16_f32 v158, v144, v145
    v_cvt_pk_bf16_f32 v159, v146, v147
    v_exp_f32 v148, v148
    v_mfma_f32_32x32x8_bf16 v[124:139], v[52:53], v[208:209], v[124:139]
    v_exp_f32 v149, v149
    v_exp_f32 v150, v150
    v_exp_f32 v151, v151
    v_exp_f32 v152, v152
    v_exp_f32 v153, v153
    v_exp_f32 v154, v154
    v_mfma_f32_32x32x16_bf16 v[164:179], v[116:119], v[156:159], v[164:179]
    v_exp_f32 v155, v155
    s_waitcnt lgkmcnt(0)
K2_cr6:
    v_readfirstlane_b32 s41, v252
    s_cmp_ge_u32 s41, 49152
    s_cbranch_scc1 K2_kr6
    s_sleep 2
    ds_read_b32 v252, v8 offset:22188
    s_waitcnt lgkmcnt(0)
    s_branch K2_cr6
K2_kr6:
    ds_read_b128 v[252:255], v9 offset:3072
    v_cvt_pk_bf16_f32 v160, v148, v149
    v_cvt_pk_bf16_f32 v161, v150, v151
    v_cvt_pk_bf16_f32 v162, v152, v153
    v_cvt_pk_bf16_f32 v163, v154, v155
    s_setprio 0
    v_exp_f32 v124, v124
    v_exp_f32 v125, v125
    v_mfma_f32_32x32x16_bf16 v[164:179], v[120:123], v[160:163], v[164:179]
    v_exp_f32 v126, v126
    v_exp_f32 v127, v127
    v_exp_f32 v128, v128
    s_waitcnt vmcnt(1) lgkmcnt(0)
    v_mfma_f32_16x16x32_bf16 v[212:215], v[232:235], v[252:255], v[212:215]
    v_exp_f32 v129, v129
    v_mfma_f32_16x16x32_bf16 v[216:219], v[236:239], v[252:255], v[216:219]
    v_exp_f32 v130, v130
    v_mfma_f32_32x32x16_bf16 v[140:155], v[24:27], v[204:207], 0
    v_exp_f32 v131, v131
    v_cvt_pk_bf16_f32 v156, v124, v125
    v_cvt_pk_bf16_f32 v157, v126, v127
    v_cvt_pk_bf16_f32 v158, v128, v129
    v_mfma_f32_16x16x32_bf16 v[220:223], v[240:243], v[252:255], v[220:223]
    v_cvt_pk_bf16_f32 v159, v130, v131
    v_exp_f32 v132, v132
    v_mfma_f32_32x32x8_bf16 v[140:155], v[52:53], v[210:211], v[140:155]
    v_exp_f32 v133, v133
    ds_write_b128 v16, v[164:167] offset:0
    v_exp_f32 v134, v134
    v_exp_f32 v135, v135
    v_mfma_f32_16x16x32_bf16 v[224:227], v[244:247], v[252:255], v[224:227]
    v_exp_f32 v136, v136
    s_cmp_lg_u32 s53, 0
    s_cbranch_scc1 K2_m4_6
    v_mfma_f32_16x16x32_bf16 v[228:231], v[248:251], v[252:255], v[228:231]
K2_m4_6:
    v_exp_f32 v137, v137
    ds_write_b128 v16, v[168:171] offset:1024
    v_exp_f32 v138, v138
    v_mfma_f32_32x32x16_bf16 v[180:195], v[60:63], v[156:159], 0
    v_exp_f32 v139, v139
    v_cvt_pk_bf16_f32 v160, v132, v133
    ds_write_b64 v17, v[172:173] offset:2048
    v_cvt_pk_bf16_f32 v161, v134, v135
    s_mov_b64 exec, 1
    ds_add_u32 v8, v9 offset:22160
    s_mov_b64 exec, -1
    v_cvt_pk_bf16_f32 v162, v136, v137
    v_cvt_pk_bf16_f32 v163, v138, v139
    s_setprio 3
    v_exp_f32 v140, v140
    s_cmp_lg_u32 s53, 0
    s_cbranch_scc1 K2_l4_7
    s_add_u32 s41, s40, 596992
    buffer_load_dwordx4 v[248:251], v3, s[32:35], s41 offen
K2_l4_7:
    v_exp_f32 v141, v141
    v_mfma_f32_32x32x16_bf16 v[180:195], v[64:67], v[160:163], v[180:195]
    v_exp_f32 v142, v142
    v_exp_f32 v143, v143
    v_exp_f32 v144, v144
    s_add_u32 s41, s40, 7168
    buffer_load_dwordx4 v[232:235], v3, s[32:35], s41 offen
    v_exp_f32 v145, v145
    v_exp_f32 v146, v146
    v_mfma_f32_32x32x16_bf16 v[124:139], v[28:31], v[204:207], 0
    v_exp_f32 v147, v147
    v_cvt_pk_bf16_f32 v156, v140, v141
    s_add_u32 s41, s40, 154624
    buffer_load_dwordx4 v[236:239], v3, s[32:35], s41 offen
    v_cvt_pk_bf16_f32 v157, v142, v143
    v_cvt_pk_bf16_f32 v158, v144, v145
    v_cvt_pk_bf16_f32 v159, v146, v147
    v_exp_f32 v148, v148
    v_mfma_f32_32x32x8_bf16 v[124:139], v[54:55], v[208:209], v[124:139]
    s_add_u32 s41, s40, 302080
    buffer_load_dwordx4 v[240:243], v3, s[32:35], s41 offen
    v_exp_f32 v149, v149
    v_exp_f32 v150, v150
    v_exp_f32 v151, v151
    v_exp_f32 v152, v152
    v_exp_f32 v153, v153
    s_add_u32 s41, s40, 449536
    buffer_load_dwordx4 v[244:247], v3, s[32:35], s41 offen
    v_exp_f32 v154, v154
    v_mfma_f32_32x32x16_bf16 v[180:195], v[68:71], v[156:159], v[180:195]
    v_exp_f32 v155, v155
    v_cvt_pk_bf16_f32 v160, v148, v149
    v_cvt_pk_bf16_f32 v161, v150, v151
    v_cvt_pk_bf16_f32 v162, v152, v153
    v_cvt_pk_bf16_f32 v163, v154, v155
    v_exp_f32 v124, v124
    ds_read_b32 v179, v8 offset:22160
    v_exp_f32 v125, v125
    v_mfma_f32_32x32x16_bf16 v[180:195], v[72:75], v[160:163], v[180:195]
    buffer_store_dwordx4 v[4:7], v3, s[8:11], s43 offen sc1
    s_add_u32 s43, s43, 65536
    v_exp_f32 v126, v126
    v_exp_f32 v127, v127
    v_exp_f32 v128, v128
    v_exp_f32 v129, v129
    v_exp_f32 v130, v130
    v_mfma_f32_32x32x16_bf16 v[140:155], v[32:35], v[204:207], 0
    v_exp_f32 v131, v131
    v_cvt_pk_bf16_f32 v156, v124, v125
    v_cvt_pk_bf16_f32 v157, v126, v127
    v_cvt_pk_bf16_f32 v158, v128, v129
    v_cvt_pk_bf16_f32 v159, v130, v131
    v_exp_f32 v132, v132
    s_cmp_lg_u32 s53, 0
    s_cbranch_scc1 K2_e2a4
    s_waitcnt lgkmcnt(0)
K2_cp4:
    v_readfirstlane_b32 s41, v179
    s_cmp_ge_u32 s41, 98304
    s_cbranch_scc1 K2_kp4
    s_sleep 2
    ds_read_b32 v179, v8 offset:22160
    s_waitcnt lgkmcnt(0)
    s_branch K2_cp4
K2_kp4:
    ds_read_b64 v[164:165], v18 offset:0
    ds_read_b64 v[166:167], v19 offset:2048
    ds_read_b64 v[168:169], v18 offset:2560
    ds_read_b64 v[170:171], v19 offset:4608
    ds_read_b64 v[172:173], v18 offset:5120
    ds_read_b64 v[174:175], v19 offset:7168
    ds_read_b64 v[176:177], v18 offset:7680
    ds_read_b64 v[178:179], v19 offset:9728
K2_e2a4:
    v_mfma_f32_32x32x8_bf16 v[140:155], v[54:55], v[210:211], v[140:155]
    v_exp_f32 v133, v133
    v_exp_f32 v134, v134
    v_exp_f32 v135, v135
    v_exp_f32 v136, v136
    v_exp_f32 v137, v137
    v_exp_f32 v138, v138
    v_mfma_f32_32x32x16_bf16 v[180:195], v[76:79], v[156:159], v[180:195]
    v_exp_f32 v139, v139
    ds_read_b128 v[252:255], v9 offset:3584
    v_cvt_pk_bf16_f32 v160, v132, v133
    v_cvt_pk_bf16_f32 v161, v134, v135
    v_cvt_pk_bf16_f32 v162, v136, v137
    v_cvt_pk_bf16_f32 v163, v138, v139
    v_exp_f32 v140, v140
    v_exp_f32 v141, v141
    v_mfma_f32_32x32x16_bf16 v[180:195], v[80:83], v[160:163], v[180:195]
    v_exp_f32 v142, v142
    v_exp_f32 v143, v143
    v_exp_f32 v144, v144
    s_waitcnt vmcnt(1) lgkmcnt(0)
    v_mfma_f32_16x16x32_bf16 v[212:215], v[232:235], v[252:255], v[212:215]
    v_exp_f32 v145, v145
    v_mfma_f32_16x16x32_bf16 v[216:219], v[236:239], v[252:255], v[216:219]
    v_exp_f32 v146, v146
    v_mfma_f32_32x32x16_bf16 v[124:139], v[36:39], v[204:207], 0
    v_exp_f32 v147, v147
    s_cmp_lg_u32 s53, 0
    s_cbranch_scc1 K2_e2b4
    s_waitcnt lgkmcnt(0)
    v_pk_add_f32 v[164:165], v[164:165], v[168:169]
    v_pk_add_f32 v[172:173], v[172:173], v[176:177]
    v_pk_add_f32 v[166:167], v[166:167], v[170:171]
    v_pk_add_f32 v[174:175], v[174:175], v[178:179]
    v_pk_add_f32 v[10:11], v[164:165], v[172:173]
    v_pk_add_f32 v[12:13], v[166:167], v[174:175]
    ds_read_b64 v[164:165], v18 offset:10240
    ds_read_b64 v[166:167], v19 offset:12288
    ds_read_b64 v[168:169], v18 offset:12800
    ds_read_b64 v[170:171], v19 offset:14848
    ds_read_b64 v[172:173], v18 offset:15360
    ds_read_b64 v[174:175], v19 offset:17408
    ds_read_b64 v[176:177], v18 offset:17920
    ds_read_b64 v[178:179], v19 offset:19968
K2_e2b4:
    v_cvt_pk_bf16_f32 v156, v140, v141
    v_cvt_pk_bf16_f32 v157, v142, v143
    v_cvt_pk_bf16_f32 v158, v144, v145
    v_mfma_f32_16x16x32_bf16 v[220:223], v[240:243], v[252:255], v[220:223]
    v_cvt_pk_bf16_f32 v159, v146, v147
    v_exp_f32 v148, v148
    v_mfma_f32_32x32x8_bf16 v[124:139], v[56:57], v[208:209], v[124:139]
    v_exp_f32 v149, v149
    v_exp_f32 v150, v150
    v_exp_f32 v151, v151
    v_mfma_f32_16x16x32_bf16 v[224:227], v[244:247], v[252:255], v[224:227]
    v_exp_f32 v152, v152
    s_cmp_lg_u32 s53, 0
    s_cbranch_scc1 K2_m4_7
    v_mfma_f32_16x16x32_bf16 v[228:231], v[248:251], v[252:255], v[228:231]
K2_m4_7:
    v_exp_f32 v153, v153
    v_exp_f32 v154, v154
    v_mfma_f32_32x32x16_bf16 v[180:195], v[84:87], v[156:159], v[180:195]
    v_exp_f32 v155, v155
    v_cvt_pk_bf16_f32 v160, v148, v149
    v_cvt_pk_bf16_f32 v161, v150, v151
    v_cvt_pk_bf16_f32 v162, v152, v153
    v_cvt_pk_bf16_f32 v163, v154, v155
    s_setprio 2
    v_exp_f32 v124, v124
    s_cmp_lg_u32 s53, 0
    s_cbranch_scc1 K2_l4_16
    s_add_u32 s41, s40, 606208
    buffer_load_dwordx4 v[248:251], v3, s[32:35], s41 offen
K2_l4_16:
    v_exp_f32 v125, v125
    v_mfma_f32_32x32x16_bf16 v[180:195], v[88:91], v[160:163], v[180:195]
    ds_read_b128 v[196:199], v3 offset:9216
    ds_read2st64_b32 v[200:201], v8 offset0:40 offset1:41
    ds_read2st64_b32 v[202:203], v8 offset0:41 offset1:40
    v_exp_f32 v126, v126
    s_cmp_lg_u32 s53, 0
    s_cbranch_scc1 K2_e2c4
    s_waitcnt lgkmcnt(0)
    v_pk_add_f32 v[166:167], v[166:167], v[170:171]
    v_pk_add_f32 v[174:175], v[174:175], v[178:179]
    v_pk_add_f32 v[12:13], v[12:13], v[166:167]
    v_pk_add_f32 v[12:13], v[12:13], v[174:175]
    v_rcp_f32 v170, v13
    v_pk_add_f32 v[164:165], v[164:165], v[168:169]
    v_pk_add_f32 v[172:173], v[172:173], v[176:177]
    v_pk_add_f32 v[10:11], v[10:11], v[164:165]
    v_pk_add_f32 v[10:11], v[10:11], v[172:173]
    v_subrev_u32 v171, 0x21800000, v13
    v_pk_mul_f32 v[10:11], v[10:11], v[170:171] op_sel_hi:[1,0]
    v_cmp_lt_u32 vcc, 1006632960, v171
    v_mul_f32 v12, v170, v12
    v_cvt_pk_bf16_f32 v10, v10, v11
    v_cvt_pk_bf16_f32 v12, v12, v12
    ds_write_b32 v1, v10 offset:16384
    ds_write_b16 v14, v12 offset:512
    s_or_b32 s23, s23, vcc_lo
    s_or_b32 s23, s23, vcc_hi
    s_mov_b64 exec, 1
    ds_add_u32 v8, v9 offset:22192
    s_mov_b64 exec, -1
K2_e2c4:
    v_exp_f32 v127, v127
    v_exp_f32 v128, v128
    s_add_u32 s41, s40, 16384
    buffer_load_dwordx4 v[232:235], v3, s[32:35], s41 offen
    v_exp_f32 v129, v129
    v_exp_f32 v130, v130
    v_mfma_f32_32x32x16_bf16 v[140:155], v[40:43], v[204:207], 0
    v_exp_f32 v131, v131
    v_cvt_pk_bf16_f32 v156, v124, v125
    s_add_u32 s41, s40, 163840
    buffer_load_dwordx4 v[236:239], v3, s[32:35], s41 offen
    v_cvt_pk_bf16_f32 v157, v126, v127
    v_cvt_pk_bf16_f32 v158, v128, v129
    v_cvt_pk_bf16_f32 v159, v130, v131
    v_exp_f32 v132, v132
    v_mfma_f32_32x32x8_bf16 v[140:155], v[56:57], v[210:211], v[140:155]
    s_add_u32 s41, s40, 311296
    buffer_load_dwordx4 v[240:243], v3, s[32:35], s41 offen
    v_exp_f32 v133, v133
    v_exp_f32 v134, v134
    v_exp_f32 v135, v135
    v_exp_f32 v136, v136
    v_exp_f32 v137, v137
    s_add_u32 s41, s40, 458752
    buffer_load_dwordx4 v[244:247], v3, s[32:35], s41 offen
    v_exp_f32 v138, v138
    v_mfma_f32_32x32x16_bf16 v[180:195], v[92:95], v[156:159], v[180:195]
    v_exp_f32 v139, v139
    v_cvt_pk_bf16_f32 v160, v132, v133
    v_cvt_pk_bf16_f32 v161, v134, v135
    v_cvt_pk_bf16_f32 v162, v136, v137
    v_cvt_pk_bf16_f32 v163, v138, v139
    v_exp_f32 v140, v140
    v_exp_f32 v141, v141
    v_mfma_f32_32x32x16_bf16 v[180:195], v[96:99], v[160:163], v[180:195]
    buffer_store_dwordx4 v[4:7], v3, s[8:11], s43 offen sc1
    s_add_u32 s43, s43, 65536
    v_exp_f32 v142, v142
    v_exp_f32 v143, v143
    v_exp_f32 v144, v144
    v_exp_f32 v145, v145
    v_exp_f32 v146, v146
    v_mfma_f32_32x32x16_bf16 v[124:139], v[44:47], v[204:207], 0
    v_exp_f32 v147, v147
    v_cvt_pk_bf16_f32 v156, v140, v141
    v_cvt_pk_bf16_f32 v157, v142, v143
    v_cvt_pk_bf16_f32 v158, v144, v145
    v_cvt_pk_bf16_f32 v159, v146, v147
    v_exp_f32 v148, v148
    v_mfma_f32_32x32x8_bf16 v[124:139], v[58:59], v[208:209], v[124:139]
    v_exp_f32 v149, v149
    v_exp_f32 v150, v150
    v_exp_f32 v151, v151
    v_exp_f32 v152, v152
    v_exp_f32 v153, v153
    v_exp_f32 v154, v154
    v_mfma_f32_32x32x16_bf16 v[180:195], v[100:103], v[156:159], v[180:195]
    v_exp_f32 v155, v155
    ds_read_b128 v[252:255], v9 offset:8192
    v_cvt_pk_bf16_f32 v160, v148, v149
    v_cvt_pk_bf16_f32 v161, v150, v151
    v_cvt_pk_bf16_f32 v162, v152, v153
    v_cvt_pk_bf16_f32 v163, v154, v155
    s_setprio 1
    v_exp_f32 v124, v124
    v_exp_f32 v125, v125
    v_mfma_f32_32x32x16_bf16 v[180:195], v[104:107], v[160:163], v[180:195]
    v_exp_f32 v126, v126
    v_exp_f32 v127, v127
    v_exp_f32 v128, v128
    s_waitcnt vmcnt(1) lgkmcnt(0)
    v_mfma_f32_16x16x32_bf16 v[212:215], v[232:235], v[252:255], v[212:215]
    v_exp_f32 v129, v129
    v_mfma_f32_16x16x32_bf16 v[216:219], v[236:239], v[252:255], v[216:219]
    v_exp_f32 v130, v130
    v_mfma_f32_32x32x16_bf16 v[140:155], v[48:51], v[204:207], 0
    v_exp_f32 v131, v131
    v_cvt_pk_bf16_f32 v156, v124, v125
    v_cvt_pk_bf16_f32 v157, v126, v127
    v_cvt_pk_bf16_f32 v158, v128, v129
    v_mfma_f32_16x16x32_bf16 v[220:223], v[240:243], v[252:255], v[220:223]
    v_cvt_pk_bf16_f32 v159, v130, v131
    v_exp_f32 v132, v132
    v_mfma_f32_32x32x8_bf16 v[140:155], v[58:59], v[210:211], v[140:155]
    v_exp_f32 v133, v133
    v_exp_f32 v134, v134
    v_exp_f32 v135, v135
    v_mfma_f32_16x16x32_bf16 v[224:227], v[244:247], v[252:255], v[224:227]
    v_exp_f32 v136, v136
    s_cmp_lg_u32 s53, 0
    s_cbranch_scc1 K2_m4_16
    v_mfma_f32_16x16x32_bf16 v[228:231], v[248:251], v[252:255], v[228:231]
K2_m4_16:
    v_exp_f32 v137, v137
    v_exp_f32 v138, v138
    v_mfma_f32_32x32x16_bf16 v[180:195], v[108:111], v[156:159], v[180:195]
    v_exp_f32 v139, v139
    v_cvt_pk_bf16_f32 v160, v132, v133
    v_cvt_pk_bf16_f32 v161, v134, v135
    v_cvt_pk_bf16_f32 v162, v136, v137
    v_cvt_pk_bf16_f32 v163, v138, v139
    v_exp_f32 v140, v140
    s_cmp_lg_u32 s53, 0
    s_cbranch_scc1 K2_l4_8
    s_add_u32 s41, s40, 598016
    buffer_load_dwordx4 v[248:251], v3, s[32:35], s41 offen
K2_l4_8:
    v_exp_f32 v141, v141
    v_mfma_f32_32x32x16_bf16 v[180:195], v[112:115], v[160:163], v[180:195]
    v_exp_f32 v142, v142
    v_exp_f32 v143, v143
    v_exp_f32 v144, v144
    s_add_u32 s41, s40, 8192
    buffer_load_dwordx4 v[232:235], v3, s[32:35], s41 offen
    v_exp_f32 v145, v145
    v_exp_f32 v146, v146
    s_waitcnt lgkmcnt(0)
    v_mfma_f32_32x32x16_bf16 v[124:139], v[20:23], v[196:199], 0
    v_exp_f32 v147, v147
    v_cvt_pk_bf16_f32 v156, v140, v141
    s_add_u32 s41, s40, 155648
    buffer_load_dwordx4 v[236:239], v3, s[32:35], s41 offen
    v_cvt_pk_bf16_f32 v157, v142, v143
    v_cvt_pk_bf16_f32 v158, v144, v145
    v_cvt_pk_bf16_f32 v159, v146, v147
    v_exp_f32 v148, v148
    v_mfma_f32_32x32x8_bf16 v[124:139], v[52:53], v[200:201], v[124:139]
    s_add_u32 s41, s40, 303104
    buffer_load_dwordx4 v[240:243], v3, s[32:35], s41 offen
    v_exp_f32 v149, v149
    v_exp_f32 v150, v150
    v_exp_f32 v151, v151
    v_exp_f32 v152, v152
    v_exp_f32 v153, v153
    s_add_u32 s41, s40, 450560
    buffer_load_dwordx4 v[244:247], v3, s[32:35], s41 offen
    v_exp_f32 v154, v154
    v_mfma_f32_32x32x16_bf16 v[180:195], v[116:119], v[156:159], v[180:195]
    v_exp_f32 v155, v155
    v_cvt_pk_bf16_f32 v160, v148, v149
    v_cvt_pk_bf16_f32 v161, v150, v151
    v_cvt_pk_bf16_f32 v162, v152, v153
    v_cvt_pk_bf16_f32 v163, v154, v155
    s_setprio 0
    v_exp_f32 v124, v124
    v_exp_f32 v125, v125
    v_mfma_f32_32x32x16_bf16 v[180:195], v[120:123], v[160:163], v[180:195]
    buffer_store_dwordx4 v[4:7], v3, s[8:11], s43 offen sc1
    s_add_u32 s43, s43, 65536
    v_exp_f32 v126, v126
    v_exp_f32 v127, v127
    v_exp_f32 v128, v128
    v_exp_f32 v129, v129
    v_exp_f32 v130, v130
    v_mfma_f32_32x32x16_bf16 v[140:155], v[24:27], v[196:199], 0
    v_exp_f32 v131, v131
    ds_read_b32 v252, v8 offset:22192
    v_cvt_pk_bf16_f32 v156, v124, v125
    s_add_u32 s42, s55, 0
    s_mov_b32 m0, s42
    s_add_u32 s41, s40, 14336
    buffer_load_dwordx4 v3, s[32:35], s41 offen lds
    v_cvt_pk_bf16_f32 v157, v126, v127
    v_cvt_pk_bf16_f32 v158, v128, v129
    v_cvt_pk_bf16_f32 v159, v130, v131
    v_exp_f32 v132, v132
    v_mfma_f32_32x32x8_bf16 v[140:155], v[52:53], v[202:203], v[140:155]
    v_exp_f32 v133, v133
    ds_write_b128 v16, v[180:183] offset:20480
    v_exp_f32 v134, v134
    v_exp_f32 v135, v135
    s_add_u32 s42, s55, 1024
    s_mov_b32 m0, s42
    s_add_u32 s41, s40, 161792
    buffer_load_dwordx4 v3, s[32:35], s41 offen lds
    v_exp_f32 v136, v136
    v_exp_f32 v137, v137
    ds_write_b128 v16, v[184:187] offset:21504
    v_exp_f32 v138, v138
    v_mfma_f32_32x32x16_bf16 v[164:179], v[60:63], v[156:159], 0
    v_exp_f32 v139, v139
    s_waitcnt lgkmcnt(0)
K2_cr8:
    v_readfirstlane_b32 s41, v252
    s_cmp_ge_u32 s41, 49152
    s_cbranch_scc1 K2_kr8
    s_sleep 2
    ds_read_b32 v252, v8 offset:22192
    s_waitcnt lgkmcnt(0)
    s_branch K2_cr8
K2_kr8:
    ds_read_b128 v[252:255], v9 offset:4096
    v_cvt_pk_bf16_f32 v160, v132, v133
    ds_write_b64 v17, v[188:189] offset:22528
    v_cvt_pk_bf16_f32 v161, v134, v135
    s_mov_b64 exec, 1
    ds_add_u32 v8, v9 offset:22164
    s_mov_b64 exec, -1
    v_cvt_pk_bf16_f32 v162, v136, v137
    v_cvt_pk_bf16_f32 v163, v138, v139
    s_setprio 3
    v_exp_f32 v140, v140
    v_exp_f32 v141, v141
    v_mfma_f32_32x32x16_bf16 v[164:179], v[64:67], v[160:163], v[164:179]
    v_exp_f32 v142, v142
    v_exp_f32 v143, v143
    v_exp_f32 v144, v144
    s_waitcnt vmcnt(3) lgkmcnt(0)
    v_mfma_f32_16x16x32_bf16 v[212:215], v[232:235], v[252:255], v[212:215]
    v_exp_f32 v145, v145
    v_mfma_f32_16x16x32_bf16 v[216:219], v[236:239], v[252:255], v[216:219]
    v_exp_f32 v146, v146
    v_mfma_f32_32x32x16_bf16 v[124:139], v[28:31], v[196:199], 0
    v_exp_f32 v147, v147
    v_cvt_pk_bf16_f32 v156, v140, v141
    v_cvt_pk_bf16_f32 v157, v142, v143
    v_cvt_pk_bf16_f32 v158, v144, v145
    v_mfma_f32_16x16x32_bf16 v[220:223], v[240:243], v[252:255], v[220:223]
    v_cvt_pk_bf16_f32 v159, v146, v147
    v_exp_f32 v148, v148
    v_mfma_f32_32x32x8_bf16 v[124:139], v[54:55], v[200:201], v[124:139]
    v_exp_f32 v149, v149
    v_exp_f32 v150, v150
    v_exp_f32 v151, v151
    v_mfma_f32_16x16x32_bf16 v[224:227], v[244:247], v[252:255], v[224:227]
    v_exp_f32 v152, v152
    s_cmp_lg_u32 s53, 0
    s_cbranch_scc1 K2_m4_8
    v_mfma_f32_16x16x32_bf16 v[228:231], v[248:251], v[252:255], v[228:231]
K2_m4_8:
    v_exp_f32 v153, v153
    v_exp_f32 v154, v154
    v_mfma_f32_32x32x16_bf16 v[164:179], v[68:71], v[156:159], v[164:179]
    v_exp_f32 v155, v155
    v_cvt_pk_bf16_f32 v160, v148, v149
    v_cvt_pk_bf16_f32 v161, v150, v151
    v_cvt_pk_bf16_f32 v162, v152, v153
    v_cvt_pk_bf16_f32 v163, v154, v155
    v_exp_f32 v124, v124
    ds_read_b32 v195, v8 offset:22164
    s_cmp_lg_u32 s53, 0
    s_cbranch_scc1 K2_l4_9
    s_add_u32 s41, s40, 599040
    buffer_load_dwordx4 v[248:251], v3, s[32:35], s41 offen
K2_l4_9:
    v_exp_f32 v125, v125
    v_mfma_f32_32x32x16_bf16 v[164:179], v[72:75], v[160:163], v[164:179]
    v_exp_f32 v126, v126
    v_exp_f32 v127, v127
    v_exp_f32 v128, v128
    s_add_u32 s41, s40, 9216
    buffer_load_dwordx4 v[232:235], v3, s[32:35], s41 offen
    v_exp_f32 v129, v129
    v_exp_f32 v130, v130
    v_mfma_f32_32x32x16_bf16 v[140:155], v[32:35], v[196:199], 0
    v_exp_f32 v131, v131
    v_cvt_pk_bf16_f32 v156, v124, v125
    s_add_u32 s41, s40, 156672
    buffer_load_dwordx4 v[236:239], v3, s[32:35], s41 offen
    v_cvt_pk_bf16_f32 v157, v126, v127
    v_cvt_pk_bf16_f32 v158, v128, v129
    v_cvt_pk_bf16_f32 v159, v130, v131
    v_exp_f32 v132, v132
    s_cmp_lg_u32 s53, 1
    s_cbranch_scc1 K2_e2a5
    s_waitcnt lgkmcnt(0)
K2_cp5:
    v_readfirstlane_b32 s41, v195
    s_cmp_ge_u32 s41, 98304
    s_cbranch_scc1 K2_kp5
    s_sleep 2
    ds_read_b32 v195, v8 offset:22164
    s_waitcnt lgkmcnt(0)
    s_branch K2_cp5
K2_kp5:
    ds_read_b64 v[180:181], v18 offset:20480
    ds_read_b64 v[182:183], v19 offset:22528
    ds_read_b64 v[184:185], v18 offset:23040
    ds_read_b64 v[186:187], v19 offset:25088
    ds_read_b64 v[188:189], v18 offset:25600
    ds_read_b64 v[190:191], v19 offset:27648
    ds_read_b64 v[192:193], v18 offset:28160
    ds_read_b64 v[194:195], v19 offset:30208
K2_e2a5:
    v_mfma_f32_32x32x8_bf16 v[140:155], v[54:55], v[202:203], v[140:155]
    s_add_u32 s41, s40, 304128
    buffer_load_dwordx4 v[240:243], v3, s[32:35], s41 offen
    v_exp_f32 v133, v133
    v_exp_f32 v134, v134
    v_exp_f32 v135, v135
    v_exp_f32 v136, v136
    v_exp_f32 v137, v137
    s_add_u32 s41, s40, 451584
    buffer_load_dwordx4 v[244:247], v3, s[32:35], s41 offen
    v_exp_f32 v138, v138
    v_mfma_f32_32x32x16_bf16 v[164:179], v[76:79], v[156:159], v[164:179]
    v_exp_f32 v139, v139
    v_cvt_pk_bf16_f32 v160, v132, v133
    v_cvt_pk_bf16_f32 v161, v134, v135
    v_cvt_pk_bf16_f32 v162, v136, v137
    v_cvt_pk_bf16_f32 v163, v138, v139
    v_exp_f32 v140, v140
    v_exp_f32 v141, v141
    v_mfma_f32_32x32x16_bf16 v[164:179], v[80:83], v[160:163], v[164:179]
    buffer_store_dwordx4 v[4:7], v3, s[8:11], s43 offen sc1
    s_add_u32 s43, s43, 65536
    v_exp_f32 v142, v142
    v_exp_f32 v143, v143
    v_exp_f32 v144, v144
    v_exp_f32 v145, v145
    v_exp_f32 v146, v146
    v_mfma_f32_32x32x16_bf16 v[124:139], v[36:39], v[196:199], 0
    v_exp_f32 v147, v147
    s_cmp_lg_u32 s53, 1
    s_cbranch_scc1 K2_e2b5
    s_waitcnt lgkmcnt(0)
    v_pk_add_f32 v[180:181], v[180:181], v[184:185]
    v_pk_add_f32 v[188:189], v[188:189], v[192:193]
    v_pk_add_f32 v[182:183], v[182:183], v[186:187]
    v_pk_add_f32 v[190:191], v[190:191], v[194:195]
    v_pk_add_f32 v[10:11], v[180:181], v[188:189]
    v_pk_add_f32 v[12:13], v[182:183], v[190:191]
    ds_read_b64 v[180:181], v18 offset:30720
    ds_read_b64 v[182:183], v19 offset:32768
    ds_read_b64 v[184:185], v18 offset:33280
    ds_read_b64 v[186:187], v19 offset:35328
    ds_read_b64 v[188:189], v18 offset:35840
    ds_read_b64 v[190:191], v19 offset:37888
    ds_read_b64 v[192:193], v18 offset:38400
    ds_read_b64 v[194:195], v19 offset:40448
K2_e2b5:
    v_cvt_pk_bf16_f32 v156, v140, v141
    s_add_u32 s42, s55, 2048
    s_mov_b32 m0, s42
    s_add_u32 s41, s40, 309248
    buffer_load_dwordx4 v3, s[32:35], s41 offen lds
    v_cvt_pk_bf16_f32 v157, v142, v143
    v_cvt_pk_bf16_f32 v158, v144, v145
    v_cvt_pk_bf16_f32 v159, v146, v147
    v_exp_f32 v148, v148
    v_mfma_f32_32x32x8_bf16 v[124:139], v[56:57], v[200:201], v[124:139]
    v_exp_f32 v149, v149
    v_exp_f32 v150, v150
    v_exp_f32 v151, v151
    s_add_u32 s42, s55, 3072
    s_mov_b32 m0, s42
    s_add_u32 s41, s40, 456704
    buffer_load_dwordx4 v3, s[32:35], s41 offen lds
    v_exp_f32 v152, v152
    v_exp_f32 v153, v153
    v_exp_f32 v154, v154
    v_mfma_f32_32x32x16_bf16 v[164:179], v[84:87], v[156:159], v[164:179]
    v_exp_f32 v155, v155
    ds_read_b128 v[252:255], v9 offset:4608
    v_cvt_pk_bf16_f32 v160, v148, v149
    v_cvt_pk_bf16_f32 v161, v150, v151
    v_cvt_pk_bf16_f32 v162, v152, v153
    v_cvt_pk_bf16_f32 v163, v154, v155
    s_setprio 2
    v_exp_f32 v124, v124
    v_exp_f32 v125, v125
    v_mfma_f32_32x32x16_bf16 v[164:179], v[88:91], v[160:163], v[164:179]
    ds_read_b128 v[204:207], v3 offset:10752
    ds_read2st64_b32 v[208:209], v8 offset0:46 offset1:47
    ds_read2st64_b32 v[210:211], v8 offset0:47 offset1:46
    v_exp_f32 v126, v126
    s_cmp_lg_u32 s53, 1
    s_cbranch_scc1 K2_e2c5
    s_waitcnt lgkmcnt(0)
    v_pk_add_f32 v[182:183], v[182:183], v[186:187]
    v_pk_add_f32 v[190:191], v[190:191], v[194:195]
    v_pk_add_f32 v[12:13], v[12:13], v[182:183]
    v_pk_add_f32 v[12:13], v[12:13], v[190:191]
    v_rcp_f32 v186, v13
    v_pk_add_f32 v[180:181], v[180:181], v[184:185]
    v_pk_add_f32 v[188:189], v[188:189], v[192:193]
    v_pk_add_f32 v[10:11], v[10:11], v[180:181]
    v_pk_add_f32 v[10:11], v[10:11], v[188:189]
    v_subrev_u32 v187, 0x21800000, v13
    v_pk_mul_f32 v[10:11], v[10:11], v[186:187] op_sel_hi:[1,0]
    v_cmp_lt_u32 vcc, 1006632960, v187
    v_mul_f32 v12, v186, v12
    v_cvt_pk_bf16_f32 v10, v10, v11
    v_cvt_pk_bf16_f32 v12, v12, v12
    ds_write_b32 v1, v10 offset:17408
    ds_write_b16 v14, v12 offset:640
    s_or_b32 s23, s23, vcc_lo
    s_or_b32 s23, s23, vcc_hi
    s_mov_b64 exec, 1
    ds_add_u32 v8, v9 offset:22196
    s_mov_b64 exec, -1
K2_e2c5:
    v_exp_f32 v127, v127
    v_exp_f32 v128, v128
    s_waitcnt vmcnt(3) lgkmcnt(0)
    v_mfma_f32_16x16x32_bf16 v[212:215], v[232:235], v[252:255], v[212:215]
    v_exp_f32 v129, v129
    v_mfma_f32_16x16x32_bf16 v[216:219], v[236:239], v[252:255], v[216:219]
    v_exp_f32 v130, v130
    v_mfma_f32_32x32x16_bf16 v[140:155], v[40:43], v[196:199], 0
    v_exp_f32 v131, v131
    v_cvt_pk_bf16_f32 v156, v124, v125
    v_cvt_pk_bf16_f32 v157, v126, v127
    v_cvt_pk_bf16_f32 v158, v128, v129
    v_mfma_f32_16x16x32_bf16 v[220:223], v[240:243], v[252:255], v[220:223]
    v_cvt_pk_bf16_f32 v159, v130, v131
    v_exp_f32 v132, v132
    v_mfma_f32_32x32x8_bf16 v[140:155], v[56:57], v[202:203], v[140:155]
    v_exp_f32 v133, v133
    v_exp_f32 v134, v134
    v_exp_f32 v135, v135
    v_mfma_f32_16x16x32_bf16 v[224:227], v[244:247], v[252:255], v[224:227]
    v_exp_f32 v136, v136
    s_cmp_lg_u32 s53, 0
    s_cbranch_scc1 K2_m4_9
    v_mfma_f32_16x16x32_bf16 v[228:231], v[248:251], v[252:255], v[228:231]
K2_m4_9:
    v_exp_f32 v137, v137
    v_exp_f32 v138, v138
    v_mfma_f32_32x32x16_bf16 v[164:179], v[92:95], v[156:159], v[164:179]
    v_exp_f32 v139, v139
    v_cvt_pk_bf16_f32 v160, v132, v133
    v_cvt_pk_bf16_f32 v161, v134, v135
    v_cvt_pk_bf16_f32 v162, v136, v137
    v_cvt_pk_bf16_f32 v163, v138, v139
    v_exp_f32 v140, v140
    s_cmp_lg_u32 s53, 0
    s_cbranch_scc1 K2_l4_10
    s_add_u32 s41, s40, 600064
    buffer_load_dwordx4 v[248:251], v3, s[32:35], s41 offen
K2_l4_10:
    v_exp_f32 v141, v141
    v_mfma_f32_32x32x16_bf16 v[164:179], v[96:99], v[160:163], v[164:179]
    v_exp_f32 v142, v142
    v_exp_f32 v143, v143
    v_exp_f32 v144, v144
    s_add_u32 s41, s40, 10240
    buffer_load_dwordx4 v[232:235], v3, s[32:35], s41 offen
    v_exp_f32 v145, v145
    v_exp_f32 v146, v146
    v_mfma_f32_32x32x16_bf16 v[124:139], v[44:47], v[196:199], 0
    v_exp_f32 v147, v147
    v_cvt_pk_bf16_f32 v156, v140, v141
    s_add_u32 s41, s40, 157696
    buffer_load_dwordx4 v[236:239], v3, s[32:35], s41 offen
    v_cvt_pk_bf16_f32 v157, v142, v143
    v_cvt_pk_bf16_f32 v158, v144, v145
    v_cvt_pk_bf16_f32 v159, v146, v147
    v_exp_f32 v148, v148
    v_mfma_f32_32x32x8_bf16 v[124:139], v[58:59], v[200:201], v[124:139]
    s_add_u32 s41, s40, 305152
    buffer_load_dwordx4 v[240:243], v3, s[32:35], s41 offen
    v_exp_f32 v149, v149
    v_exp_f32 v150, v150
    v_exp_f32 v151, v151
    v_exp_f32 v152, v152
    v_exp_f32 v153, v153
    s_add_u32 s41, s40, 452608
    buffer_load_dwordx4 v[244:247], v3, s[32:35], s41 offen
    v_exp_f32 v154, v154
    v_mfma_f32_32x32x16_bf16 v[164:179], v[100:103], v[156:159], v[164:179]
    v_exp_f32 v155, v155
    v_cvt_pk_bf16_f32 v160, v148, v149
    v_cvt_pk_bf16_f32 v161, v150, v151
    v_cvt_pk_bf16_f32 v162, v152, v153
    v_cvt_pk_bf16_f32 v163, v154, v155
    s_setprio 1
    v_exp_f32 v124, v124
    v_exp_f32 v125, v125
    v_mfma_f32_32x32x16_bf16 v[164:179], v[104:107], v[160:163], v[164:179]
    buffer_store_dwordx4 v[4:7], v3, s[8:11], s43 offen sc1
    s_add_u32 s43, s43, 65536
    v_exp_f32 v126, v126
    v_exp_f32 v127, v127
    v_exp_f32 v128, v128
    v_exp_f32 v129, v129
    v_exp_f32 v130, v130
    v_mfma_f32_32x32x16_bf16 v[140:155], v[48:51], v[196:199], 0
    v_exp_f32 v131, v131
    ds_read_b32 v252, v8 offset:22196
    v_cvt_pk_bf16_f32 v156, v124, v125
    v_cvt_pk_bf16_f32 v157, v126, v127
    v_cvt_pk_bf16_f32 v158, v128, v129
    v_cvt_pk_bf16_f32 v159, v130, v131
    v_exp_f32 v132, v132
    v_mfma_f32_32x32x8_bf16 v[140:155], v[58:59], v[202:203], v[140:155]
    v_exp_f32 v133, v133
    v_exp_f32 v134, v134
    v_exp_f32 v135, v135
    v_exp_f32 v136, v136
    v_exp_f32 v137, v137
    v_exp_f32 v138, v138
    v_mfma_f32_32x32x16_bf16 v[164:179], v[108:111], v[156:159], v[164:179]
    v_exp_f32 v139, v139
    s_waitcnt lgkmcnt(0)
K2_cr10:
    v_readfirstlane_b32 s41, v252
    s_cmp_ge_u32 s41, 49152
    s_cbranch_scc1 K2_kr10
    s_sleep 2
    ds_read_b32 v252, v8 offset:22196
    s_waitcnt lgkmcnt(0)
    s_branch K2_cr10
K2_kr10:
    ds_read_b128 v[252:255], v9 offset:5120
    v_cvt_pk_bf16_f32 v160, v132, v133
    v_cvt_pk_bf16_f32 v161, v134, v135
    v_cvt_pk_bf16_f32 v162, v136, v137
    v_cvt_pk_bf16_f32 v163, v138, v139
    v_exp_f32 v140, v140
    v_exp_f32 v141, v141
    v_mfma_f32_32x32x16_bf16 v[164:179], v[112:115], v[160:163], v[164:179]
    v_exp_f32 v142, v142
    v_exp_f32 v143, v143
    v_exp_f32 v144, v144
    s_waitcnt vmcnt(1) lgkmcnt(0)
    v_mfma_f32_16x16x32_bf16 v[212:215], v[232:235], v[252:255], v[212:215]
    v_exp_f32 v145, v145
    v_mfma_f32_16x16x32_bf16 v[216:219], v[236:239], v[252:255], v[216:219]
    v_exp_f32 v146, v146
    s_waitcnt lgkmcnt(0)
    v_mfma_f32_32x32x16_bf16 v[124:139], v[20:23], v[204:207], 0
    v_exp_f32 v147, v147
    v_cvt_pk_bf16_f32 v156, v140, v141
    v_cvt_pk_bf16_f32 v157, v142, v143
    v_cvt_pk_bf16_f32 v158, v144, v145
    v_mfma_f32_16x16x32_bf16 v[220:223], v[240:243], v[252:255], v[220:223]
    v_cvt_pk_bf16_f32 v159, v146, v147
    v_exp_f32 v148, v148
    v_mfma_f32_32x32x8_bf16 v[124:139], v[52:53], v[208:209], v[124:139]
    v_exp_f32 v149, v149
    v_exp_f32 v150, v150
    v_exp_f32 v151, v151
    v_mfma_f32_16x16x32_bf16 v[224:227], v[244:247], v[252:255], v[224:227]
    v_exp_f32 v152, v152
    s_cmp_lg_u32 s53, 0
    s_cbranch_scc1 K2_m4_10
    v_mfma_f32_16x16x32_bf16 v[228:231], v[248:251], v[252:255], v[228:231]
K2_m4_10:
    v_exp_f32 v153, v153
    v_exp_f32 v154, v154
    v_mfma_f32_32x32x16_bf16 v[164:179], v[116:119], v[156:159], v[164:179]
    v_exp_f32 v155, v155
    v_cvt_pk_bf16_f32 v160, v148, v149
    v_cvt_pk_bf16_f32 v161, v150, v151
    v_cvt_pk_bf16_f32 v162, v152, v153
    v_cvt_pk_bf16_f32 v163, v154, v155
    s_setprio 1
    v_exp_f32 v124, v124
    s_cmp_lg_u32 s53, 0
    s_cbranch_scc1 K2_l4_11
    s_add_u32 s41, s40, 601088
    buffer_load_dwordx4 v[248:251], v3, s[32:35], s41 offen
K2_l4_11:
    v_exp_f32 v125, v125
    v_mfma_f32_32x32x16_bf16 v[164:179], v[120:123], v[160:163], v[164:179]
    s_lshr_b32 s44, s2, 3
    s_bfe_u32 s45, s2, 0x20001
    s_and_b32 s46, s2, 1
    s_lshl_b32 s46, s46, 8
    s_mul_i32 s47, s44, 73728
    s_lshr_b32 s48, s3, 1
    s_lshl_b32 s48, s48, 12
    s_add_u32 s47, s47, s48
    v_exp_f32 v126, v126
    v_exp_f32 v127, v127
    v_exp_f32 v128, v128
    s_add_u32 s41, s40, 11264
    buffer_load_dwordx4 v[232:235], v3, s[32:35], s41 offen
    v_exp_f32 v129, v129
    v_exp_f32 v130, v130
    v_mfma_f32_32x32x16_bf16 v[140:155], v[24:27], v[204:207], 0
    v_exp_f32 v131, v131
    v_cvt_pk_bf16_f32 v156, v124, v125
    s_add_u32 s41, s40, 158720
    buffer_load_dwordx4 v[236:239], v3, s[32:35], s41 offen
    s_lshl_b32 s48, s45, 10
    s_add_u32 s47, s47, s48
    s_and_b32 s48, s3, 1
    s_lshl_b32 s48, s48, 9
    s_add_u32 s47, s47, s48
    s_add_u32 s47, s47, s46
    s_add_u32 s47, s47, 2359296
    v_cvt_pk_bf16_f32 v157, v126, v127
    v_cvt_pk_bf16_f32 v158, v128, v129
    v_cvt_pk_bf16_f32 v159, v130, v131
    v_exp_f32 v132, v132
    v_mfma_f32_32x32x8_bf16 v[140:155], v[52:53], v[210:211], v[140:155]
    s_add_u32 s41, s40, 306176
    buffer_load_dwordx4 v[240:243], v3, s[32:35], s41 offen
    v_exp_f32 v133, v133
    ds_write_b128 v16, v[164:167] offset:0
    v_exp_f32 v134, v134
    v_exp_f32 v135, v135
    s_mul_i32 s49, s44, 36
    s_add_u32 s49, s49, s3
    s_lshl_b32 s49, s49, 11
    s_lshl_b32 s48, s45, 9
    s_add_u32 s49, s49, s48
    s_add_u32 s49, s49, s46
    s_add_u32 s49, s49, 35053568
    v_exp_f32 v136, v136
    v_exp_f32 v137, v137
    ds_write_b128 v16, v[168:171] offset:1024
    s_add_u32 s41, s40, 453632
    buffer_load_dwordx4 v[244:247], v3, s[32:35], s41 offen
    v_exp_f32 v138, v138
    v_mfma_f32_32x32x16_bf16 v[180:195], v[60:63], v[156:159], 0
    v_exp_f32 v139, v139
    v_cvt_pk_bf16_f32 v160, v132, v133
    ds_write_b64 v17, v[172:173] offset:2048
    v_cvt_pk_bf16_f32 v161, v134, v135
    s_mov_b64 exec, 1
    ds_add_u32 v8, v9 offset:22168
    s_mov_b64 exec, -1
    v_cvt_pk_bf16_f32 v162, v136, v137
    v_cvt_pk_bf16_f32 v163, v138, v139
    s_setprio 0
    v_exp_f32 v140, v140
    v_exp_f32 v141, v141
    v_mfma_f32_32x32x16_bf16 v[180:195], v[64:67], v[160:163], v[180:195]
    buffer_store_dwordx4 v[4:7], v3, s[8:11], s43 offen sc1
    s_add_u32 s43, s43, 65536
    v_exp_f32 v142, v142
    v_exp_f32 v143, v143
    v_exp_f32 v144, v144
    v_exp_f32 v145, v145
    v_exp_f32 v146, v146
    v_mfma_f32_32x32x16_bf16 v[124:139], v[28:31], v[204:207], 0
    v_exp_f32 v147, v147
    v_cvt_pk_bf16_f32 v156, v140, v141
    s_add_u32 s42, s55, 8192
    s_mov_b32 m0, s42
    s_add_u32 s41, s40, 457728
    buffer_load_dwordx4 v3, s[32:35], s41 offen lds
    v_cvt_pk_bf16_f32 v157, v142, v143
    v_cvt_pk_bf16_f32 v158, v144, v145
    v_cvt_pk_bf16_f32 v159, v146, v147
    v_exp_f32 v148, v148
    v_mfma_f32_32x32x8_bf16 v[124:139], v[54:55], v[208:209], v[124:139]
    v_exp_f32 v149, v149
    v_exp_f32 v150, v150
    v_exp_f32 v151, v151
    s_add_u32 s42, s55, 9216
    s_mov_b32 m0, s42
    s_add_u32 s41, s40, 605184
    buffer_load_dwordx4 v3, s[32:35], s41 offen lds
    v_exp_f32 v152, v152
    v_exp_f32 v153, v153
    v_exp_f32 v154, v154
    v_mfma_f32_32x32x16_bf16 v[180:195], v[68:71], v[156:159], v[180:195]
    v_exp_f32 v155, v155
    ds_read_b128 v[252:255], v9 offset:5632
    v_cvt_pk_bf16_f32 v160, v148, v149
    v_cvt_pk_bf16_f32 v161, v150, v151
    v_cvt_pk_bf16_f32 v162, v152, v153
    v_cvt_pk_bf16_f32 v163, v154, v155
    s_setprio 3
    v_exp_f32 v124, v124
    ds_read_b32 v179, v8 offset:22168
    v_exp_f32 v125, v125
    v_mfma_f32_32x32x16_bf16 v[180:195], v[72:75], v[160:163], v[180:195]
    v_exp_f32 v126, v126
    v_exp_f32 v127, v127
    v_exp_f32 v128, v128
    s_waitcnt vmcnt(3) lgkmcnt(0)
    v_mfma_f32_16x16x32_bf16 v[212:215], v[232:235], v[252:255], v[212:215]
    v_exp_f32 v129, v129
    v_mfma_f32_16x16x32_bf16 v[216:219], v[236:239], v[252:255], v[216:219]
    v_exp_f32 v130, v130
    v_mfma_f32_32x32x16_bf16 v[140:155], v[32:35], v[204:207], 0
    v_exp_f32 v131, v131
    v_cvt_pk_bf16_f32 v156, v124, v125
    v_cvt_pk_bf16_f32 v157, v126, v127
    v_cvt_pk_bf16_f32 v158, v128, v129
    v_mfma_f32_16x16x32_bf16 v[220:223], v[240:243], v[252:255], v[220:223]
    v_cvt_pk_bf16_f32 v159, v130, v131
    v_exp_f32 v132, v132
    s_cmp_lg_u32 s53, 0
    s_cbranch_scc1 K2_e2a6
    s_waitcnt lgkmcnt(0)
K2_cp6:
    v_readfirstlane_b32 s41, v179
    s_cmp_ge_u32 s41, 98304
    s_cbranch_scc1 K2_kp6
    s_sleep 2
    ds_read_b32 v179, v8 offset:22168
    s_waitcnt lgkmcnt(0)
    s_branch K2_cp6
K2_kp6:
    ds_read_b64 v[164:165], v18 offset:0
    ds_read_b64 v[166:167], v19 offset:2048
    ds_read_b64 v[168:169], v18 offset:2560
    ds_read_b64 v[170:171], v19 offset:4608
    ds_read_b64 v[172:173], v18 offset:5120
    ds_read_b64 v[174:175], v19 offset:7168
    ds_read_b64 v[176:177], v18 offset:7680
    ds_read_b64 v[178:179], v19 offset:9728
K2_e2a6:
    v_mfma_f32_32x32x8_bf16 v[140:155], v[54:55], v[210:211], v[140:155]
    v_exp_f32 v133, v133
    v_exp_f32 v134, v134
    v_exp_f32 v135, v135
    v_mfma_f32_16x16x32_bf16 v[224:227], v[244:247], v[252:255], v[224:227]
    v_exp_f32 v136, v136
    s_cmp_lg_u32 s53, 0
    s_cbranch_scc1 K2_m4_11
    v_mfma_f32_16x16x32_bf16 v[228:231], v[248:251], v[252:255], v[228:231]
K2_m4_11:
    v_exp_f32 v137, v137
    v_exp_f32 v138, v138
    v_mfma_f32_32x32x16_bf16 v[180:195], v[76:79], v[156:159], v[180:195]
    v_exp_f32 v139, v139
    v_cvt_pk_bf16_f32 v160, v132, v133
    v_cvt_pk_bf16_f32 v161, v134, v135
    v_cvt_pk_bf16_f32 v162, v136, v137
    v_cvt_pk_bf16_f32 v163, v138, v139
    v_exp_f32 v140, v140
    s_cmp_lg_u32 s53, 0
    s_cbranch_scc1 K2_l4_12
    s_add_u32 s41, s40, 602112
    buffer_load_dwordx4 v[248:251], v3, s[32:35], s41 offen
K2_l4_12:
    v_exp_f32 v141, v141
    v_mfma_f32_32x32x16_bf16 v[180:195], v[80:83], v[160:163], v[180:195]
    v_exp_f32 v142, v142
    v_exp_f32 v143, v143
    v_exp_f32 v144, v144
    s_add_u32 s41, s40, 12288
    buffer_load_dwordx4 v[232:235], v3, s[32:35], s41 offen
    v_exp_f32 v145, v145
    v_exp_f32 v146, v146
    v_mfma_f32_32x32x16_bf16 v[124:139], v[36:39], v[204:207], 0
    v_exp_f32 v147, v147
    s_cmp_lg_u32 s53, 0
    s_cbranch_scc1 K2_e2b6
    s_waitcnt lgkmcnt(0)
    v_pk_add_f32 v[164:165], v[164:165], v[168:169]
    v_pk_add_f32 v[172:173], v[172:173], v[176:177]
    v_pk_add_f32 v[166:167], v[166:167], v[170:171]
    v_pk_add_f32 v[174:175], v[174:175], v[178:179]
    v_pk_add_f32 v[10:11], v[164:165], v[172:173]
    v_pk_add_f32 v[12:13], v[166:167], v[174:175]
    ds_read_b64 v[164:165], v18 offset:10240
    ds_read_b64 v[166:167], v19 offset:12288
    ds_read_b64 v[168:169], v18 offset:12800
    ds_read_b64 v[170:171], v19 offset:14848
    ds_read_b64 v[172:173], v18 offset:15360
    ds_read_b64 v[174:175], v19 offset:17408
    ds_read_b64 v[176:177], v18 offset:17920
    ds_read_b64 v[178:179], v19 offset:19968
K2_e2b6:
    v_cvt_pk_bf16_f32 v156, v140, v141
    s_add_u32 s41, s40, 159744
    buffer_load_dwordx4 v[236:239], v3, s[32:35], s41 offen
    v_cvt_pk_bf16_f32 v157, v142, v143
    v_cvt_pk_bf16_f32 v158, v144, v145
    v_cvt_pk_bf16_f32 v159, v146, v147
    v_exp_f32 v148, v148
    v_mfma_f32_32x32x8_bf16 v[124:139], v[56:57], v[208:209], v[124:139]
    s_add_u32 s41, s40, 307200
    buffer_load_dwordx4 v[240:243], v3, s[32:35], s41 offen
    v_exp_f32 v149, v149
    v_exp_f32 v150, v150
    v_exp_f32 v151, v151
    v_exp_f32 v152, v152
    v_exp_f32 v153, v153
    s_add_u32 s41, s40, 454656
    buffer_load_dwordx4 v[244:247], v3, s[32:35], s41 offen
    v_exp_f32 v154, v154
    v_mfma_f32_32x32x16_bf16 v[180:195], v[84:87], v[156:159], v[180:195]
    v_exp_f32 v155, v155
    v_cvt_pk_bf16_f32 v160, v148, v149
    v_cvt_pk_bf16_f32 v161, v150, v151
    v_cvt_pk_bf16_f32 v162, v152, v153
    v_cvt_pk_bf16_f32 v163, v154, v155
    s_setprio 2
    v_exp_f32 v124, v124
    s_add_u32 s41, s40, 607232
    buffer_load_dwordx4 v[20:23], v3, s[32:35], s41 offen
    v_exp_f32 v125, v125
    v_mfma_f32_32x32x16_bf16 v[180:195], v[88:91], v[160:163], v[180:195]
    v_exp_f32 v126, v126
    s_cmp_lg_u32 s53, 0
    s_cbranch_scc1 K2_e2c6
    s_waitcnt lgkmcnt(0)
    v_pk_add_f32 v[166:167], v[166:167], v[170:171]
    v_pk_add_f32 v[174:175], v[174:175], v[178:179]
    v_pk_add_f32 v[12:13], v[12:13], v[166:167]
    v_pk_add_f32 v[12:13], v[12:13], v[174:175]
    v_rcp_f32 v170, v13
    v_pk_add_f32 v[164:165], v[164:165], v[168:169]
    v_pk_add_f32 v[172:173], v[172:173], v[176:177]
    v_pk_add_f32 v[10:11], v[10:11], v[164:165]
    v_pk_add_f32 v[10:11], v[10:11], v[172:173]
    v_subrev_u32 v171, 0x21800000, v13
    v_pk_mul_f32 v[10:11], v[10:11], v[170:171] op_sel_hi:[1,0]
    v_cmp_lt_u32 vcc, 1006632960, v171
    v_mul_f32 v12, v170, v12
    v_cvt_pk_bf16_f32 v10, v10, v11
    v_cvt_pk_bf16_f32 v12, v12, v12
    ds_write_b32 v1, v10 offset:18432
    ds_write_b16 v14, v12 offset:768
    s_or_b32 s23, s23, vcc_lo
    s_or_b32 s23, s23, vcc_hi
    s_mov_b64 exec, 1
    ds_add_u32 v8, v9 offset:22200
    s_mov_b64 exec, -1
K2_e2c6:
    v_exp_f32 v127, v127
    v_exp_f32 v128, v128
    s_add_u32 s41, s40, 17408
    buffer_load_dwordx4 v[60:63], v3, s[32:35], s41 offen
    v_exp_f32 v129, v129
    v_exp_f32 v130, v130
    v_mfma_f32_32x32x16_bf16 v[140:155], v[40:43], v[204:207], 0
    v_exp_f32 v131, v131
    v_cvt_pk_bf16_f32 v156, v124, v125
    s_add_u32 s41, s40, 164864
    buffer_load_dwordx4 v[64:67], v3, s[32:35], s41 offen
    v_cvt_pk_bf16_f32 v157, v126, v127
    v_cvt_pk_bf16_f32 v158, v128, v129
    v_cvt_pk_bf16_f32 v159, v130, v131
    v_exp_f32 v132, v132
    v_mfma_f32_32x32x8_bf16 v[140:155], v[56:57], v[210:211], v[140:155]
    s_add_u32 s41, s40, 312320
    buffer_load_dwordx4 v[68:71], v3, s[32:35], s41 offen
    v_exp_f32 v133, v133
    v_exp_f32 v134, v134
    v_exp_f32 v135, v135
    v_exp_f32 v136, v136
    v_exp_f32 v137, v137
    s_add_u32 s41, s40, 459776
    buffer_load_dwordx4 v[72:75], v3, s[32:35], s41 offen
    v_exp_f32 v138, v138
    v_mfma_f32_32x32x16_bf16 v[180:195], v[92:95], v[156:159], v[180:195]
    v_exp_f32 v139, v139
    v_cvt_pk_bf16_f32 v160, v132, v133
    v_cvt_pk_bf16_f32 v161, v134, v135
    v_cvt_pk_bf16_f32 v162, v136, v137
    v_cvt_pk_bf16_f32 v163, v138, v139
    v_exp_f32 v140, v140
    s_cmp_lg_u32 s53, 0
    s_cbranch_scc1 K2_l4_13
    s_add_u32 s41, s40, 603136
    buffer_load_dwordx4 v[24:27], v3, s[32:35], s41 offen
K2_l4_13:
    v_exp_f32 v141, v141
    v_mfma_f32_32x32x16_bf16 v[180:195], v[96:99], v[160:163], v[180:195]
    v_exp_f32 v142, v142
    v_exp_f32 v143, v143
    v_exp_f32 v144, v144
    s_add_u32 s41, s40, 13312
    buffer_load_dwordx4 v[76:79], v3, s[32:35], s41 offen
    v_exp_f32 v145, v145
    v_exp_f32 v146, v146
    v_mfma_f32_32x32x16_bf16 v[124:139], v[44:47], v[204:207], 0
    v_exp_f32 v147, v147
    ds_read_b32 v252, v8 offset:22200
    v_cvt_pk_bf16_f32 v156, v140, v141
    s_add_u32 s41, s40, 160768
    buffer_load_dwordx4 v[80:83], v3, s[32:35], s41 offen
    v_cvt_pk_bf16_f32 v157, v142, v143
    v_cvt_pk_bf16_f32 v158, v144, v145
    v_cvt_pk_bf16_f32 v159, v146, v147
    v_exp_f32 v148, v148
    v_mfma_f32_32x32x8_bf16 v[124:139], v[58:59], v[208:209], v[124:139]
    s_add_u32 s41, s40, 308224
    buffer_load_dwordx4 v[84:87], v3, s[32:35], s41 offen
    v_exp_f32 v149, v149
    v_exp_f32 v150, v150
    v_exp_f32 v151, v151
    v_exp_f32 v152, v152
    v_exp_f32 v153, v153
    s_add_u32 s41, s40, 455680
    buffer_load_dwordx4 v[88:91], v3, s[32:35], s41 offen
    v_exp_f32 v154, v154
    v_mfma_f32_32x32x16_bf16 v[180:195], v[100:103], v[156:159], v[180:195]
    v_exp_f32 v155, v155
    s_waitcnt lgkmcnt(0)
K2_cr12:
    v_readfirstlane_b32 s41, v252
    s_cmp_ge_u32 s41, 49152
    s_cbranch_scc1 K2_kr12
    s_sleep 2
    ds_read_b32 v252, v8 offset:22200
    s_waitcnt lgkmcnt(0)
    s_branch K2_cr12
K2_kr12:
    ds_read_b128 v[252:255], v9 offset:6144
    v_cvt_pk_bf16_f32 v160, v148, v149
    v_cvt_pk_bf16_f32 v161, v150, v151
    v_cvt_pk_bf16_f32 v162, v152, v153
    v_cvt_pk_bf16_f32 v163, v154, v155
    s_setprio 1
    v_exp_f32 v124, v124
    v_exp_f32 v125, v125
    v_mfma_f32_32x32x16_bf16 v[180:195], v[104:107], v[160:163], v[180:195]
    v_add_u32 v7, s55, v3
    v_exp_f32 v126, v126
    v_exp_f32 v127, v127
    v_exp_f32 v128, v128
    s_waitcnt vmcnt(9) lgkmcnt(0)
    v_mfma_f32_16x16x32_bf16 v[212:215], v[232:235], v[252:255], v[212:215]
    v_exp_f32 v129, v129
    v_mfma_f32_16x16x32_bf16 v[216:219], v[236:239], v[252:255], v[216:219]
    ds_read_b128 v[92:95], v7 offset:5120
    v_exp_f32 v130, v130
    v_mfma_f32_32x32x16_bf16 v[140:155], v[48:51], v[204:207], 0
    v_exp_f32 v131, v131
    v_cvt_pk_bf16_f32 v156, v124, v125
    ds_read_b128 v[96:99], v7 offset:6144
    v_cvt_pk_bf16_f32 v157, v126, v127
    v_cvt_pk_bf16_f32 v158, v128, v129
    v_mfma_f32_16x16x32_bf16 v[220:223], v[240:243], v[252:255], v[220:223]
    v_cvt_pk_bf16_f32 v159, v130, v131
    v_exp_f32 v132, v132
    ds_read_b128 v[28:31], v7 offset:7168
    v_mfma_f32_32x32x8_bf16 v[140:155], v[58:59], v[210:211], v[140:155]
    v_exp_f32 v133, v133
    v_exp_f32 v134, v134
    v_exp_f32 v135, v135
    v_mfma_f32_16x16x32_bf16 v[224:227], v[244:247], v[252:255], v[224:227]
    ds_read_b128 v[32:35], v7 offset:8192
    v_exp_f32 v136, v136
    s_cmp_lg_u32 s53, 0
    s_cbranch_scc1 K2_m4_12
    v_mfma_f32_16x16x32_bf16 v[228:231], v[248:251], v[252:255], v[228:231]
K2_m4_12:
    v_exp_f32 v137, v137
    v_exp_f32 v138, v138
    v_mfma_f32_32x32x16_bf16 v[180:195], v[108:111], v[156:159], v[180:195]
    ds_read_b128 v[36:39], v7 offset:9216
    v_exp_f32 v139, v139
    v_cvt_pk_bf16_f32 v160, v132, v133
    v_cvt_pk_bf16_f32 v161, v134, v135
    v_cvt_pk_bf16_f32 v162, v136, v137
    v_cvt_pk_bf16_f32 v163, v138, v139
    ds_read_b128 v[252:255], v9 offset:6656
    s_setprio 0
    v_exp_f32 v140, v140
    v_exp_f32 v141, v141
    v_mfma_f32_32x32x16_bf16 v[180:195], v[112:115], v[160:163], v[180:195]
    ds_read_b64 v[124:125], v15 offset:0
    v_exp_f32 v142, v142
    v_exp_f32 v143, v143
    ds_read_b64 v[126:127], v15 offset:256
    v_exp_f32 v144, v144
    s_waitcnt vmcnt(0) lgkmcnt(0)
    v_mfma_f32_16x16x32_bf16 v[212:215], v[76:79], v[252:255], v[212:215]
    v_exp_f32 v145, v145
    v_mfma_f32_16x16x32_bf16 v[216:219], v[80:83], v[252:255], v[216:219]
    ds_read_b64 v[128:129], v15 offset:512
    v_exp_f32 v146, v146
    s_nop 0
    ds_read_b64 v[130:131], v15 offset:768
    v_exp_f32 v147, v147
    v_cvt_pk_bf16_f32 v156, v140, v141
    ds_read_b64 v[132:133], v15 offset:1024
    v_cvt_pk_bf16_f32 v157, v142, v143
    v_cvt_pk_bf16_f32 v158, v144, v145
    v_mfma_f32_16x16x32_bf16 v[220:223], v[84:87], v[252:255], v[220:223]
    v_cvt_pk_bf16_f32 v159, v146, v147
    v_exp_f32 v148, v148
    s_nop 0
    ds_read_b128 v[232:235], v7 offset:0
    v_exp_f32 v149, v149
    v_exp_f32 v150, v150
    ds_read_b128 v[236:239], v7 offset:1024
    v_exp_f32 v151, v151
    v_mfma_f32_16x16x32_bf16 v[224:227], v[88:91], v[252:255], v[224:227]
    v_exp_f32 v152, v152
    s_cmp_lg_u32 s53, 0
    s_cbranch_scc1 K2_m4_13
    v_mfma_f32_16x16x32_bf16 v[228:231], v[24:27], v[252:255], v[228:231]
K2_m4_13:
    ds_read_b128 v[240:243], v7 offset:2048
    v_exp_f32 v153, v153
    v_exp_f32 v154, v154
    ds_read_b128 v[244:247], v7 offset:3072
    v_mfma_f32_32x32x16_bf16 v[180:195], v[116:119], v[156:159], v[180:195]
    v_exp_f32 v155, v155
    ds_read_b128 v[248:251], v7 offset:4096
    v_cvt_pk_bf16_f32 v160, v148, v149
    v_cvt_pk_bf16_f32 v161, v150, v151
    v_cvt_pk_bf16_f32 v162, v152, v153
    v_cvt_pk_bf16_f32 v163, v154, v155
    s_setprio 3
    s_nop 0
    v_mfma_f32_32x32x16_bf16 v[180:195], v[120:123], v[160:163], v[180:195]
    v_bfe_u32 v197, v0, 4, 2
    v_and_b32 v198, 7, v0
    v_lshlrev_b32 v199, 6, v197
    v_lshl_add_u32 v199, v198, 3, v199
    v_and_b32 v200, 8, v0
    v_cmp_eq_u32 s[50:51], 0, v200
    v_mov_b32 v200, s47
    v_mov_b32 v201, s49
    v_cndmask_b32_e64 v200, v200, v201, s[50:51]
    v_add_u32 v199, v199, v200
    v_lshlrev_b32 v200, 3, v198
    v_add_u32 v200, 21504, v200
    ds_write_b128 v16, v[180:183] offset:20480
    ds_write_b128 v16, v[184:187] offset:21504
    ds_write_b64 v17, v[188:189] offset:22528
    s_lshl_b32 s17, s3, 6
    v_add_u32 v201, s17, v200
    v_lshlrev_b32 v202, 2, v198
    s_cmp_lt_u32 s3, 4
    s_cselect_b32 s17, -1, 0
    s_waitcnt lgkmcnt(0)
    s_barrier
    s_cbranch_scc1 K2_t1
    ds_read_b64 v[164:165], v18 offset:20480
    ds_read_b64 v[166:167], v19 offset:22528
    ds_read_b64 v[168:169], v18 offset:23040
    ds_read_b64 v[170:171], v19 offset:25088
    ds_read_b64 v[172:173], v18 offset:25600
    ds_read_b64 v[174:175], v19 offset:27648
    ds_read_b64 v[176:177], v18 offset:28160
    ds_read_b64 v[178:179], v19 offset:30208
    ds_read_b64 v[180:181], v18 offset:30720
    ds_read_b64 v[182:183], v19 offset:32768
    ds_read_b64 v[184:185], v18 offset:33280
    ds_read_b64 v[186:187], v19 offset:35328
    ds_read_b64 v[188:189], v18 offset:35840
    ds_read_b64 v[190:191], v19 offset:37888
    ds_read_b64 v[192:193], v18 offset:38400
    ds_read_b64 v[194:195], v19 offset:40448
K2_t1:
    v_lshlrev_b32 v204, 6, v197
    v_lshl_add_u32 v204, v198, 3, v204
    v_and_b32 v205, 8, v0
    v_lshl_add_u32 v204, v205, 5, v204
    v_add_u32 v204, s55, v204
    v_and_b32 v205, 16, v0
    v_cmp_eq_u32 vcc, 0, v205
    v_mov_b32 v205, s47
    v_mov_b32 v206, s49
    v_cndmask_b32 v205, v205, v206, vcc
    v_bfe_u32 v206, v0, 5, 1
    v_lshl_add_u32 v205, v206, 14, v205
    v_and_b32 v206, 15, v0
    v_lshl_add_u32 v205, v206, 4, v205
    v_and_b32 v132, s17, v132
    v_and_b32 v133, s17, v133
    v_lshlrev_b32 v140, 16, v124
    v_and_b32 v141, 0xffff0000, v124
    v_pk_add_f32 v[212:213], v[212:213], v[140:141]
    v_lshlrev_b32 v142, 16, v125
    v_and_b32 v143, 0xffff0000, v125
    v_pk_add_f32 v[214:215], v[214:215], v[142:143]
    v_lshlrev_b32 v144, 16, v126
    v_and_b32 v145, 0xffff0000, v126
    v_pk_add_f32 v[216:217], v[216:217], v[144:145]
    v_lshlrev_b32 v146, 16, v127
    v_and_b32 v147, 0xffff0000, v127
    v_pk_add_f32 v[218:219], v[218:219], v[146:147]
    v_lshlrev_b32 v140, 16, v128
    v_and_b32 v141, 0xffff0000, v128
    v_pk_add_f32 v[220:221], v[220:221], v[140:141]
    v_lshlrev_b32 v142, 16, v129
    v_and_b32 v143, 0xffff0000, v129
    v_pk_add_f32 v[222:223], v[222:223], v[142:143]
    v_lshlrev_b32 v144, 16, v130
    v_and_b32 v145, 0xffff0000, v130
    v_pk_add_f32 v[224:225], v[224:225], v[144:145]
    v_lshlrev_b32 v146, 16, v131
    v_and_b32 v147, 0xffff0000, v131
    v_pk_add_f32 v[226:227], v[226:227], v[146:147]
    v_lshlrev_b32 v140, 16, v132
    v_and_b32 v141, 0xffff0000, v132
    v_pk_add_f32 v[228:229], v[228:229], v[140:141]
    v_lshlrev_b32 v142, 16, v133
    v_and_b32 v143, 0xffff0000, v133
    v_pk_add_f32 v[230:231], v[230:231], v[142:143]
    s_cbranch_scc1 K2_t2
    s_waitcnt lgkmcnt(0)
    v_pk_add_f32 v[166:167], v[166:167], v[170:171]
    v_pk_add_f32 v[174:175], v[174:175], v[178:179]
    v_pk_add_f32 v[182:183], v[182:183], v[186:187]
    v_pk_add_f32 v[190:191], v[190:191], v[194:195]
    v_pk_add_f32 v[164:165], v[164:165], v[168:169]
    v_pk_add_f32 v[172:173], v[172:173], v[176:177]
    v_pk_add_f32 v[180:181], v[180:181], v[184:185]
    v_pk_add_f32 v[188:189], v[188:189], v[192:193]
    v_pk_add_f32 v[166:167], v[166:167], v[174:175]
    v_pk_add_f32 v[182:183], v[182:183], v[190:191]
    v_pk_add_f32 v[164:165], v[164:165], v[172:173]
    v_pk_add_f32 v[180:181], v[180:181], v[188:189]
    v_pk_add_f32 v[166:167], v[166:167], v[182:183]
    v_rcp_f32 v170, v167
    v_pk_add_f32 v[164:165], v[164:165], v[180:181]
    v_subrev_u32 v171, 0x21800000, v167
    v_pk_mul_f32 v[164:165], v[164:165], v[170:171] op_sel_hi:[1,0]
    v_cmp_lt_u32 vcc, 1006632960, v171
    v_mul_f32 v166, v170, v166
    v_cvt_pk_bf16_f32 v164, v164, v165
    v_cvt_pk_bf16_f32 v166, v166, v166
    ds_write_b32 v1, v164 offset:19456
    ds_write_b16 v14, v166 offset:896
    s_or_b32 s23, s23, vcc_lo
    s_or_b32 s23, s23, vcc_hi
    s_waitcnt lgkmcnt(0)
K2_t2:
    s_barrier
    ds_read_b128 v[252:255], v9 offset:7168
    ds_read_b128 v[156:159], v9 offset:7680
    ds_read_b128 v[160:163], v9 offset:8704
    s_lshl_b32 s17, s3, 2
    s_add_u32 s17, s17, 22016
    v_mov_b32 v10, s17
    v_mov_b32 v11, s23
    s_mov_b64 exec, 1
    ds_write_b32 v10, v11
    s_mov_b64 exec, -1
    s_waitcnt vmcnt(4) lgkmcnt(1)
    v_mfma_f32_16x16x32_bf16 v[212:215], v[232:235], v[252:255], v[212:215]
    v_mfma_f32_16x16x32_bf16 v[212:215], v[92:95], v[156:159], v[212:215]
    v_mfma_f32_16x16x32_bf16 v[212:215], v[60:63], v[160:163], v[212:215]
    v_mfma_f32_16x16x32_bf16 v[216:219], v[236:239], v[252:255], v[216:219]
    v_mfma_f32_16x16x32_bf16 v[216:219], v[96:99], v[156:159], v[216:219]
    v_mfma_f32_16x16x32_bf16 v[216:219], v[64:67], v[160:163], v[216:219]
    v_mfma_f32_16x16x32_bf16 v[220:223], v[240:243], v[252:255], v[220:223]
    v_mfma_f32_16x16x32_bf16 v[220:223], v[28:31], v[156:159], v[220:223]
    v_mfma_f32_16x16x32_bf16 v[220:223], v[68:71], v[160:163], v[220:223]
    v_mfma_f32_16x16x32_bf16 v[224:227], v[244:247], v[252:255], v[224:227]
    v_mfma_f32_16x16x32_bf16 v[224:227], v[32:35], v[156:159], v[224:227]
    v_mfma_f32_16x16x32_bf16 v[224:227], v[72:75], v[160:163], v[224:227]
    v_mfma_f32_16x16x32_bf16 v[228:231], v[248:251], v[252:255], v[228:231]
    v_mfma_f32_16x16x32_bf16 v[228:231], v[36:39], v[156:159], v[228:231]
    v_mfma_f32_16x16x32_bf16 v[228:231], v[20:23], v[160:163], v[228:231]
    v_pk_mul_f32 v[174:175], v[212:213], v[212:213]
    v_pk_add_f32 v[172:173], v[212:213], v[214:215]
    v_pk_fma_f32 v[174:175], v[214:215], v[214:215], v[174:175]
    v_pk_add_f32 v[172:173], v[172:173], v[216:217]
    v_pk_fma_f32 v[174:175], v[216:217], v[216:217], v[174:175]
    v_pk_add_f32 v[172:173], v[172:173], v[218:219]
    v_pk_fma_f32 v[174:175], v[218:219], v[218:219], v[174:175]
    v_pk_add_f32 v[172:173], v[172:173], v[220:221]
    v_pk_fma_f32 v[174:175], v[220:221], v[220:221], v[174:175]
    v_pk_add_f32 v[172:173], v[172:173], v[222:223]
    v_pk_fma_f32 v[174:175], v[222:223], v[222:223], v[174:175]
    v_pk_add_f32 v[172:173], v[172:173], v[224:225]
    v_pk_fma_f32 v[174:175], v[224:225], v[224:225], v[174:175]
    v_pk_add_f32 v[172:173], v[172:173], v[226:227]
    v_pk_fma_f32 v[174:175], v[226:227], v[226:227], v[174:175]
    v_pk_add_f32 v[172:173], v[172:173], v[228:229]
    v_pk_fma_f32 v[174:175], v[228:229], v[228:229], v[174:175]
    v_pk_add_f32 v[172:173], v[172:173], v[230:231]
    v_pk_fma_f32 v[174:175], v[230:231], v[230:231], v[174:175]
    v_add_f32 v172, v172, v173
    v_add_f32 v173, v174, v175
    v_mov_b32 v174, v172
    v_mov_b32 v175, v173
    s_nop 0
    v_permlane16_swap_b32 v172, v174
    v_permlane16_swap_b32 v173, v175
    s_nop 0
    v_pk_add_f32 v[172:173], v[172:173], v[174:175]
    v_mov_b32 v174, v172
    v_mov_b32 v175, v173
    s_nop 0
    v_permlane32_swap_b32 v172, v174
    v_permlane32_swap_b32 v173, v175
    s_nop 0
    v_pk_add_f32 v[172:173], v[172:173], v[174:175]
    s_mov_b64 exec, 0xff
    ds_write_b64 v201, v[172:173]
    s_mov_b64 exec, -1
    s_waitcnt lgkmcnt(0)
    s_barrier
    ds_read_b64 v[140:141], v200 offset:0
    ds_read_b64 v[142:143], v200 offset:64
    ds_read_b64 v[144:145], v200 offset:128
    ds_read_b64 v[146:147], v200 offset:192
    ds_read_b64 v[148:149], v200 offset:256
    ds_read_b64 v[150:151], v200 offset:320
    ds_read_b64 v[152:153], v200 offset:384
    ds_read_b64 v[154:155], v200 offset:448
    ds_read_b32 v176, v202 offset:22016
    v_mov_b32 v174, 0x3727c5ac
    s_waitcnt lgkmcnt(0)
    v_cmp_ne_u32 vcc, 0, v176
    v_pk_add_f32 v[140:141], v[140:141], v[142:143]
    v_pk_add_f32 v[144:145], v[144:145], v[146:147]
    v_pk_add_f32 v[148:149], v[148:149], v[150:151]
    v_pk_add_f32 v[152:153], v[152:153], v[154:155]
    v_pk_add_f32 v[140:141], v[140:141], v[144:145]
    v_pk_add_f32 v[148:149], v[148:149], v[152:153]
    v_pk_add_f32 v[172:173], v[140:141], v[148:149]
    s_mov_b32 s23, vcc_lo
    v_mul_f32 v172, 0xbae38e39, v172
    v_fmac_f32 v174, 0x3ae38e39, v173
    v_fma_f32 v174, -v172, v172, v174
    v_max_f32 v174, 0x3727c5ac, v174
    v_rsq_f32 v174, v174
    s_cmp_lg_u32 s22, 0
    s_cselect_b32 s23, 0, s23
    s_cmp_lg_u32 s23, 0
    s_cbranch_scc1 K2_slow
    v_mul_f32 v172, v172, v174
    v_cndmask_b32_e64 v174, v174, 1.0, s[50:51]
    v_cndmask_b32_e64 v172, v172, 0, s[50:51]
    s_cmp_ge_u32 s3, 4
    s_cbranch_scc1 K2_no4
    v_pk_fma_f32 v[228:229], v[228:229], v[174:175], v[172:173] op_sel_hi:[1,0,0]
    v_pk_fma_f32 v[230:231], v[230:231], v[174:175], v[172:173] op_sel_hi:[1,0,0]
    v_cvt_pk_bf16_f32 v132, v228, v229
    v_cvt_pk_bf16_f32 v133, v230, v231
    s_mov_b32 s17, 65536
    buffer_store_dwordx2 v[132:133], v199, s[8:11], s17 offen sc1
K2_no4:
    v_pk_fma_f32 v[212:213], v[212:213], v[174:175], v[172:173] op_sel_hi:[1,0,0]
    v_pk_fma_f32 v[214:215], v[214:215], v[174:175], v[172:173] op_sel_hi:[1,0,0]
    v_cvt_pk_bf16_f32 v124, v212, v213
    v_cvt_pk_bf16_f32 v125, v214, v215
    s_mov_b32 s17, 0
    buffer_store_dwordx2 v[124:125], v199, s[8:11], s17 offen sc1
    v_pk_fma_f32 v[216:217], v[216:217], v[174:175], v[172:173] op_sel_hi:[1,0,0]
    v_pk_fma_f32 v[218:219], v[218:219], v[174:175], v[172:173] op_sel_hi:[1,0,0]
    v_cvt_pk_bf16_f32 v126, v216, v217
    v_cvt_pk_bf16_f32 v127, v218, v219
    s_mov_b32 s17, 16384
    buffer_store_dwordx2 v[126:127], v199, s[8:11], s17 offen sc1
    v_pk_fma_f32 v[220:221], v[220:221], v[174:175], v[172:173] op_sel_hi:[1,0,0]
    v_pk_fma_f32 v[222:223], v[222:223], v[174:175], v[172:173] op_sel_hi:[1,0,0]
    v_cvt_pk_bf16_f32 v128, v220, v221
    v_cvt_pk_bf16_f32 v129, v222, v223
    s_mov_b32 s17, 32768
    buffer_store_dwordx2 v[128:129], v199, s[8:11], s17 offen sc1
    v_pk_fma_f32 v[224:225], v[224:225], v[174:175], v[172:173] op_sel_hi:[1,0,0]
    v_pk_fma_f32 v[226:227], v[226:227], v[174:175], v[172:173] op_sel_hi:[1,0,0]
    v_cvt_pk_bf16_f32 v130, v224, v225
    v_cvt_pk_bf16_f32 v131, v226, v227
    s_mov_b32 s17, 49152
    buffer_store_dwordx2 v[130:131], v199, s[8:11], s17 offen sc1
    s_endpgm
K2_slow:
    s_waitcnt vmcnt(0)
    s_barrier
    buffer_load_dwordx4 v[20:23], v3, s[12:15], s24 offen
    buffer_load_dwordx4 v[24:27], v3, s[12:15], s25 offen
    buffer_load_dwordx4 v[28:31], v3, s[12:15], s26 offen
    buffer_load_dwordx4 v[32:35], v3, s[12:15], s27 offen
    buffer_load_dwordx4 v[36:39], v3, s[12:15], s28 offen
    buffer_load_dwordx4 v[40:43], v3, s[12:15], s29 offen
    buffer_load_dwordx4 v[44:47], v3, s[12:15], s30 offen
    buffer_load_dwordx4 v[48:51], v3, s[12:15], s31 offen
    v_and_b32 v10, 31, v0
    v_lshlrev_b32 v10, 2, v10
    v_add_u32 v10, 22528, v10
    v_mov_b32 v11, 0xff800000
    s_lshl_b32 s17, s3, 7
    v_add_u32 v12, s17, v10
    ds_write_b32 v12, v11
    v_mov_b32 v13, v3
    v_mov_b32 v18, v8
    s_mov_b32 s17, 0
    s_waitcnt vmcnt(0) lgkmcnt(0)
    s_barrier
K2_mx:
    ds_read_b128 v[196:199], v13 offset:0
    ds_read2st64_b32 v[200:201], v18 offset0:4 offset1:5
    ds_read2st64_b32 v[202:203], v18 offset0:5 offset1:4
    v_mov_b32 v11, 0xff800000
    s_waitcnt lgkmcnt(0)
    v_mfma_f32_32x32x16_bf16 v[124:139], v[20:23], v[196:199], 0
    v_mfma_f32_32x32x8_bf16 v[124:139], v[52:53], v[200:201], v[124:139]
    s_nop 7
    s_nop 7
    v_max3_f32 v11, v11, v124, v125
    v_max3_f32 v11, v11, v126, v127
    v_max3_f32 v11, v11, v128, v129
    v_max3_f32 v11, v11, v130, v131
    v_max3_f32 v11, v11, v132, v133
    v_max3_f32 v11, v11, v134, v135
    v_max3_f32 v11, v11, v136, v137
    v_max3_f32 v11, v11, v138, v139
    v_mfma_f32_32x32x16_bf16 v[140:155], v[24:27], v[196:199], 0
    v_mfma_f32_32x32x8_bf16 v[140:155], v[52:53], v[202:203], v[140:155]
    s_nop 7
    s_nop 7
    v_max3_f32 v11, v11, v140, v141
    v_max3_f32 v11, v11, v142, v143
    v_max3_f32 v11, v11, v144, v145
    v_max3_f32 v11, v11, v146, v147
    v_max3_f32 v11, v11, v148, v149
    v_max3_f32 v11, v11, v150, v151
    v_max3_f32 v11, v11, v152, v153
    v_max3_f32 v11, v11, v154, v155
    v_mfma_f32_32x32x16_bf16 v[124:139], v[28:31], v[196:199], 0
    v_mfma_f32_32x32x8_bf16 v[124:139], v[54:55], v[200:201], v[124:139]
    s_nop 7
    s_nop 7
    v_max3_f32 v11, v11, v124, v125
    v_max3_f32 v11, v11, v126, v127
    v_max3_f32 v11, v11, v128, v129
    v_max3_f32 v11, v11, v130, v131
    v_max3_f32 v11, v11, v132, v133
    v_max3_f32 v11, v11, v134, v135
    v_max3_f32 v11, v11, v136, v137
    v_max3_f32 v11, v11, v138, v139
    v_mfma_f32_32x32x16_bf16 v[140:155], v[32:35], v[196:199], 0
    v_mfma_f32_32x32x8_bf16 v[140:155], v[54:55], v[202:203], v[140:155]
    s_nop 7
    s_nop 7
    v_max3_f32 v11, v11, v140, v141
    v_max3_f32 v11, v11, v142, v143
    v_max3_f32 v11, v11, v144, v145
    v_max3_f32 v11, v11, v146, v147
    v_max3_f32 v11, v11, v148, v149
    v_max3_f32 v11, v11, v150, v151
    v_max3_f32 v11, v11, v152, v153
    v_max3_f32 v11, v11, v154, v155
    v_mfma_f32_32x32x16_bf16 v[124:139], v[36:39], v[196:199], 0
    v_mfma_f32_32x32x8_bf16 v[124:139], v[56:57], v[200:201], v[124:139]
    s_nop 7
    s_nop 7
    v_max3_f32 v11, v11, v124, v125
    v_max3_f32 v11, v11, v126, v127
    v_max3_f32 v11, v11, v128, v129
    v_max3_f32 v11, v11, v130, v131
    v_max3_f32 v11, v11, v132, v133
    v_max3_f32 v11, v11, v134, v135
    v_max3_f32 v11, v11, v136, v137
    v_max3_f32 v11, v11, v138, v139
    v_mfma_f32_32x32x16_bf16 v[140:155], v[40:43], v[196:199], 0
    v_mfma_f32_32x32x8_bf16 v[140:155], v[56:57], v[202:203], v[140:155]
    s_nop 7
    s_nop 7
    v_max3_f32 v11, v11, v140, v141
    v_max3_f32 v11, v11, v142, v143
    v_max3_f32 v11, v11, v144, v145
    v_max3_f32 v11, v11, v146, v147
    v_max3_f32 v11, v11, v148, v149
    v_max3_f32 v11, v11, v150, v151
    v_max3_f32 v11, v11, v152, v153
    v_max3_f32 v11, v11, v154, v155
    v_mfma_f32_32x32x16_bf16 v[124:139], v[44:47], v[196:199], 0
    v_mfma_f32_32x32x8_bf16 v[124:139], v[58:59], v[200:201], v[124:139]
    s_nop 7
    s_nop 7
    v_max3_f32 v11, v11, v124, v125
    v_max3_f32 v11, v11, v126, v127
    v_max3_f32 v11, v11, v128, v129
    v_max3_f32 v11, v11, v130, v131
    v_max3_f32 v11, v11, v132, v133
    v_max3_f32 v11, v11, v134, v135
    v_max3_f32 v11, v11, v136, v137
    v_max3_f32 v11, v11, v138, v139
    v_mfma_f32_32x32x16_bf16 v[140:155], v[48:51], v[196:199], 0
    v_mfma_f32_32x32x8_bf16 v[140:155], v[58:59], v[202:203], v[140:155]
    s_nop 7
    s_nop 7
    v_max3_f32 v11, v11, v140, v141
    v_max3_f32 v11, v11, v142, v143
    v_max3_f32 v11, v11, v144, v145
    v_max3_f32 v11, v11, v146, v147
    v_max3_f32 v11, v11, v148, v149
    v_max3_f32 v11, v11, v150, v151
    v_max3_f32 v11, v11, v152, v153
    v_max3_f32 v11, v11, v154, v155
    ds_max_f32 v10, v11
    v_add_u32 v10, 128, v10
    v_add_u32 v13, 1536, v13
    v_add_u32 v18, 1536, v18
    s_add_u32 s17, s17, 1
    s_cmp_lt_u32 s17, 8
    s_cbranch_scc1 K2_mx
    s_waitcnt lgkmcnt(0)
    s_barrier
    ds_read_b32 v11, v12
    s_mul_i32 s17, s3, 1536
    v_add_u32 v13, s17, v8
    s_waitcnt lgkmcnt(0)
    v_sub_f32 v11, 0, v11
    v_and_b32 v124, 0xffff0000, v11
    v_sub_f32 v11, v11, v124
    v_and_b32 v125, 0xffff0000, v11
    v_sub_f32 v11, v11, v125
    v_lshrrev_b32 v124, 16, v124
    v_or_b32 v124, v124, v125
    v_lshrrev_b32 v125, 16, v11
    s_not_b64 exec, s[20:21]
    ds_write_b32 v13, v124 offset:1024
    ds_write_b32 v13, v125 offset:1280
    s_mov_b64 exec, -1
    s_mov_b32 s22, 1
    s_waitcnt lgkmcnt(0)
    s_barrier
    s_branch K2_main
K2_end:
    s_endpgm
.globl k3_kernel
.p2align 8
.type k3_kernel,@function
k3_kernel:
    s_cmp_lt_u32 s2, 256
    s_cbranch_scc1 K3_run
    s_endpgm
K3_run:
    s_load_dwordx2 s[4:5], s[0:1], 96
    s_load_dwordx2 s[6:7], s[0:1], 56
    s_load_dwordx4 s[24:27], s[0:1], 72
    v_lshrrev_b32 v1, 6, v0
    v_and_b32 v2, 63, v0
    v_readfirstlane_b32 s3, v1
    v_and_b32 v3, 15, v0
    v_bfe_u32 v4, v0, 4, 2
    v_lshlrev_b32 v5, 4, v2
    v_add_u32 v6, 4096, v5
    v_add_u32 v7, 8192, v5
    v_add_u32 v8, 12288, v5
    v_add_u32 v9, 16384, v5
    v_lshlrev_b32 v12, 3, v4
    v_and_b32 v10, 0x23, v2
    v_lshlrev_b32 v10, 4, v10
    v_bfe_u32 v11, v2, 3, 2
    v_lshl_add_u32 v10, v11, 6, v10
    v_bfe_u32 v11, v2, 2, 1
    v_lshl_add_u32 v10, v11, 8, v10
    s_and_b32 s28, s2, 7
    s_lshr_b32 s29, s2, 3
    s_mul_i32 s31, s29, 73728
    s_lshl_b32 s30, s3, 10
    s_add_u32 s31, s31, s30
    s_add_u32 s31, s31, 2359296
    s_mul_i32 s60, s28, 36
    s_mul_i32 s59, s3, 9
    s_mul_i32 s61, s29, 57
    s_lshr_b32 s61, s61, 9
    s_mul_i32 s61, s61, 9
    s_sub_u32 s61, s29, s61
    s_add_u32 s50, s61, 0
    s_cmp_ge_u32 s50, 9
    s_cselect_b32 s62, 9, 0
    s_sub_u32 s50, s50, s62
    s_add_u32 s50, s50, s59
    s_add_u32 s62, s50, s60
    s_mul_i32 s62, s62, 18432
    s_add_u32 s32, s62, 5562368
    s_add_u32 s51, s61, 1
    s_cmp_ge_u32 s51, 9
    s_cselect_b32 s62, 9, 0
    s_sub_u32 s51, s51, s62
    s_add_u32 s51, s51, s59
    s_add_u32 s62, s51, s60
    s_mul_i32 s62, s62, 18432
    s_add_u32 s33, s62, 5562368
    s_waitcnt lgkmcnt(0)
    s_mov_b32 s8, s4
    s_mov_b32 s9, s5
    s_mov_b32 s10, 268435456
    s_mov_b32 s11, 0x00020000
    s_mov_b32 s12, s6
    s_mov_b32 s13, s7
    s_mov_b32 s14, 9216
    s_mov_b32 s15, 0x00020000
    s_cmp_lg_u32 s3, 3
    s_cbranch_scc1 K3_nopf
    s_lshr_b32 s85, s2, 3
    s_getpc_b64 s[86:87]
Lpf3:
    s_lshl_b32 s88, s85, 10
    s_min_u32 s88, s88, K3_end-k3_kernel-1024
    s_add_u32 s86, s86, s88
    s_addc_u32 s87, s87, 0
    s_add_u32 s86, s86, k3_kernel-Lpf3
    s_addc_u32 s87, s87, (k3_kernel-Lpf3)>>32
    global_load_dwordx4 v[248:251], v5, s[86:87]
K3_nopf:
    s_mov_b32 m0, s30
    s_add_u32 s30, s30, 4096
    buffer_load_dwordx4 v10, s[8:11], s31 offen lds
    s_add_u32 s31, s31, 4096
    s_mov_b32 m0, s30
    s_add_u32 s30, s30, 4096
    buffer_load_dwordx4 v10, s[8:11], s31 offen lds
    s_add_u32 s31, s31, 4096
    s_mov_b32 m0, s30
    s_add_u32 s30, s30, 4096
    buffer_load_dwordx4 v10, s[8:11], s31 offen lds
    s_add_u32 s31, s31, 4096
    s_add_u32 s62, s50, s60
    s_lshl_b32 s62, s62, 5
    buffer_load_dwordx2 v[24:25], v12, s[12:15], s62 offen
    s_add_u32 s62, s51, s60
    s_lshl_b32 s62, s62, 5
    buffer_load_dwordx2 v[26:27], v12, s[12:15], s62 offen
    buffer_load_dwordx4 v[104:107], v5, s[8:11], s32 offen offset:0
    buffer_load_dwordx4 v[176:179], v5, s[8:11], s33 offen offset:0
    s_mov_b32 m0, s30
    s_add_u32 s30, s30, 4096
    buffer_load_dwordx4 v10, s[8:11], s31 offen lds
    s_add_u32 s31, s31, 4096
    s_mov_b32 m0, s30
    s_add_u32 s30, s30, 4096
    buffer_load_dwordx4 v10, s[8:11], s31 offen lds
    s_add_u32 s31, s31, 4096
    s_mov_b32 m0, s30
    s_add_u32 s30, s30, 4096
    buffer_load_dwordx4 v10, s[8:11], s31 offen lds
    s_add_u32 s31, s31, 4096
    buffer_load_dwordx4 v[108:111], v5, s[8:11], s32 offen offset:1024
    buffer_load_dwordx4 v[180:183], v5, s[8:11], s33 offen offset:1024
    buffer_load_dwordx4 v[112:115], v5, s[8:11], s32 offen offset:2048
    buffer_load_dwordx4 v[184:187], v5, s[8:11], s33 offen offset:2048
    s_add_u32 s52, s61, 2
    s_cmp_ge_u32 s52, 9
    s_cselect_b32 s62, 9, 0
    s_sub_u32 s52, s52, s62
    s_add_u32 s52, s52, s59
    s_add_u32 s62, s52, s60
    s_mul_i32 s62, s62, 18432
    s_add_u32 s34, s62, 5562368
    s_add_u32 s53, s61, 3
    s_cmp_ge_u32 s53, 9
    s_cselect_b32 s62, 9, 0
    s_sub_u32 s53, s53, s62
    s_add_u32 s53, s53, s59
    s_add_u32 s62, s53, s60
    s_mul_i32 s62, s62, 18432
    s_add_u32 s35, s62, 5562368
    s_add_u32 s54, s61, 4
    s_cmp_ge_u32 s54, 9
    s_cselect_b32 s62, 9, 0
    s_sub_u32 s54, s54, s62
    s_add_u32 s54, s54, s59
    s_add_u32 s62, s54, s60
    s_mul_i32 s62, s62, 18432
    s_add_u32 s36, s62, 5562368
    s_add_u32 s55, s61, 5
    s_cmp_ge_u32 s55, 9
    s_cselect_b32 s62, 9, 0
    s_sub_u32 s55, s55, s62
    s_add_u32 s55, s55, s59
    s_add_u32 s62, s55, s60
    s_mul_i32 s62, s62, 18432
    s_add_u32 s37, s62, 5562368
    s_add_u32 s56, s61, 6
    s_cmp_ge_u32 s56, 9
    s_cselect_b32 s62, 9, 0
    s_sub_u32 s56, s56, s62
    s_add_u32 s56, s56, s59
    s_add_u32 s62, s56, s60
    s_mul_i32 s62, s62, 18432
    s_add_u32 s38, s62, 5562368
    s_add_u32 s57, s61, 7
    s_cmp_ge_u32 s57, 9
    s_cselect_b32 s62, 9, 0
    s_sub_u32 s57, s57, s62
    s_add_u32 s57, s57, s59
    s_add_u32 s62, s57, s60
    s_mul_i32 s62, s62, 18432
    s_add_u32 s39, s62, 5562368
    s_add_u32 s58, s61, 8
    s_cmp_ge_u32 s58, 9
    s_cselect_b32 s62, 9, 0
    s_sub_u32 s58, s58, s62
    s_add_u32 s58, s58, s59
    s_add_u32 s62, s58, s60
    s_mul_i32 s62, s62, 18432
    s_add_u32 s40, s62, 5562368
    s_mov_b32 s16, s24
    s_mov_b32 s17, s25
    s_mov_b32 s18, 1152
    s_mov_b32 s19, 0x00020000
    s_mov_b32 s20, s26
    s_mov_b32 s21, s27
    s_mov_b32 s22, 2359296
    s_mov_b32 s23, 0x00020000
    s_add_u32 s28, s28, s29
    s_and_b32 s28, s28, 7
    s_mov_b32 s64, 8
    s_lshl_b32 s62, s64, 2
    s_add_u32 s62, s62, s3
    s_add_u32 s62, s62, s60
    s_mul_i32 s62, s62, 18432
    s_add_u32 s41, s62, 10870784
    s_add_u32 s65, s28, 1
    s_and_b32 s65, s65, 7
    s_lshl_b32 s62, s65, 2
    s_add_u32 s62, s62, s3
    s_add_u32 s62, s62, s60
    s_mul_i32 s62, s62, 18432
    s_add_u32 s42, s62, 10870784
    s_add_u32 s66, s28, 2
    s_and_b32 s66, s66, 7
    s_lshl_b32 s62, s66, 2
    s_add_u32 s62, s62, s3
    s_add_u32 s62, s62, s60
    s_mul_i32 s62, s62, 18432
    s_add_u32 s43, s62, 10870784
    s_add_u32 s67, s28, 3
    s_and_b32 s67, s67, 7
    s_lshl_b32 s62, s67, 2
    s_add_u32 s62, s62, s3
    s_add_u32 s62, s62, s60
    s_mul_i32 s62, s62, 18432
    s_add_u32 s44, s62, 10870784
    s_add_u32 s68, s28, 4
    s_and_b32 s68, s68, 7
    s_lshl_b32 s62, s68, 2
    s_add_u32 s62, s62, s3
    s_add_u32 s62, s62, s60
    s_mul_i32 s62, s62, 18432
    s_add_u32 s45, s62, 10870784
    s_add_u32 s69, s28, 5
    s_and_b32 s69, s69, 7
    s_lshl_b32 s62, s69, 2
    s_add_u32 s62, s62, s3
    s_add_u32 s62, s62, s60
    s_mul_i32 s62, s62, 18432
    s_add_u32 s46, s62, 10870784
    s_add_u32 s70, s28, 6
    s_and_b32 s70, s70, 7
    s_lshl_b32 s62, s70, 2
    s_add_u32 s62, s62, s3
    s_add_u32 s62, s62, s60
    s_mul_i32 s62, s62, 18432
    s_add_u32 s47, s62, 10870784
    s_add_u32 s71, s28, 7
    s_and_b32 s71, s71, 7
    s_lshl_b32 s62, s71, 2
    s_add_u32 s62, s62, s3
    s_add_u32 s62, s62, s60
    s_mul_i32 s62, s62, 18432
    s_add_u32 s48, s62, 10870784
    s_add_u32 s72, s28, 8
    s_and_b32 s72, s72, 7
    s_lshl_b32 s62, s72, 2
    s_add_u32 s62, s62, s3
    s_add_u32 s62, s62, s60
    s_mul_i32 s62, s62, 18432
    s_add_u32 s49, s62, 10870784
    s_mov_b32 s75, 0x00003f80
    s_mov_b32 s76, 0x3f800000
    v_lshlrev_b32 v255, 3, v2
    v_add_u32 v11, 73728, v5
    v_add_u32 v13, 110592, v5
    s_mul_i32 s78, s29, 36
    s_add_u32 s78, s78, s3
    s_lshl_b32 s77, s78, 14
    s_add_u32 s77, s77, 16179200
    s_lshl_b32 s78, s78, 11
    s_add_u32 s78, s78, 35053568
    s_lshl_b32 s79, s28, 11
    s_add_u32 s79, s79, s77
    s_lshl_b32 s84, s28, 16
    s_add_u32 s84, s84, s77
    s_lshl_b32 s62, s28, 7
    s_lshl_b32 s63, s3, 5
    s_add_u32 s82, s62, s63
    s_add_u32 s83, s63, 1024
    s_and_b32 s73, s28, 1
    s_lshl_b32 s73, s73, 10
    s_add_u32 s85, s73, s77
    s_add_u32 s85, s85, 524288
    s_lshr_b32 s62, s28, 1
    s_cmp_eq_u32 s62, s3
    s_cselect_b32 s80, 1, 0
    s_lshl_b32 s74, s80, 8
    s_or_b32 s74, s74, 0xfe
    s_waitcnt vmcnt(9)
    v_lshlrev_b32 v16, 16, v24
    v_and_b32 v17, 0xffff0000, v24
    v_lshlrev_b32 v18, 16, v25
    v_and_b32 v19, 0xffff0000, v25
    v_lshlrev_b32 v20, 16, v26
    v_and_b32 v21, 0xffff0000, v26
    v_lshlrev_b32 v22, 16, v27
    v_and_b32 v23, 0xffff0000, v27
    s_waitcnt vmcnt(11)
    s_barrier
    ds_read2st64_b64 a[0:3], v255 offset0:0 offset1:1
    ds_read2st64_b64 a[4:7], v255 offset0:2 offset1:3
    ds_read2st64_b64 a[8:11], v255 offset0:4 offset1:5
    ds_read2st64_b64 a[12:15], v255 offset0:6 offset1:7
    ds_read2st64_b64 a[16:19], v255 offset0:8 offset1:9
    ds_read2st64_b64 a[20:23], v255 offset0:10 offset1:11
    ds_read2st64_b64 a[24:27], v255 offset0:12 offset1:13
    ds_read2st64_b64 a[28:31], v255 offset0:14 offset1:15
    ds_read2st64_b64 a[32:35], v255 offset0:16 offset1:17
    ds_read2st64_b64 a[36:39], v255 offset0:18 offset1:19
    ds_read2st64_b64 a[40:43], v255 offset0:20 offset1:21
    ds_read2st64_b64 a[44:47], v255 offset0:22 offset1:23
    s_waitcnt vmcnt(8) lgkmcnt(8)
    v_mfma_f32_16x16x32_bf16 v[40:43], v[104:107], a[0:3], v[16:19]
    v_mfma_f32_16x16x32_bf16 v[44:47], v[104:107], a[4:7], v[16:19]
    v_mfma_f32_16x16x32_bf16 v[48:51], v[104:107], a[8:11], v[16:19]
    v_mfma_f32_16x16x32_bf16 v[52:55], v[104:107], a[12:15], v[16:19]
    s_mov_b32 m0, s30
    s_add_u32 s30, s30, 4096
    buffer_load_dwordx4 v10, s[8:11], s31 offen lds
    s_add_u32 s31, s31, 4096
    buffer_load_dwordx4 v[116:119], v5, s[8:11], s32 offen offset:3072
    s_waitcnt vmcnt(9)
    v_mfma_f32_16x16x32_bf16 v[56:59], v[176:179], a[0:3], v[20:23]
    v_mfma_f32_16x16x32_bf16 v[60:63], v[176:179], a[4:7], v[20:23]
    v_mfma_f32_16x16x32_bf16 v[64:67], v[176:179], a[8:11], v[20:23]
    v_mfma_f32_16x16x32_bf16 v[68:71], v[176:179], a[12:15], v[20:23]
    buffer_load_dwordx4 v[188:191], v5, s[8:11], s33 offen offset:3072
    s_waitcnt vmcnt(6) lgkmcnt(4)
    v_mfma_f32_16x16x32_bf16 v[40:43], v[108:111], a[16:19], v[40:43]
    v_mfma_f32_16x16x32_bf16 v[44:47], v[108:111], a[20:23], v[44:47]
    v_mfma_f32_16x16x32_bf16 v[48:51], v[108:111], a[24:27], v[48:51]
    v_mfma_f32_16x16x32_bf16 v[52:55], v[108:111], a[28:31], v[52:55]
    s_mov_b32 m0, s30
    s_add_u32 s30, s30, 4096
    buffer_load_dwordx4 v10, s[8:11], s31 offen lds
    s_add_u32 s31, s31, 4096
    buffer_load_dwordx4 v[120:123], v6, s[8:11], s32 offen offset:0
    s_waitcnt vmcnt(7)
    v_mfma_f32_16x16x32_bf16 v[56:59], v[180:183], a[16:19], v[56:59]
    v_mfma_f32_16x16x32_bf16 v[60:63], v[180:183], a[20:23], v[60:63]
    v_mfma_f32_16x16x32_bf16 v[64:67], v[180:183], a[24:27], v[64:67]
    v_mfma_f32_16x16x32_bf16 v[68:71], v[180:183], a[28:31], v[68:71]
    buffer_load_dwordx4 v[192:195], v6, s[8:11], s33 offen offset:0
    s_waitcnt vmcnt(7) lgkmcnt(0)
    v_mfma_f32_16x16x32_bf16 v[40:43], v[112:115], a[32:35], v[40:43]
    v_mfma_f32_16x16x32_bf16 v[44:47], v[112:115], a[36:39], v[44:47]
    v_mfma_f32_16x16x32_bf16 v[48:51], v[112:115], a[40:43], v[48:51]
    v_mfma_f32_16x16x32_bf16 v[52:55], v[112:115], a[44:47], v[52:55]
    s_mov_b32 m0, s30
    s_add_u32 s30, s30, 4096
    buffer_load_dwordx4 v10, s[8:11], s31 offen lds
    s_add_u32 s31, s31, 4096
    buffer_load_dwordx4 v[124:127], v6, s[8:11], s32 offen offset:1024
    s_waitcnt vmcnt(8)
    v_mfma_f32_16x16x32_bf16 v[56:59], v[184:187], a[32:35], v[56:59]
    v_mfma_f32_16x16x32_bf16 v[60:63], v[184:187], a[36:39], v[60:63]
    v_mfma_f32_16x16x32_bf16 v[64:67], v[184:187], a[40:43], v[64:67]
    v_mfma_f32_16x16x32_bf16 v[68:71], v[184:187], a[44:47], v[68:71]
    buffer_load_dwordx4 v[196:199], v6, s[8:11], s33 offen offset:1024
    s_add_u32 s62, s52, s60
    s_lshl_b32 s62, s62, 5
    buffer_load_dwordx2 v[28:29], v12, s[12:15], s62 offen
    s_waitcnt vmcnt(14)
    s_barrier
    ds_read2st64_b64 a[48:51], v255 offset0:24 offset1:25
    ds_read2st64_b64 a[52:55], v255 offset0:26 offset1:27
    ds_read2st64_b64 a[56:59], v255 offset0:28 offset1:29
    ds_read2st64_b64 a[60:63], v255 offset0:30 offset1:31
    ds_read2st64_b64 a[64:67], v255 offset0:32 offset1:33
    ds_read2st64_b64 a[68:71], v255 offset0:34 offset1:35
    ds_read2st64_b64 a[72:75], v255 offset0:36 offset1:37
    ds_read2st64_b64 a[76:79], v255 offset0:38 offset1:39
    ds_read2st64_b64 a[80:83], v255 offset0:40 offset1:41
    ds_read2st64_b64 a[84:87], v255 offset0:42 offset1:43
    ds_read2st64_b64 a[88:91], v255 offset0:44 offset1:45
    ds_read2st64_b64 a[92:95], v255 offset0:46 offset1:47
    s_waitcnt vmcnt(8) lgkmcnt(8)
    v_mfma_f32_16x16x32_bf16 v[40:43], v[116:119], a[48:51], v[40:43]
    v_mfma_f32_16x16x32_bf16 v[44:47], v[116:119], a[52:55], v[44:47]
    v_mfma_f32_16x16x32_bf16 v[48:51], v[116:119], a[56:59], v[48:51]
    v_mfma_f32_16x16x32_bf16 v[52:55], v[116:119], a[60:63], v[52:55]
    s_mov_b32 m0, s30
    s_add_u32 s30, s30, 4096
    buffer_load_dwordx4 v10, s[8:11], s31 offen lds
    s_add_u32 s31, s31, 4096
    buffer_load_dwordx4 v[128:131], v6, s[8:11], s32 offen offset:2048
    s_waitcnt vmcnt(9)
    v_mfma_f32_16x16x32_bf16 v[56:59], v[188:191], a[48:51], v[56:59]
    v_mfma_f32_16x16x32_bf16 v[60:63], v[188:191], a[52:55], v[60:63]
    v_mfma_f32_16x16x32_bf16 v[64:67], v[188:191], a[56:59], v[64:67]
    v_mfma_f32_16x16x32_bf16 v[68:71], v[188:191], a[60:63], v[68:71]
    buffer_load_dwordx4 v[200:203], v6, s[8:11], s33 offen offset:2048
    s_add_u32 s62, s53, s60
    s_lshl_b32 s62, s62, 5
    buffer_load_dwordx2 v[30:31], v12, s[12:15], s62 offen
    s_waitcnt vmcnt(9) lgkmcnt(4)
    v_mfma_f32_16x16x32_bf16 v[40:43], v[120:123], a[64:67], v[40:43]
    v_mfma_f32_16x16x32_bf16 v[44:47], v[120:123], a[68:71], v[44:47]
    v_mfma_f32_16x16x32_bf16 v[48:51], v[120:123], a[72:75], v[48:51]
    v_mfma_f32_16x16x32_bf16 v[52:55], v[120:123], a[76:79], v[52:55]
    s_mov_b32 m0, s30
    s_add_u32 s30, s30, 4096
    buffer_load_dwordx4 v10, s[8:11], s31 offen lds
    s_add_u32 s31, s31, 4096
    buffer_load_dwordx4 v[132:135], v6, s[8:11], s32 offen offset:3072
    s_waitcnt vmcnt(10)
    v_mfma_f32_16x16x32_bf16 v[56:59], v[192:195], a[64:67], v[56:59]
    v_mfma_f32_16x16x32_bf16 v[60:63], v[192:195], a[68:71], v[60:63]
    v_mfma_f32_16x16x32_bf16 v[64:67], v[192:195], a[72:75], v[64:67]
    v_mfma_f32_16x16x32_bf16 v[68:71], v[192:195], a[76:79], v[68:71]
    buffer_load_dwordx4 v[204:207], v6, s[8:11], s33 offen offset:3072
    s_add_u32 s62, s54, s60
    s_lshl_b32 s62, s62, 5
    buffer_load_dwordx2 v[32:33], v12, s[12:15], s62 offen
    s_waitcnt vmcnt(10) lgkmcnt(0)
    v_mfma_f32_16x16x32_bf16 v[40:43], v[124:127], a[80:83], v[40:43]
    v_mfma_f32_16x16x32_bf16 v[44:47], v[124:127], a[84:87], v[44:47]
    v_mfma_f32_16x16x32_bf16 v[48:51], v[124:127], a[88:91], v[48:51]
    v_mfma_f32_16x16x32_bf16 v[52:55], v[124:127], a[92:95], v[52:55]
    s_mov_b32 m0, s30
    s_add_u32 s30, s30, 4096
    buffer_load_dwordx4 v10, s[8:11], s31 offen lds
    s_add_u32 s31, s31, 4096
    buffer_load_dwordx4 v[136:139], v7, s[8:11], s32 offen offset:0
    s_waitcnt vmcnt(11)
    v_mfma_f32_16x16x32_bf16 v[56:59], v[196:199], a[80:83], v[56:59]
    v_mfma_f32_16x16x32_bf16 v[60:63], v[196:199], a[84:87], v[60:63]
    v_mfma_f32_16x16x32_bf16 v[64:67], v[196:199], a[88:91], v[64:67]
    v_mfma_f32_16x16x32_bf16 v[68:71], v[196:199], a[92:95], v[68:71]
    buffer_load_dwordx4 v[208:211], v7, s[8:11], s33 offen offset:0
    s_add_u32 s62, s55, s60
    s_lshl_b32 s62, s62, 5
    buffer_load_dwordx2 v[34:35], v12, s[12:15], s62 offen
    s_waitcnt vmcnt(15)
    s_barrier
    ds_read2st64_b64 a[96:99], v255 offset0:48 offset1:49
    ds_read2st64_b64 a[100:103], v255 offset0:50 offset1:51
    ds_read2st64_b64 a[104:107], v255 offset0:52 offset1:53
    ds_read2st64_b64 a[108:111], v255 offset0:54 offset1:55
    ds_read2st64_b64 a[112:115], v255 offset0:56 offset1:57
    ds_read2st64_b64 a[116:119], v255 offset0:58 offset1:59
    ds_read2st64_b64 a[120:123], v255 offset0:60 offset1:61
    ds_read2st64_b64 a[124:127], v255 offset0:62 offset1:63
    ds_read2st64_b64 a[128:131], v255 offset0:64 offset1:65
    ds_read2st64_b64 a[132:135], v255 offset0:66 offset1:67
    ds_read2st64_b64 a[136:139], v255 offset0:68 offset1:69
    ds_read2st64_b64 a[140:143], v255 offset0:70 offset1:71
    s_waitcnt vmcnt(10) lgkmcnt(8)
    v_mfma_f32_16x16x32_bf16 v[40:43], v[128:131], a[96:99], v[40:43]
    v_mfma_f32_16x16x32_bf16 v[44:47], v[128:131], a[100:103], v[44:47]
    v_mfma_f32_16x16x32_bf16 v[48:51], v[128:131], a[104:107], v[48:51]
    v_mfma_f32_16x16x32_bf16 v[52:55], v[128:131], a[108:111], v[52:55]
    s_mov_b32 m0, s30
    s_add_u32 s30, s30, 4096
    buffer_load_dwordx4 v10, s[8:11], s31 offen lds
    s_add_u32 s31, s31, 4096
    buffer_load_dwordx4 v[140:143], v7, s[8:11], s32 offen offset:1024
    s_waitcnt vmcnt(11)
    v_mfma_f32_16x16x32_bf16 v[56:59], v[200:203], a[96:99], v[56:59]
    v_mfma_f32_16x16x32_bf16 v[60:63], v[200:203], a[100:103], v[60:63]
    v_mfma_f32_16x16x32_bf16 v[64:67], v[200:203], a[104:107], v[64:67]
    v_mfma_f32_16x16x32_bf16 v[68:71], v[200:203], a[108:111], v[68:71]
    buffer_load_dwordx4 v[212:215], v7, s[8:11], s33 offen offset:1024
    s_add_u32 s62, s56, s60
    s_lshl_b32 s62, s62, 5
    buffer_load_dwordx2 v[36:37], v12, s[12:15], s62 offen
    s_waitcnt vmcnt(10) lgkmcnt(4)
    v_mfma_f32_16x16x32_bf16 v[40:43], v[132:135], a[112:115], v[40:43]
    v_mfma_f32_16x16x32_bf16 v[44:47], v[132:135], a[116:119], v[44:47]
    v_mfma_f32_16x16x32_bf16 v[48:51], v[132:135], a[120:123], v[48:51]
    v_mfma_f32_16x16x32_bf16 v[52:55], v[132:135], a[124:127], v[52:55]
    s_mov_b32 m0, s30
    s_add_u32 s30, s30, 4096
    buffer_load_dwordx4 v10, s[8:11], s31 offen lds
    s_add_u32 s31, s31, 4096
    buffer_load_dwordx4 v[144:147], v7, s[8:11], s32 offen offset:2048
    s_waitcnt vmcnt(11)
    v_mfma_f32_16x16x32_bf16 v[56:59], v[204:207], a[112:115], v[56:59]
    v_mfma_f32_16x16x32_bf16 v[60:63], v[204:207], a[116:119], v[60:63]
    v_mfma_f32_16x16x32_bf16 v[64:67], v[204:207], a[120:123], v[64:67]
    v_mfma_f32_16x16x32_bf16 v[68:71], v[204:207], a[124:127], v[68:71]
    buffer_load_dwordx4 v[216:219], v7, s[8:11], s33 offen offset:2048
    s_add_u32 s62, s57, s60
    s_lshl_b32 s62, s62, 5
    buffer_load_dwordx2 v[38:39], v12, s[12:15], s62 offen
    s_waitcnt vmcnt(10) lgkmcnt(0)
    v_mfma_f32_16x16x32_bf16 v[40:43], v[136:139], a[128:131], v[40:43]
    v_mfma_f32_16x16x32_bf16 v[44:47], v[136:139], a[132:135], v[44:47]
    v_mfma_f32_16x16x32_bf16 v[48:51], v[136:139], a[136:139], v[48:51]
    v_mfma_f32_16x16x32_bf16 v[52:55], v[136:139], a[140:143], v[52:55]
    s_mov_b32 m0, s30
    s_add_u32 s30, s30, 4096
    buffer_load_dwordx4 v10, s[8:11], s31 offen lds
    s_add_u32 s31, s31, 4096
    buffer_load_dwordx4 v[148:151], v7, s[8:11], s32 offen offset:3072
    s_waitcnt vmcnt(11)
    v_mfma_f32_16x16x32_bf16 v[56:59], v[208:211], a[128:131], v[56:59]
    v_mfma_f32_16x16x32_bf16 v[60:63], v[208:211], a[132:135], v[60:63]
    v_mfma_f32_16x16x32_bf16 v[64:67], v[208:211], a[136:139], v[64:67]
    v_mfma_f32_16x16x32_bf16 v[68:71], v[208:211], a[140:143], v[68:71]
    buffer_load_dwordx4 v[220:223], v7, s[8:11], s33 offen offset:3072
    s_add_u32 s62, s58, s60
    s_lshl_b32 s62, s62, 5
    buffer_load_dwordx2 v[14:15], v12, s[12:15], s62 offen
    s_waitcnt vmcnt(15)
    s_barrier
    ds_read2st64_b64 a[144:147], v255 offset0:72 offset1:73
    ds_read2st64_b64 a[148:151], v255 offset0:74 offset1:75
    ds_read2st64_b64 a[152:155], v255 offset0:76 offset1:77
    ds_read2st64_b64 a[156:159], v255 offset0:78 offset1:79
    ds_read2st64_b64 a[160:163], v255 offset0:80 offset1:81
    ds_read2st64_b64 a[164:167], v255 offset0:82 offset1:83
    ds_read2st64_b64 a[168:171], v255 offset0:84 offset1:85
    ds_read2st64_b64 a[172:175], v255 offset0:86 offset1:87
    ds_read2st64_b64 a[176:179], v255 offset0:88 offset1:89
    ds_read2st64_b64 a[180:183], v255 offset0:90 offset1:91
    ds_read2st64_b64 a[184:187], v255 offset0:92 offset1:93
    ds_read2st64_b64 a[188:191], v255 offset0:94 offset1:95
    s_waitcnt vmcnt(10) lgkmcnt(8)
    v_mfma_f32_16x16x32_bf16 v[40:43], v[140:143], a[144:147], v[40:43]
    v_mfma_f32_16x16x32_bf16 v[44:47], v[140:143], a[148:151], v[44:47]
    v_mfma_f32_16x16x32_bf16 v[48:51], v[140:143], a[152:155], v[48:51]
    v_mfma_f32_16x16x32_bf16 v[52:55], v[140:143], a[156:159], v[52:55]
    s_mov_b32 m0, s30
    s_add_u32 s30, s30, 4096
    buffer_load_dwordx4 v10, s[8:11], s31 offen lds
    s_add_u32 s31, s31, 4096
    buffer_load_dwordx4 v[152:155], v8, s[8:11], s32 offen offset:0
    s_waitcnt vmcnt(11)
    v_mfma_f32_16x16x32_bf16 v[56:59], v[212:215], a[144:147], v[56:59]
    v_mfma_f32_16x16x32_bf16 v[60:63], v[212:215], a[148:151], v[60:63]
    v_mfma_f32_16x16x32_bf16 v[64:67], v[212:215], a[152:155], v[64:67]
    v_mfma_f32_16x16x32_bf16 v[68:71], v[212:215], a[156:159], v[68:71]
    buffer_load_dwordx4 v[224:227], v8, s[8:11], s33 offen offset:0
    buffer_load_dwordx4 v[164:167], v8, s[8:11], s32 offen offset:3072
    s_waitcnt vmcnt(10) lgkmcnt(4)
    v_mfma_f32_16x16x32_bf16 v[40:43], v[144:147], a[160:163], v[40:43]
    v_mfma_f32_16x16x32_bf16 v[44:47], v[144:147], a[164:167], v[44:47]
    v_mfma_f32_16x16x32_bf16 v[48:51], v[144:147], a[168:171], v[48:51]
    v_mfma_f32_16x16x32_bf16 v[52:55], v[144:147], a[172:175], v[52:55]
    s_mov_b32 m0, s30
    s_add_u32 s30, s30, 4096
    buffer_load_dwordx4 v10, s[8:11], s31 offen lds
    s_add_u32 s31, s31, 4096
    buffer_load_dwordx4 v[156:159], v8, s[8:11], s32 offen offset:1024
    s_waitcnt vmcnt(11)
    v_mfma_f32_16x16x32_bf16 v[56:59], v[216:219], a[160:163], v[56:59]
    v_mfma_f32_16x16x32_bf16 v[60:63], v[216:219], a[164:167], v[60:63]
    v_mfma_f32_16x16x32_bf16 v[64:67], v[216:219], a[168:171], v[64:67]
    v_mfma_f32_16x16x32_bf16 v[68:71], v[216:219], a[172:175], v[68:71]
    buffer_load_dwordx4 v[228:231], v8, s[8:11], s33 offen offset:1024
    buffer_load_dwordx4 v[168:171], v9, s[8:11], s32 offen offset:0
    s_waitcnt vmcnt(10) lgkmcnt(0)
    v_mfma_f32_16x16x32_bf16 v[40:43], v[148:151], a[176:179], v[40:43]
    v_mfma_f32_16x16x32_bf16 v[44:47], v[148:151], a[180:183], v[44:47]
    v_mfma_f32_16x16x32_bf16 v[48:51], v[148:151], a[184:187], v[48:51]
    v_mfma_f32_16x16x32_bf16 v[52:55], v[148:151], a[188:191], v[52:55]
    s_mov_b32 m0, s30
    s_add_u32 s30, s30, 4096
    buffer_load_dwordx4 v10, s[8:11], s31 offen lds
    s_add_u32 s31, s31, 4096
    buffer_load_dwordx4 v[160:163], v8, s[8:11], s32 offen offset:2048
    s_waitcnt vmcnt(11)
    v_mfma_f32_16x16x32_bf16 v[56:59], v[220:223], a[176:179], v[56:59]
    v_mfma_f32_16x16x32_bf16 v[60:63], v[220:223], a[180:183], v[60:63]
    v_mfma_f32_16x16x32_bf16 v[64:67], v[220:223], a[184:187], v[64:67]
    v_mfma_f32_16x16x32_bf16 v[68:71], v[220:223], a[188:191], v[68:71]
    buffer_load_dwordx4 v[232:235], v8, s[8:11], s33 offen offset:2048
    buffer_load_dwordx4 v[172:175], v9, s[8:11], s32 offen offset:1024
    s_waitcnt vmcnt(15)
    s_barrier
    ds_read2st64_b64 a[192:195], v255 offset0:96 offset1:97
    ds_read2st64_b64 a[196:199], v255 offset0:98 offset1:99
    ds_read2st64_b64 a[200:203], v255 offset0:100 offset1:101
    ds_read2st64_b64 a[204:207], v255 offset0:102 offset1:103
    ds_read2st64_b64 a[208:211], v255 offset0:104 offset1:105
    ds_read2st64_b64 a[212:215], v255 offset0:106 offset1:107
    ds_read2st64_b64 a[216:219], v255 offset0:108 offset1:109
    ds_read2st64_b64 a[220:223], v255 offset0:110 offset1:111
    ds_read2st64_b64 a[224:227], v255 offset0:112 offset1:113
    ds_read2st64_b64 a[228:231], v255 offset0:114 offset1:115
    ds_read2st64_b64 a[232:235], v255 offset0:116 offset1:117
    ds_read2st64_b64 a[236:239], v255 offset0:118 offset1:119
    s_waitcnt vmcnt(10) lgkmcnt(8)
    v_mfma_f32_16x16x32_bf16 v[40:43], v[152:155], a[192:195], v[40:43]
    v_mfma_f32_16x16x32_bf16 v[44:47], v[152:155], a[196:199], v[44:47]
    v_mfma_f32_16x16x32_bf16 v[48:51], v[152:155], a[200:203], v[48:51]
    v_mfma_f32_16x16x32_bf16 v[52:55], v[152:155], a[204:207], v[52:55]
    buffer_load_dwordx4 v[236:239], v8, s[8:11], s33 offen offset:3072
    buffer_load_dwordx4 v[104:107], v5, s[8:11], s34 offen offset:0
    s_waitcnt vmcnt(8) lgkmcnt(4)
    v_mfma_f32_16x16x32_bf16 v[40:43], v[156:159], a[208:211], v[40:43]
    v_mfma_f32_16x16x32_bf16 v[44:47], v[156:159], a[212:215], v[44:47]
    v_mfma_f32_16x16x32_bf16 v[48:51], v[156:159], a[216:219], v[48:51]
    v_mfma_f32_16x16x32_bf16 v[52:55], v[156:159], a[220:223], v[52:55]
    buffer_load_dwordx4 v[240:243], v9, s[8:11], s33 offen offset:0
    buffer_load_dwordx4 v[108:111], v5, s[8:11], s34 offen offset:1024
    s_waitcnt vmcnt(6) lgkmcnt(0)
    v_mfma_f32_16x16x32_bf16 v[40:43], v[160:163], a[224:227], v[40:43]
    v_mfma_f32_16x16x32_bf16 v[44:47], v[160:163], a[228:231], v[44:47]
    v_mfma_f32_16x16x32_bf16 v[48:51], v[160:163], a[232:235], v[48:51]
    v_mfma_f32_16x16x32_bf16 v[52:55], v[160:163], a[236:239], v[52:55]
    buffer_load_dwordx4 v[244:247], v9, s[8:11], s33 offen offset:1024
    buffer_load_dwordx4 v[112:115], v5, s[8:11], s34 offen offset:2048
    s_waitcnt vmcnt(9)
    s_barrier
    ds_read2st64_b64 a[240:243], v255 offset0:120 offset1:121
    ds_read2st64_b64 a[244:247], v255 offset0:122 offset1:123
    ds_read2st64_b64 a[248:251], v255 offset0:124 offset1:125
    ds_read2st64_b64 a[252:255], v255 offset0:126 offset1:127
    ds_read2st64_b64 v[72:75], v255 offset0:128 offset1:129
    ds_read2st64_b64 v[76:79], v255 offset0:130 offset1:131
    ds_read2st64_b64 v[80:83], v255 offset0:132 offset1:133
    ds_read2st64_b64 v[84:87], v255 offset0:134 offset1:135
    ds_read2st64_b64 v[88:91], v255 offset0:136 offset1:137
    ds_read2st64_b64 v[92:95], v255 offset0:138 offset1:139
    ds_read2st64_b64 v[96:99], v255 offset0:140 offset1:141
    ds_read2st64_b64 v[100:103], v255 offset0:142 offset1:143
    s_waitcnt vmcnt(14) lgkmcnt(8)
    v_mfma_f32_16x16x32_bf16 v[40:43], v[164:167], a[240:243], v[40:43]
    v_mfma_f32_16x16x32_bf16 v[44:47], v[164:167], a[244:247], v[44:47]
    v_mfma_f32_16x16x32_bf16 v[48:51], v[164:167], a[248:251], v[48:51]
    v_mfma_f32_16x16x32_bf16 v[52:55], v[164:167], a[252:255], v[52:55]
    buffer_load_dwordx4 v[116:119], v5, s[8:11], s34 offen offset:3072
    s_waitcnt vmcnt(11) lgkmcnt(4)
    v_mfma_f32_16x16x32_bf16 v[40:43], v[168:171], v[72:75], v[40:43]
    v_mfma_f32_16x16x32_bf16 v[44:47], v[168:171], v[76:79], v[44:47]
    v_mfma_f32_16x16x32_bf16 v[48:51], v[168:171], v[80:83], v[48:51]
    v_mfma_f32_16x16x32_bf16 v[52:55], v[168:171], v[84:87], v[52:55]
    buffer_load_dwordx4 v[120:123], v6, s[8:11], s34 offen offset:0
    s_waitcnt vmcnt(8) lgkmcnt(0)
    v_mfma_f32_16x16x32_bf16 v[40:43], v[172:175], v[88:91], v[40:43]
    v_mfma_f32_16x16x32_bf16 v[44:47], v[172:175], v[92:95], v[44:47]
    v_mfma_f32_16x16x32_bf16 v[48:51], v[172:175], v[96:99], v[48:51]
    v_mfma_f32_16x16x32_bf16 v[52:55], v[172:175], v[100:103], v[52:55]
    buffer_load_dwordx4 v[124:127], v6, s[8:11], s34 offen offset:1024
    s_waitcnt vmcnt(18)
    v_mfma_f32_16x16x32_bf16 v[56:59], v[224:227], a[192:195], v[56:59]
    s_lshr_b32 s63, s50, 1
    s_lshl_b32 s63, s63, 12
    s_and_b32 s62, s50, 1
    s_lshl_b32 s62, s62, 3
    s_add_u32 s62, s62, s63
    v_add_u32 v248, s62, v11
    v_mfma_f32_16x16x32_bf16 v[60:63], v[224:227], a[196:199], v[60:63]
    v_mul_f32 v40, v40, abs(v40)
    v_mul_f32 v41, v41, abs(v41)
    v_mfma_f32_16x16x32_bf16 v[64:67], v[224:227], a[200:203], v[64:67]
    v_mul_f32 v42, v42, abs(v42)
    v_mul_f32 v43, v43, abs(v43)
    v_mfma_f32_16x16x32_bf16 v[68:71], v[224:227], a[204:207], v[68:71]
    v_cvt_pk_bf16_f32 v40, v40, v41
    v_cvt_pk_bf16_f32 v41, v42, v43
    buffer_load_dwordx4 v[128:131], v6, s[8:11], s34 offen offset:2048
    s_waitcnt vmcnt(15)
    v_mfma_f32_16x16x32_bf16 v[56:59], v[228:231], a[208:211], v[56:59]
    v_pk_max_i16 v40, v40, 0
    v_pk_max_i16 v41, v41, 0
    v_mfma_f32_16x16x32_bf16 v[60:63], v[228:231], a[212:215], v[60:63]
    ds_write_b64 v248, v[40:41] offset:0
    v_mul_f32 v44, v44, abs(v44)
    v_mfma_f32_16x16x32_bf16 v[64:67], v[228:231], a[216:219], v[64:67]
    v_mul_f32 v45, v45, abs(v45)
    v_mul_f32 v46, v46, abs(v46)
    v_mfma_f32_16x16x32_bf16 v[68:71], v[228:231], a[220:223], v[68:71]
    v_mul_f32 v47, v47, abs(v47)
    v_cvt_pk_bf16_f32 v44, v44, v45
    buffer_load_dwordx4 v[132:135], v6, s[8:11], s34 offen offset:3072
    s_waitcnt vmcnt(12)
    v_mfma_f32_16x16x32_bf16 v[56:59], v[232:235], a[224:227], v[56:59]
    v_cvt_pk_bf16_f32 v45, v46, v47
    v_pk_max_i16 v44, v44, 0
    v_mfma_f32_16x16x32_bf16 v[60:63], v[232:235], a[228:231], v[60:63]
    v_pk_max_i16 v45, v45, 0
    ds_write_b64 v248, v[44:45] offset:1024
    v_mfma_f32_16x16x32_bf16 v[64:67], v[232:235], a[232:235], v[64:67]
    v_mul_f32 v48, v48, abs(v48)
    v_mul_f32 v49, v49, abs(v49)
    v_mfma_f32_16x16x32_bf16 v[68:71], v[232:235], a[236:239], v[68:71]
    v_mul_f32 v50, v50, abs(v50)
    v_mul_f32 v51, v51, abs(v51)
    buffer_load_dwordx4 v[136:139], v7, s[8:11], s34 offen offset:0
    s_waitcnt vmcnt(11)
    v_mfma_f32_16x16x32_bf16 v[56:59], v[236:239], a[240:243], v[56:59]
    v_cvt_pk_bf16_f32 v48, v48, v49
    v_cvt_pk_bf16_f32 v49, v50, v51
    v_mfma_f32_16x16x32_bf16 v[60:63], v[236:239], a[244:247], v[60:63]
    v_pk_max_i16 v48, v48, 0
    v_pk_max_i16 v49, v49, 0
    v_mfma_f32_16x16x32_bf16 v[64:67], v[236:239], a[248:251], v[64:67]
    ds_write_b64 v248, v[48:49] offset:2048
    v_mul_f32 v52, v52, abs(v52)
    v_mfma_f32_16x16x32_bf16 v[68:71], v[236:239], a[252:255], v[68:71]
    v_mul_f32 v53, v53, abs(v53)
    v_mul_f32 v54, v54, abs(v54)
    buffer_load_dwordx4 v[140:143], v7, s[8:11], s34 offen offset:1024
    s_waitcnt vmcnt(10)
    v_mfma_f32_16x16x32_bf16 v[56:59], v[240:243], v[72:75], v[56:59]
    v_mul_f32 v55, v55, abs(v55)
    v_cvt_pk_bf16_f32 v52, v52, v53
    v_mfma_f32_16x16x32_bf16 v[60:63], v[240:243], v[76:79], v[60:63]
    v_cvt_pk_bf16_f32 v53, v54, v55
    v_pk_max_i16 v52, v52, 0
    v_mfma_f32_16x16x32_bf16 v[64:67], v[240:243], v[80:83], v[64:67]
    v_pk_max_i16 v53, v53, 0
    ds_write_b64 v248, v[52:53] offset:3072
    v_mfma_f32_16x16x32_bf16 v[68:71], v[240:243], v[84:87], v[68:71]
    s_waitcnt vmcnt(49)
    v_lshlrev_b32 v16, 16, v28
    buffer_load_dwordx4 v[144:147], v7, s[8:11], s34 offen offset:2048
    s_waitcnt vmcnt(9)
    v_mfma_f32_16x16x32_bf16 v[56:59], v[244:247], v[88:91], v[56:59]
    v_and_b32 v17, 0xffff0000, v28
    v_lshlrev_b32 v18, 16, v29
    v_mfma_f32_16x16x32_bf16 v[60:63], v[244:247], v[92:95], v[60:63]
    v_and_b32 v19, 0xffff0000, v29
    v_mfma_f32_16x16x32_bf16 v[64:67], v[244:247], v[96:99], v[64:67]
    v_mfma_f32_16x16x32_bf16 v[68:71], v[244:247], v[100:103], v[68:71]
    buffer_load_dwordx4 v[148:151], v7, s[8:11], s34 offen offset:3072
    s_waitcnt vmcnt(11)
    v_mfma_f32_16x16x32_bf16 v[40:43], v[104:107], a[0:3], v[16:19]
    v_mfma_f32_16x16x32_bf16 v[40:43], v[108:111], a[16:19], v[40:43]
    v_mfma_f32_16x16x32_bf16 v[44:47], v[104:107], a[4:7], v[16:19]
    v_mfma_f32_16x16x32_bf16 v[44:47], v[108:111], a[20:23], v[44:47]
    buffer_load_dwordx4 v[152:155], v8, s[8:11], s34 offen offset:0
    v_mfma_f32_16x16x32_bf16 v[48:51], v[104:107], a[8:11], v[16:19]
    v_mfma_f32_16x16x32_bf16 v[48:51], v[108:111], a[24:27], v[48:51]
    v_mfma_f32_16x16x32_bf16 v[52:55], v[104:107], a[12:15], v[16:19]
    v_mfma_f32_16x16x32_bf16 v[52:55], v[108:111], a[28:31], v[52:55]
    buffer_load_dwordx4 v[156:159], v8, s[8:11], s34 offen offset:1024
    s_waitcnt vmcnt(10)
    v_mfma_f32_16x16x32_bf16 v[40:43], v[112:115], a[32:35], v[40:43]
    s_lshr_b32 s63, s51, 1
    s_lshl_b32 s63, s63, 12
    s_and_b32 s62, s51, 1
    s_lshl_b32 s62, s62, 3
    s_add_u32 s62, s62, s63
    v_add_u32 v248, s62, v11
    v_mfma_f32_16x16x32_bf16 v[40:43], v[116:119], a[48:51], v[40:43]
    v_mul_f32 v56, v56, abs(v56)
    v_mfma_f32_16x16x32_bf16 v[44:47], v[112:115], a[36:39], v[44:47]
    v_mul_f32 v57, v57, abs(v57)
    v_mfma_f32_16x16x32_bf16 v[44:47], v[116:119], a[52:55], v[44:47]
    buffer_load_dwordx4 v[160:163], v8, s[8:11], s34 offen offset:2048
    v_mfma_f32_16x16x32_bf16 v[48:51], v[112:115], a[40:43], v[48:51]
    v_mul_f32 v58, v58, abs(v58)
    v_mfma_f32_16x16x32_bf16 v[48:51], v[116:119], a[56:59], v[48:51]
    v_mul_f32 v59, v59, abs(v59)
    v_mfma_f32_16x16x32_bf16 v[52:55], v[112:115], a[44:47], v[52:55]
    v_cvt_pk_bf16_f32 v56, v56, v57
    v_mfma_f32_16x16x32_bf16 v[52:55], v[116:119], a[60:63], v[52:55]
    buffer_load_dwordx4 v[164:167], v8, s[8:11], s34 offen offset:3072
    s_waitcnt vmcnt(10)
    v_mfma_f32_16x16x32_bf16 v[40:43], v[120:123], a[64:67], v[40:43]
    v_cvt_pk_bf16_f32 v57, v58, v59
    v_mfma_f32_16x16x32_bf16 v[40:43], v[124:127], a[80:83], v[40:43]
    v_pk_max_i16 v56, v56, 0
    v_mfma_f32_16x16x32_bf16 v[44:47], v[120:123], a[68:71], v[44:47]
    v_pk_max_i16 v57, v57, 0
    v_mfma_f32_16x16x32_bf16 v[44:47], v[124:127], a[84:87], v[44:47]
    buffer_load_dwordx4 v[168:171], v9, s[8:11], s34 offen offset:0
    buffer_load_dwordx4 v[172:175], v9, s[8:11], s34 offen offset:1024
    v_mfma_f32_16x16x32_bf16 v[48:51], v[120:123], a[72:75], v[48:51]
    ds_write_b64 v248, v[56:57] offset:0
    v_mfma_f32_16x16x32_bf16 v[48:51], v[124:127], a[88:91], v[48:51]
    v_mul_f32 v60, v60, abs(v60)
    v_mfma_f32_16x16x32_bf16 v[52:55], v[120:123], a[76:79], v[52:55]
    v_mul_f32 v61, v61, abs(v61)
    v_mfma_f32_16x16x32_bf16 v[52:55], v[124:127], a[92:95], v[52:55]
    buffer_load_dwordx4 v[176:179], v5, s[8:11], s35 offen offset:0
    s_waitcnt vmcnt(11)
    v_mfma_f32_16x16x32_bf16 v[40:43], v[128:131], a[96:99], v[40:43]
    v_mul_f32 v62, v62, abs(v62)
    v_mfma_f32_16x16x32_bf16 v[40:43], v[132:135], a[112:115], v[40:43]
    v_mul_f32 v63, v63, abs(v63)
    v_mfma_f32_16x16x32_bf16 v[44:47], v[128:131], a[100:103], v[44:47]
    v_cvt_pk_bf16_f32 v60, v60, v61
    v_mfma_f32_16x16x32_bf16 v[44:47], v[132:135], a[116:119], v[44:47]
    buffer_load_dwordx4 v[180:183], v5, s[8:11], s35 offen offset:1024
    v_mfma_f32_16x16x32_bf16 v[48:51], v[128:131], a[104:107], v[48:51]
    v_cvt_pk_bf16_f32 v61, v62, v63
    v_mfma_f32_16x16x32_bf16 v[48:51], v[132:135], a[120:123], v[48:51]
    v_pk_max_i16 v60, v60, 0
    v_mfma_f32_16x16x32_bf16 v[52:55], v[128:131], a[108:111], v[52:55]
    v_pk_max_i16 v61, v61, 0
    v_mfma_f32_16x16x32_bf16 v[52:55], v[132:135], a[124:127], v[52:55]
    buffer_load_dwordx4 v[184:187], v5, s[8:11], s35 offen offset:2048
    s_waitcnt vmcnt(11)
    v_mfma_f32_16x16x32_bf16 v[40:43], v[136:139], a[128:131], v[40:43]
    ds_write_b64 v248, v[60:61] offset:1024
    v_mfma_f32_16x16x32_bf16 v[40:43], v[140:143], a[144:147], v[40:43]
    v_mul_f32 v64, v64, abs(v64)
    v_mfma_f32_16x16x32_bf16 v[44:47], v[136:139], a[132:135], v[44:47]
    v_mul_f32 v65, v65, abs(v65)
    v_mfma_f32_16x16x32_bf16 v[44:47], v[140:143], a[148:151], v[44:47]
    buffer_load_dwordx4 v[188:191], v5, s[8:11], s35 offen offset:3072
    buffer_load_dwordx4 v[192:195], v6, s[8:11], s35 offen offset:0
    v_mfma_f32_16x16x32_bf16 v[48:51], v[136:139], a[136:139], v[48:51]
    v_mul_f32 v66, v66, abs(v66)
    v_mfma_f32_16x16x32_bf16 v[48:51], v[140:143], a[152:155], v[48:51]
    v_mul_f32 v67, v67, abs(v67)
    v_mfma_f32_16x16x32_bf16 v[52:55], v[136:139], a[140:143], v[52:55]
    v_cvt_pk_bf16_f32 v64, v64, v65
    v_mfma_f32_16x16x32_bf16 v[52:55], v[140:143], a[156:159], v[52:55]
    buffer_load_dwordx4 v[196:199], v6, s[8:11], s35 offen offset:1024
    s_waitcnt vmcnt(12)
    v_mfma_f32_16x16x32_bf16 v[40:43], v[144:147], a[160:163], v[40:43]
    v_cvt_pk_bf16_f32 v65, v66, v67
    v_mfma_f32_16x16x32_bf16 v[40:43], v[148:151], a[176:179], v[40:43]
    v_pk_max_i16 v64, v64, 0
    v_mfma_f32_16x16x32_bf16 v[44:47], v[144:147], a[164:167], v[44:47]
    v_pk_max_i16 v65, v65, 0
    v_mfma_f32_16x16x32_bf16 v[44:47], v[148:151], a[180:183], v[44:47]
    buffer_load_dwordx4 v[200:203], v6, s[8:11], s35 offen offset:2048
    v_mfma_f32_16x16x32_bf16 v[48:51], v[144:147], a[168:171], v[48:51]
    ds_write_b64 v248, v[64:65] offset:2048
    v_mfma_f32_16x16x32_bf16 v[48:51], v[148:151], a[184:187], v[48:51]
    v_mul_f32 v68, v68, abs(v68)
    v_mfma_f32_16x16x32_bf16 v[52:55], v[144:147], a[172:175], v[52:55]
    v_mul_f32 v69, v69, abs(v69)
    v_mfma_f32_16x16x32_bf16 v[52:55], v[148:151], a[188:191], v[52:55]
    buffer_load_dwordx4 v[204:207], v6, s[8:11], s35 offen offset:3072
    s_waitcnt vmcnt(12)
    v_mfma_f32_16x16x32_bf16 v[40:43], v[152:155], a[192:195], v[40:43]
    v_mul_f32 v70, v70, abs(v70)
    v_mfma_f32_16x16x32_bf16 v[40:43], v[156:159], a[208:211], v[40:43]
    v_mul_f32 v71, v71, abs(v71)
    v_mfma_f32_16x16x32_bf16 v[44:47], v[152:155], a[196:199], v[44:47]
    v_cvt_pk_bf16_f32 v68, v68, v69
    v_mfma_f32_16x16x32_bf16 v[44:47], v[156:159], a[212:215], v[44:47]
    buffer_load_dwordx4 v[208:211], v7, s[8:11], s35 offen offset:0
    buffer_load_dwordx4 v[212:215], v7, s[8:11], s35 offen offset:1024
    v_mfma_f32_16x16x32_bf16 v[48:51], v[152:155], a[200:203], v[48:51]
    v_cvt_pk_bf16_f32 v69, v70, v71
    v_mfma_f32_16x16x32_bf16 v[48:51], v[156:159], a[216:219], v[48:51]
    v_pk_max_i16 v68, v68, 0
    v_mfma_f32_16x16x32_bf16 v[52:55], v[152:155], a[204:207], v[52:55]
    v_pk_max_i16 v69, v69, 0
    v_mfma_f32_16x16x32_bf16 v[52:55], v[156:159], a[220:223], v[52:55]
    buffer_load_dwordx4 v[216:219], v7, s[8:11], s35 offen offset:2048
    s_waitcnt vmcnt(13)
    v_mfma_f32_16x16x32_bf16 v[40:43], v[160:163], a[224:227], v[40:43]
    ds_write_b64 v248, v[68:69] offset:3072
    v_mfma_f32_16x16x32_bf16 v[40:43], v[164:167], a[240:243], v[40:43]
    v_lshlrev_b32 v20, 16, v30
    v_mfma_f32_16x16x32_bf16 v[44:47], v[160:163], a[228:231], v[44:47]
    v_and_b32 v21, 0xffff0000, v30
    v_mfma_f32_16x16x32_bf16 v[44:47], v[164:167], a[244:247], v[44:47]
    buffer_load_dwordx4 v[220:223], v7, s[8:11], s35 offen offset:3072
    v_mfma_f32_16x16x32_bf16 v[48:51], v[160:163], a[232:235], v[48:51]
    v_lshlrev_b32 v22, 16, v31
    v_mfma_f32_16x16x32_bf16 v[48:51], v[164:167], a[248:251], v[48:51]
    v_and_b32 v23, 0xffff0000, v31
    v_mfma_f32_16x16x32_bf16 v[52:55], v[160:163], a[236:239], v[52:55]
    v_mfma_f32_16x16x32_bf16 v[52:55], v[164:167], a[252:255], v[52:55]
    buffer_load_dwordx4 v[224:227], v8, s[8:11], s35 offen offset:0
    s_waitcnt vmcnt(13)
    v_mfma_f32_16x16x32_bf16 v[40:43], v[168:171], v[72:75], v[40:43]
    v_mfma_f32_16x16x32_bf16 v[40:43], v[172:175], v[88:91], v[40:43]
    v_mfma_f32_16x16x32_bf16 v[44:47], v[168:171], v[76:79], v[44:47]
    v_mfma_f32_16x16x32_bf16 v[44:47], v[172:175], v[92:95], v[44:47]
    buffer_load_dwordx4 v[228:231], v8, s[8:11], s35 offen offset:1024
    buffer_load_dwordx4 v[232:235], v8, s[8:11], s35 offen offset:2048
    v_mfma_f32_16x16x32_bf16 v[48:51], v[168:171], v[80:83], v[48:51]
    v_mfma_f32_16x16x32_bf16 v[48:51], v[172:175], v[96:99], v[48:51]
    v_mfma_f32_16x16x32_bf16 v[52:55], v[168:171], v[84:87], v[52:55]
    v_mfma_f32_16x16x32_bf16 v[52:55], v[172:175], v[100:103], v[52:55]
    buffer_load_dwordx4 v[236:239], v8, s[8:11], s35 offen offset:3072
    s_waitcnt vmcnt(14)
    v_mfma_f32_16x16x32_bf16 v[56:59], v[176:179], a[0:3], v[20:23]
    v_mfma_f32_16x16x32_bf16 v[56:59], v[180:183], a[16:19], v[56:59]
    v_mfma_f32_16x16x32_bf16 v[60:63], v[176:179], a[4:7], v[20:23]
    v_mfma_f32_16x16x32_bf16 v[60:63], v[180:183], a[20:23], v[60:63]
    buffer_load_dwordx4 v[240:243], v9, s[8:11], s35 offen offset:0
    v_mfma_f32_16x16x32_bf16 v[64:67], v[176:179], a[8:11], v[20:23]
    v_mfma_f32_16x16x32_bf16 v[64:67], v[180:183], a[24:27], v[64:67]
    v_mfma_f32_16x16x32_bf16 v[68:71], v[176:179], a[12:15], v[20:23]
    v_mfma_f32_16x16x32_bf16 v[68:71], v[180:183], a[28:31], v[68:71]
    buffer_load_dwordx4 v[244:247], v9, s[8:11], s35 offen offset:1024
    s_waitcnt vmcnt(14)
    v_mfma_f32_16x16x32_bf16 v[56:59], v[184:187], a[32:35], v[56:59]
    s_lshr_b32 s63, s52, 1
    s_lshl_b32 s63, s63, 12
    s_and_b32 s62, s52, 1
    s_lshl_b32 s62, s62, 3
    s_add_u32 s62, s62, s63
    v_add_u32 v248, s62, v11
    v_mfma_f32_16x16x32_bf16 v[56:59], v[188:191], a[48:51], v[56:59]
    v_mul_f32 v40, v40, abs(v40)
    v_mfma_f32_16x16x32_bf16 v[60:63], v[184:187], a[36:39], v[60:63]
    v_mul_f32 v41, v41, abs(v41)
    v_mfma_f32_16x16x32_bf16 v[60:63], v[188:191], a[52:55], v[60:63]
    buffer_load_dwordx4 v[104:107], v5, s[8:11], s36 offen offset:0
    buffer_load_dwordx4 v[108:111], v5, s[8:11], s36 offen offset:1024
    v_mfma_f32_16x16x32_bf16 v[64:67], v[184:187], a[40:43], v[64:67]
    v_mul_f32 v42, v42, abs(v42)
    v_mfma_f32_16x16x32_bf16 v[64:67], v[188:191], a[56:59], v[64:67]
    v_mul_f32 v43, v43, abs(v43)
    v_mfma_f32_16x16x32_bf16 v[68:71], v[184:187], a[44:47], v[68:71]
    v_cvt_pk_bf16_f32 v40, v40, v41
    v_mfma_f32_16x16x32_bf16 v[68:71], v[188:191], a[60:63], v[68:71]
    buffer_load_dwordx4 v[112:115], v5, s[8:11], s36 offen offset:2048
    s_waitcnt vmcnt(15)
    v_mfma_f32_16x16x32_bf16 v[56:59], v[192:195], a[64:67], v[56:59]
    v_cvt_pk_bf16_f32 v41, v42, v43
    v_mfma_f32_16x16x32_bf16 v[56:59], v[196:199], a[80:83], v[56:59]
    v_pk_max_i16 v40, v40, 0
    v_mfma_f32_16x16x32_bf16 v[60:63], v[192:195], a[68:71], v[60:63]
    v_pk_max_i16 v41, v41, 0
    v_mfma_f32_16x16x32_bf16 v[60:63], v[196:199], a[84:87], v[60:63]
    buffer_load_dwordx4 v[116:119], v5, s[8:11], s36 offen offset:3072
    v_mfma_f32_16x16x32_bf16 v[64:67], v[192:195], a[72:75], v[64:67]
    ds_write_b64 v248, v[40:41] offset:0
    v_mfma_f32_16x16x32_bf16 v[64:67], v[196:199], a[88:91], v[64:67]
    v_mul_f32 v44, v44, abs(v44)
    v_mfma_f32_16x16x32_bf16 v[68:71], v[192:195], a[76:79], v[68:71]
    v_mul_f32 v45, v45, abs(v45)
    v_mfma_f32_16x16x32_bf16 v[68:71], v[196:199], a[92:95], v[68:71]
    buffer_load_dwordx4 v[120:123], v6, s[8:11], s36 offen offset:0
    s_waitcnt vmcnt(15)
    v_mfma_f32_16x16x32_bf16 v[56:59], v[200:203], a[96:99], v[56:59]
    v_mul_f32 v46, v46, abs(v46)
    v_mfma_f32_16x16x32_bf16 v[56:59], v[204:207], a[112:115], v[56:59]
    v_mul_f32 v47, v47, abs(v47)
    v_mfma_f32_16x16x32_bf16 v[60:63], v[200:203], a[100:103], v[60:63]
    v_cvt_pk_bf16_f32 v44, v44, v45
    v_mfma_f32_16x16x32_bf16 v[60:63], v[204:207], a[116:119], v[60:63]
    buffer_load_dwordx4 v[124:127], v6, s[8:11], s36 offen offset:1024
    buffer_load_dwordx4 v[128:131], v6, s[8:11], s36 offen offset:2048
    v_mfma_f32_16x16x32_bf16 v[64:67], v[200:203], a[104:107], v[64:67]
    v_cvt_pk_bf16_f32 v45, v46, v47
    v_mfma_f32_16x16x32_bf16 v[64:67], v[204:207], a[120:123], v[64:67]
    v_pk_max_i16 v44, v44, 0
    v_mfma_f32_16x16x32_bf16 v[68:71], v[200:203], a[108:111], v[68:71]
    v_pk_max_i16 v45, v45, 0
    v_mfma_f32_16x16x32_bf16 v[68:71], v[204:207], a[124:127], v[68:71]
    buffer_load_dwordx4 v[132:135], v6, s[8:11], s36 offen offset:3072
    s_waitcnt vmcnt(16)
    v_mfma_f32_16x16x32_bf16 v[56:59], v[208:211], a[128:131], v[56:59]
    ds_write_b64 v248, v[44:45] offset:1024
    v_mfma_f32_16x16x32_bf16 v[56:59], v[212:215], a[144:147], v[56:59]
    v_mul_f32 v48, v48, abs(v48)
    v_mfma_f32_16x16x32_bf16 v[60:63], v[208:211], a[132:135], v[60:63]
    v_mul_f32 v49, v49, abs(v49)
    v_mfma_f32_16x16x32_bf16 v[60:63], v[212:215], a[148:151], v[60:63]
    buffer_load_dwordx4 v[136:139], v7, s[8:11], s36 offen offset:0
    v_mfma_f32_16x16x32_bf16 v[64:67], v[208:211], a[136:139], v[64:67]
    v_mul_f32 v50, v50, abs(v50)
    v_mfma_f32_16x16x32_bf16 v[64:67], v[212:215], a[152:155], v[64:67]
    v_mul_f32 v51, v51, abs(v51)
    v_mfma_f32_16x16x32_bf16 v[68:71], v[208:211], a[140:143], v[68:71]
    v_cvt_pk_bf16_f32 v48, v48, v49
    v_mfma_f32_16x16x32_bf16 v[68:71], v[212:215], a[156:159], v[68:71]
    buffer_load_dwordx4 v[140:143], v7, s[8:11], s36 offen offset:1024
    s_waitcnt vmcnt(16)
    v_mfma_f32_16x16x32_bf16 v[56:59], v[216:219], a[160:163], v[56:59]
    v_cvt_pk_bf16_f32 v49, v50, v51
    v_mfma_f32_16x16x32_bf16 v[56:59], v[220:223], a[176:179], v[56:59]
    v_pk_max_i16 v48, v48, 0
    v_mfma_f32_16x16x32_bf16 v[60:63], v[216:219], a[164:167], v[60:63]
    v_pk_max_i16 v49, v49, 0
    v_mfma_f32_16x16x32_bf16 v[60:63], v[220:223], a[180:183], v[60:63]
    buffer_load_dwordx4 v[144:147], v7, s[8:11], s36 offen offset:2048
    buffer_load_dwordx4 v[148:151], v7, s[8:11], s36 offen offset:3072
    v_mfma_f32_16x16x32_bf16 v[64:67], v[216:219], a[168:171], v[64:67]
    ds_write_b64 v248, v[48:49] offset:2048
    v_mfma_f32_16x16x32_bf16 v[64:67], v[220:223], a[184:187], v[64:67]
    v_mul_f32 v52, v52, abs(v52)
    v_mfma_f32_16x16x32_bf16 v[68:71], v[216:219], a[172:175], v[68:71]
    v_mul_f32 v53, v53, abs(v53)
    v_mfma_f32_16x16x32_bf16 v[68:71], v[220:223], a[188:191], v[68:71]
    buffer_load_dwordx4 v[152:155], v8, s[8:11], s36 offen offset:0
    s_waitcnt vmcnt(17)
    v_mfma_f32_16x16x32_bf16 v[56:59], v[224:227], a[192:195], v[56:59]
    v_mul_f32 v54, v54, abs(v54)
    v_mfma_f32_16x16x32_bf16 v[56:59], v[228:231], a[208:211], v[56:59]
    v_mul_f32 v55, v55, abs(v55)
    v_mfma_f32_16x16x32_bf16 v[60:63], v[224:227], a[196:199], v[60:63]
    v_cvt_pk_bf16_f32 v52, v52, v53
    v_mfma_f32_16x16x32_bf16 v[60:63], v[228:231], a[212:215], v[60:63]
    buffer_load_dwordx4 v[156:159], v8, s[8:11], s36 offen offset:1024
    v_mfma_f32_16x16x32_bf16 v[64:67], v[224:227], a[200:203], v[64:67]
    v_cvt_pk_bf16_f32 v53, v54, v55
    v_mfma_f32_16x16x32_bf16 v[64:67], v[228:231], a[216:219], v[64:67]
    v_pk_max_i16 v52, v52, 0
    v_mfma_f32_16x16x32_bf16 v[68:71], v[224:227], a[204:207], v[68:71]
    v_pk_max_i16 v53, v53, 0
    v_mfma_f32_16x16x32_bf16 v[68:71], v[228:231], a[220:223], v[68:71]
    buffer_load_dwordx4 v[160:163], v8, s[8:11], s36 offen offset:2048
    s_waitcnt vmcnt(17)
    v_mfma_f32_16x16x32_bf16 v[56:59], v[232:235], a[224:227], v[56:59]
    ds_write_b64 v248, v[52:53] offset:3072
    v_mfma_f32_16x16x32_bf16 v[56:59], v[236:239], a[240:243], v[56:59]
    v_lshlrev_b32 v16, 16, v32
    v_mfma_f32_16x16x32_bf16 v[60:63], v[232:235], a[228:231], v[60:63]
    v_and_b32 v17, 0xffff0000, v32
    v_mfma_f32_16x16x32_bf16 v[60:63], v[236:239], a[244:247], v[60:63]
    buffer_load_dwordx4 v[164:167], v8, s[8:11], s36 offen offset:3072
    buffer_load_dwordx4 v[168:171], v9, s[8:11], s36 offen offset:0
    v_mfma_f32_16x16x32_bf16 v[64:67], v[232:235], a[232:235], v[64:67]
    v_lshlrev_b32 v18, 16, v33
    v_mfma_f32_16x16x32_bf16 v[64:67], v[236:239], a[248:251], v[64:67]
    v_and_b32 v19, 0xffff0000, v33
    v_mfma_f32_16x16x32_bf16 v[68:71], v[232:235], a[236:239], v[68:71]
    v_mfma_f32_16x16x32_bf16 v[68:71], v[236:239], a[252:255], v[68:71]
    buffer_load_dwordx4 v[172:175], v9, s[8:11], s36 offen offset:1024
    s_waitcnt vmcnt(18)
    v_mfma_f32_16x16x32_bf16 v[56:59], v[240:243], v[72:75], v[56:59]
    v_mfma_f32_16x16x32_bf16 v[56:59], v[244:247], v[88:91], v[56:59]
    v_mfma_f32_16x16x32_bf16 v[60:63], v[240:243], v[76:79], v[60:63]
    v_mfma_f32_16x16x32_bf16 v[60:63], v[244:247], v[92:95], v[60:63]
    buffer_load_dwordx4 v[176:179], v5, s[8:11], s37 offen offset:0
    v_mfma_f32_16x16x32_bf16 v[64:67], v[240:243], v[80:83], v[64:67]
    v_mfma_f32_16x16x32_bf16 v[64:67], v[244:247], v[96:99], v[64:67]
    v_mfma_f32_16x16x32_bf16 v[68:71], v[240:243], v[84:87], v[68:71]
    v_mfma_f32_16x16x32_bf16 v[68:71], v[244:247], v[100:103], v[68:71]
    buffer_load_dwordx4 v[180:183], v5, s[8:11], s37 offen offset:1024
    s_waitcnt vmcnt(18)
    v_mfma_f32_16x16x32_bf16 v[40:43], v[104:107], a[0:3], v[16:19]
    v_mfma_f32_16x16x32_bf16 v[40:43], v[108:111], a[16:19], v[40:43]
    v_mfma_f32_16x16x32_bf16 v[44:47], v[104:107], a[4:7], v[16:19]
    v_mfma_f32_16x16x32_bf16 v[44:47], v[108:111], a[20:23], v[44:47]
    buffer_load_dwordx4 v[184:187], v5, s[8:11], s37 offen offset:2048
    buffer_load_dwordx4 v[188:191], v5, s[8:11], s37 offen offset:3072
    v_mfma_f32_16x16x32_bf16 v[48:51], v[104:107], a[8:11], v[16:19]
    v_mfma_f32_16x16x32_bf16 v[48:51], v[108:111], a[24:27], v[48:51]
    v_mfma_f32_16x16x32_bf16 v[52:55], v[104:107], a[12:15], v[16:19]
    v_mfma_f32_16x16x32_bf16 v[52:55], v[108:111], a[28:31], v[52:55]
    buffer_load_dwordx4 v[192:195], v6, s[8:11], s37 offen offset:0
    s_waitcnt vmcnt(19)
    v_mfma_f32_16x16x32_bf16 v[40:43], v[112:115], a[32:35], v[40:43]
    s_lshr_b32 s63, s53, 1
    s_lshl_b32 s63, s63, 12
    s_and_b32 s62, s53, 1
    s_lshl_b32 s62, s62, 3
    s_add_u32 s62, s62, s63
    v_add_u32 v248, s62, v11
    v_mfma_f32_16x16x32_bf16 v[40:43], v[116:119], a[48:51], v[40:43]
    v_mul_f32 v56, v56, abs(v56)
    v_mfma_f32_16x16x32_bf16 v[44:47], v[112:115], a[36:39], v[44:47]
    v_mul_f32 v57, v57, abs(v57)
    v_mfma_f32_16x16x32_bf16 v[44:47], v[116:119], a[52:55], v[44:47]
    buffer_load_dwordx4 v[196:199], v6, s[8:11], s37 offen offset:1024
    v_mfma_f32_16x16x32_bf16 v[48:51], v[112:115], a[40:43], v[48:51]
    v_mul_f32 v58, v58, abs(v58)
    v_mfma_f32_16x16x32_bf16 v[48:51], v[116:119], a[56:59], v[48:51]
    v_mul_f32 v59, v59, abs(v59)
    v_mfma_f32_16x16x32_bf16 v[52:55], v[112:115], a[44:47], v[52:55]
    v_cvt_pk_bf16_f32 v56, v56, v57
    v_mfma_f32_16x16x32_bf16 v[52:55], v[116:119], a[60:63], v[52:55]
    buffer_load_dwordx4 v[200:203], v6, s[8:11], s37 offen offset:2048
    s_waitcnt vmcnt(19)
    v_mfma_f32_16x16x32_bf16 v[40:43], v[120:123], a[64:67], v[40:43]
    v_cvt_pk_bf16_f32 v57, v58, v59
    v_mfma_f32_16x16x32_bf16 v[40:43], v[124:127], a[80:83], v[40:43]
    v_pk_max_i16 v56, v56, 0
    v_mfma_f32_16x16x32_bf16 v[44:47], v[120:123], a[68:71], v[44:47]
    v_pk_max_i16 v57, v57, 0
    v_mfma_f32_16x16x32_bf16 v[44:47], v[124:127], a[84:87], v[44:47]
    buffer_load_dwordx4 v[204:207], v6, s[8:11], s37 offen offset:3072
    buffer_load_dwordx4 v[208:211], v7, s[8:11], s37 offen offset:0
    v_mfma_f32_16x16x32_bf16 v[48:51], v[120:123], a[72:75], v[48:51]
    ds_write_b64 v248, v[56:57] offset:0
    v_mfma_f32_16x16x32_bf16 v[48:51], v[124:127], a[88:91], v[48:51]
    v_mul_f32 v60, v60, abs(v60)
    v_mfma_f32_16x16x32_bf16 v[52:55], v[120:123], a[76:79], v[52:55]
    v_mul_f32 v61, v61, abs(v61)
    v_mfma_f32_16x16x32_bf16 v[52:55], v[124:127], a[92:95], v[52:55]
    buffer_load_dwordx4 v[212:215], v7, s[8:11], s37 offen offset:1024
    s_waitcnt vmcnt(20)
    v_mfma_f32_16x16x32_bf16 v[40:43], v[128:131], a[96:99], v[40:43]
    v_mul_f32 v62, v62, abs(v62)
    v_mfma_f32_16x16x32_bf16 v[40:43], v[132:135], a[112:115], v[40:43]
    v_mul_f32 v63, v63, abs(v63)
    v_mfma_f32_16x16x32_bf16 v[44:47], v[128:131], a[100:103], v[44:47]
    v_cvt_pk_bf16_f32 v60, v60, v61
    v_mfma_f32_16x16x32_bf16 v[44:47], v[132:135], a[116:119], v[44:47]
    buffer_load_dwordx4 v[216:219], v7, s[8:11], s37 offen offset:2048
    v_mfma_f32_16x16x32_bf16 v[48:51], v[128:131], a[104:107], v[48:51]
    v_cvt_pk_bf16_f32 v61, v62, v63
    v_mfma_f32_16x16x32_bf16 v[48:51], v[132:135], a[120:123], v[48:51]
    v_pk_max_i16 v60, v60, 0
    v_mfma_f32_16x16x32_bf16 v[52:55], v[128:131], a[108:111], v[52:55]
    v_pk_max_i16 v61, v61, 0
    v_mfma_f32_16x16x32_bf16 v[52:55], v[132:135], a[124:127], v[52:55]
    buffer_load_dwordx4 v[220:223], v7, s[8:11], s37 offen offset:3072
    s_waitcnt vmcnt(20)
    v_mfma_f32_16x16x32_bf16 v[40:43], v[136:139], a[128:131], v[40:43]
    ds_write_b64 v248, v[60:61] offset:1024
    v_mfma_f32_16x16x32_bf16 v[40:43], v[140:143], a[144:147], v[40:43]
    v_mul_f32 v64, v64, abs(v64)
    v_mfma_f32_16x16x32_bf16 v[44:47], v[136:139], a[132:135], v[44:47]
    v_mul_f32 v65, v65, abs(v65)
    v_mfma_f32_16x16x32_bf16 v[44:47], v[140:143], a[148:151], v[44:47]
    buffer_load_dwordx4 v[224:227], v8, s[8:11], s37 offen offset:0
    v_mfma_f32_16x16x32_bf16 v[48:51], v[136:139], a[136:139], v[48:51]
    v_mul_f32 v66, v66, abs(v66)
    v_mfma_f32_16x16x32_bf16 v[48:51], v[140:143], a[152:155], v[48:51]
    v_mul_f32 v67, v67, abs(v67)
    v_mfma_f32_16x16x32_bf16 v[52:55], v[136:139], a[140:143], v[52:55]
    v_cvt_pk_bf16_f32 v64, v64, v65
    v_mfma_f32_16x16x32_bf16 v[52:55], v[140:143], a[156:159], v[52:55]
    buffer_load_dwordx4 v[228:231], v8, s[8:11], s37 offen offset:1024
    s_waitcnt vmcnt(20)
    v_mfma_f32_16x16x32_bf16 v[40:43], v[144:147], a[160:163], v[40:43]
    v_cvt_pk_bf16_f32 v65, v66, v67
    v_mfma_f32_16x16x32_bf16 v[40:43], v[148:151], a[176:179], v[40:43]
    v_pk_max_i16 v64, v64, 0
    v_mfma_f32_16x16x32_bf16 v[44:47], v[144:147], a[164:167], v[44:47]
    v_pk_max_i16 v65, v65, 0
    v_mfma_f32_16x16x32_bf16 v[44:47], v[148:151], a[180:183], v[44:47]
    buffer_load_dwordx4 v[232:235], v8, s[8:11], s37 offen offset:2048
    v_mfma_f32_16x16x32_bf16 v[48:51], v[144:147], a[168:171], v[48:51]
    ds_write_b64 v248, v[64:65] offset:2048
    v_mfma_f32_16x16x32_bf16 v[48:51], v[148:151], a[184:187], v[48:51]
    v_mul_f32 v68, v68, abs(v68)
    v_mfma_f32_16x16x32_bf16 v[52:55], v[144:147], a[172:175], v[52:55]
    v_mul_f32 v69, v69, abs(v69)
    v_mfma_f32_16x16x32_bf16 v[52:55], v[148:151], a[188:191], v[52:55]
    buffer_load_dwordx4 v[236:239], v8, s[8:11], s37 offen offset:3072
    s_waitcnt vmcnt(20)
    v_mfma_f32_16x16x32_bf16 v[40:43], v[152:155], a[192:195], v[40:43]
    v_mul_f32 v70, v70, abs(v70)
    v_mfma_f32_16x16x32_bf16 v[40:43], v[156:159], a[208:211], v[40:43]
    v_mul_f32 v71, v71, abs(v71)
    v_mfma_f32_16x16x32_bf16 v[44:47], v[152:155], a[196:199], v[44:47]
    v_cvt_pk_bf16_f32 v68, v68, v69
    v_mfma_f32_16x16x32_bf16 v[44:47], v[156:159], a[212:215], v[44:47]
    buffer_load_dwordx4 v[240:243], v9, s[8:11], s37 offen offset:0
    v_mfma_f32_16x16x32_bf16 v[48:51], v[152:155], a[200:203], v[48:51]
    v_cvt_pk_bf16_f32 v69, v70, v71
    v_mfma_f32_16x16x32_bf16 v[48:51], v[156:159], a[216:219], v[48:51]
    v_pk_max_i16 v68, v68, 0
    v_mfma_f32_16x16x32_bf16 v[52:55], v[152:155], a[204:207], v[52:55]
    v_pk_max_i16 v69, v69, 0
    v_mfma_f32_16x16x32_bf16 v[52:55], v[156:159], a[220:223], v[52:55]
    buffer_load_dwordx4 v[244:247], v9, s[8:11], s37 offen offset:1024
    s_waitcnt vmcnt(20)
    v_mfma_f32_16x16x32_bf16 v[40:43], v[160:163], a[224:227], v[40:43]
    ds_write_b64 v248, v[68:69] offset:3072
    v_mfma_f32_16x16x32_bf16 v[40:43], v[164:167], a[240:243], v[40:43]
    v_lshlrev_b32 v20, 16, v34
    v_mfma_f32_16x16x32_bf16 v[44:47], v[160:163], a[228:231], v[44:47]
    v_and_b32 v21, 0xffff0000, v34
    v_mfma_f32_16x16x32_bf16 v[44:47], v[164:167], a[244:247], v[44:47]
    buffer_load_dwordx4 v[104:107], v5, s[8:11], s38 offen offset:0
    v_mfma_f32_16x16x32_bf16 v[48:51], v[160:163], a[232:235], v[48:51]
    v_lshlrev_b32 v22, 16, v35
    v_mfma_f32_16x16x32_bf16 v[48:51], v[164:167], a[248:251], v[48:51]
    v_and_b32 v23, 0xffff0000, v35
    v_mfma_f32_16x16x32_bf16 v[52:55], v[160:163], a[236:239], v[52:55]
    v_mfma_f32_16x16x32_bf16 v[52:55], v[164:167], a[252:255], v[52:55]
    buffer_load_dwordx4 v[108:111], v5, s[8:11], s38 offen offset:1024
    s_waitcnt vmcnt(20)
    v_mfma_f32_16x16x32_bf16 v[40:43], v[168:171], v[72:75], v[40:43]
    v_mfma_f32_16x16x32_bf16 v[40:43], v[172:175], v[88:91], v[40:43]
    v_mfma_f32_16x16x32_bf16 v[44:47], v[168:171], v[76:79], v[44:47]
    v_mfma_f32_16x16x32_bf16 v[44:47], v[172:175], v[92:95], v[44:47]
    buffer_load_dwordx4 v[112:115], v5, s[8:11], s38 offen offset:2048
    v_mfma_f32_16x16x32_bf16 v[48:51], v[168:171], v[80:83], v[48:51]
    v_mfma_f32_16x16x32_bf16 v[48:51], v[172:175], v[96:99], v[48:51]
    v_mfma_f32_16x16x32_bf16 v[52:55], v[168:171], v[84:87], v[52:55]
    v_mfma_f32_16x16x32_bf16 v[52:55], v[172:175], v[100:103], v[52:55]
    buffer_load_dwordx4 v[116:119], v5, s[8:11], s38 offen offset:3072
    s_waitcnt vmcnt(20)
    v_mfma_f32_16x16x32_bf16 v[56:59], v[176:179], a[0:3], v[20:23]
    v_mfma_f32_16x16x32_bf16 v[56:59], v[180:183], a[16:19], v[56:59]
    v_mfma_f32_16x16x32_bf16 v[60:63], v[176:179], a[4:7], v[20:23]
    v_mfma_f32_16x16x32_bf16 v[60:63], v[180:183], a[20:23], v[60:63]
    buffer_load_dwordx4 v[120:123], v6, s[8:11], s38 offen offset:0
    v_mfma_f32_16x16x32_bf16 v[64:67], v[176:179], a[8:11], v[20:23]
    v_mfma_f32_16x16x32_bf16 v[64:67], v[180:183], a[24:27], v[64:67]
    v_mfma_f32_16x16x32_bf16 v[68:71], v[176:179], a[12:15], v[20:23]
    v_mfma_f32_16x16x32_bf16 v[68:71], v[180:183], a[28:31], v[68:71]
    buffer_load_dwordx4 v[124:127], v6, s[8:11], s38 offen offset:1024
    s_waitcnt vmcnt(20)
    v_mfma_f32_16x16x32_bf16 v[56:59], v[184:187], a[32:35], v[56:59]
    s_lshr_b32 s63, s54, 1
    s_lshl_b32 s63, s63, 12
    s_and_b32 s62, s54, 1
    s_lshl_b32 s62, s62, 3
    s_add_u32 s62, s62, s63
    v_add_u32 v248, s62, v11
    v_mfma_f32_16x16x32_bf16 v[56:59], v[188:191], a[48:51], v[56:59]
    v_mul_f32 v40, v40, abs(v40)
    v_mfma_f32_16x16x32_bf16 v[60:63], v[184:187], a[36:39], v[60:63]
    v_mul_f32 v41, v41, abs(v41)
    v_mfma_f32_16x16x32_bf16 v[60:63], v[188:191], a[52:55], v[60:63]
    buffer_load_dwordx4 v[128:131], v6, s[8:11], s38 offen offset:2048
    v_mfma_f32_16x16x32_bf16 v[64:67], v[184:187], a[40:43], v[64:67]
    v_mul_f32 v42, v42, abs(v42)
    v_mfma_f32_16x16x32_bf16 v[64:67], v[188:191], a[56:59], v[64:67]
    v_mul_f32 v43, v43, abs(v43)
    v_mfma_f32_16x16x32_bf16 v[68:71], v[184:187], a[44:47], v[68:71]
    v_cvt_pk_bf16_f32 v40, v40, v41
    v_mfma_f32_16x16x32_bf16 v[68:71], v[188:191], a[60:63], v[68:71]
    buffer_load_dwordx4 v[132:135], v6, s[8:11], s38 offen offset:3072
    s_waitcnt vmcnt(20)
    v_mfma_f32_16x16x32_bf16 v[56:59], v[192:195], a[64:67], v[56:59]
    v_cvt_pk_bf16_f32 v41, v42, v43
    v_mfma_f32_16x16x32_bf16 v[56:59], v[196:199], a[80:83], v[56:59]
    v_pk_max_i16 v40, v40, 0
    v_mfma_f32_16x16x32_bf16 v[60:63], v[192:195], a[68:71], v[60:63]
    v_pk_max_i16 v41, v41, 0
    v_mfma_f32_16x16x32_bf16 v[60:63], v[196:199], a[84:87], v[60:63]
    buffer_load_dwordx4 v[136:139], v7, s[8:11], s38 offen offset:0
    v_mfma_f32_16x16x32_bf16 v[64:67], v[192:195], a[72:75], v[64:67]
    ds_write_b64 v248, v[40:41] offset:0
    v_mfma_f32_16x16x32_bf16 v[64:67], v[196:199], a[88:91], v[64:67]
    v_mul_f32 v44, v44, abs(v44)
    v_mfma_f32_16x16x32_bf16 v[68:71], v[192:195], a[76:79], v[68:71]
    v_mul_f32 v45, v45, abs(v45)
    v_mfma_f32_16x16x32_bf16 v[68:71], v[196:199], a[92:95], v[68:71]
    buffer_load_dwordx4 v[140:143], v7, s[8:11], s38 offen offset:1024
    s_waitcnt vmcnt(20)
    v_mfma_f32_16x16x32_bf16 v[56:59], v[200:203], a[96:99], v[56:59]
    v_mul_f32 v46, v46, abs(v46)
    v_mfma_f32_16x16x32_bf16 v[56:59], v[204:207], a[112:115], v[56:59]
    v_mul_f32 v47, v47, abs(v47)
    v_mfma_f32_16x16x32_bf16 v[60:63], v[200:203], a[100:103], v[60:63]
    v_cvt_pk_bf16_f32 v44, v44, v45
    v_mfma_f32_16x16x32_bf16 v[60:63], v[204:207], a[116:119], v[60:63]
    buffer_load_dwordx4 v[144:147], v7, s[8:11], s38 offen offset:2048
    v_mfma_f32_16x16x32_bf16 v[64:67], v[200:203], a[104:107], v[64:67]
    v_cvt_pk_bf16_f32 v45, v46, v47
    v_mfma_f32_16x16x32_bf16 v[64:67], v[204:207], a[120:123], v[64:67]
    v_pk_max_i16 v44, v44, 0
    v_mfma_f32_16x16x32_bf16 v[68:71], v[200:203], a[108:111], v[68:71]
    v_pk_max_i16 v45, v45, 0
    v_mfma_f32_16x16x32_bf16 v[68:71], v[204:207], a[124:127], v[68:71]
    buffer_load_dwordx4 v[148:151], v7, s[8:11], s38 offen offset:3072
    s_waitcnt vmcnt(20)
    v_mfma_f32_16x16x32_bf16 v[56:59], v[208:211], a[128:131], v[56:59]
    ds_write_b64 v248, v[44:45] offset:1024
    v_mfma_f32_16x16x32_bf16 v[56:59], v[212:215], a[144:147], v[56:59]
    v_mul_f32 v48, v48, abs(v48)
    v_mfma_f32_16x16x32_bf16 v[60:63], v[208:211], a[132:135], v[60:63]
    v_mul_f32 v49, v49, abs(v49)
    v_mfma_f32_16x16x32_bf16 v[60:63], v[212:215], a[148:151], v[60:63]
    buffer_load_dwordx4 v[152:155], v8, s[8:11], s38 offen offset:0
    v_mfma_f32_16x16x32_bf16 v[64:67], v[208:211], a[136:139], v[64:67]
    v_mul_f32 v50, v50, abs(v50)
    v_mfma_f32_16x16x32_bf16 v[64:67], v[212:215], a[152:155], v[64:67]
    v_mul_f32 v51, v51, abs(v51)
    v_mfma_f32_16x16x32_bf16 v[68:71], v[208:211], a[140:143], v[68:71]
    v_cvt_pk_bf16_f32 v48, v48, v49
    v_mfma_f32_16x16x32_bf16 v[68:71], v[212:215], a[156:159], v[68:71]
    buffer_load_dwordx4 v[156:159], v8, s[8:11], s38 offen offset:1024
    s_waitcnt vmcnt(20)
    v_mfma_f32_16x16x32_bf16 v[56:59], v[216:219], a[160:163], v[56:59]
    v_cvt_pk_bf16_f32 v49, v50, v51
    v_mfma_f32_16x16x32_bf16 v[56:59], v[220:223], a[176:179], v[56:59]
    v_pk_max_i16 v48, v48, 0
    v_mfma_f32_16x16x32_bf16 v[60:63], v[216:219], a[164:167], v[60:63]
    v_pk_max_i16 v49, v49, 0
    v_mfma_f32_16x16x32_bf16 v[60:63], v[220:223], a[180:183], v[60:63]
    buffer_load_dwordx4 v[160:163], v8, s[8:11], s38 offen offset:2048
    v_mfma_f32_16x16x32_bf16 v[64:67], v[216:219], a[168:171], v[64:67]
    ds_write_b64 v248, v[48:49] offset:2048
    v_mfma_f32_16x16x32_bf16 v[64:67], v[220:223], a[184:187], v[64:67]
    v_mul_f32 v52, v52, abs(v52)
    v_mfma_f32_16x16x32_bf16 v[68:71], v[216:219], a[172:175], v[68:71]
    v_mul_f32 v53, v53, abs(v53)
    v_mfma_f32_16x16x32_bf16 v[68:71], v[220:223], a[188:191], v[68:71]
    buffer_load_dwordx4 v[164:167], v8, s[8:11], s38 offen offset:3072
    s_waitcnt vmcnt(20)
    v_mfma_f32_16x16x32_bf16 v[56:59], v[224:227], a[192:195], v[56:59]
    v_mul_f32 v54, v54, abs(v54)
    v_mfma_f32_16x16x32_bf16 v[56:59], v[228:231], a[208:211], v[56:59]
    v_mul_f32 v55, v55, abs(v55)
    v_mfma_f32_16x16x32_bf16 v[60:63], v[224:227], a[196:199], v[60:63]
    v_cvt_pk_bf16_f32 v52, v52, v53
    v_mfma_f32_16x16x32_bf16 v[60:63], v[228:231], a[212:215], v[60:63]
    buffer_load_dwordx4 v[168:171], v9, s[8:11], s38 offen offset:0
    v_mfma_f32_16x16x32_bf16 v[64:67], v[224:227], a[200:203], v[64:67]
    v_cvt_pk_bf16_f32 v53, v54, v55
    v_mfma_f32_16x16x32_bf16 v[64:67], v[228:231], a[216:219], v[64:67]
    v_pk_max_i16 v52, v52, 0
    v_mfma_f32_16x16x32_bf16 v[68:71], v[224:227], a[204:207], v[68:71]
    v_pk_max_i16 v53, v53, 0
    v_mfma_f32_16x16x32_bf16 v[68:71], v[228:231], a[220:223], v[68:71]
    buffer_load_dwordx4 v[172:175], v9, s[8:11], s38 offen offset:1024
    s_waitcnt vmcnt(20)
    v_mfma_f32_16x16x32_bf16 v[56:59], v[232:235], a[224:227], v[56:59]
    ds_write_b64 v248, v[52:53] offset:3072
    v_mfma_f32_16x16x32_bf16 v[56:59], v[236:239], a[240:243], v[56:59]
    v_lshlrev_b32 v16, 16, v36
    v_mfma_f32_16x16x32_bf16 v[60:63], v[232:235], a[228:231], v[60:63]
    v_and_b32 v17, 0xffff0000, v36
    v_mfma_f32_16x16x32_bf16 v[60:63], v[236:239], a[244:247], v[60:63]
    buffer_load_dwordx4 v[176:179], v5, s[8:11], s39 offen offset:0
    v_mfma_f32_16x16x32_bf16 v[64:67], v[232:235], a[232:235], v[64:67]
    v_lshlrev_b32 v18, 16, v37
    v_mfma_f32_16x16x32_bf16 v[64:67], v[236:239], a[248:251], v[64:67]
    v_and_b32 v19, 0xffff0000, v37
    v_mfma_f32_16x16x32_bf16 v[68:71], v[232:235], a[236:239], v[68:71]
    v_mfma_f32_16x16x32_bf16 v[68:71], v[236:239], a[252:255], v[68:71]
    buffer_load_dwordx4 v[180:183], v5, s[8:11], s39 offen offset:1024
    s_waitcnt vmcnt(20)
    v_mfma_f32_16x16x32_bf16 v[56:59], v[240:243], v[72:75], v[56:59]
    v_mfma_f32_16x16x32_bf16 v[56:59], v[244:247], v[88:91], v[56:59]
    v_mfma_f32_16x16x32_bf16 v[60:63], v[240:243], v[76:79], v[60:63]
    v_mfma_f32_16x16x32_bf16 v[60:63], v[244:247], v[92:95], v[60:63]
    buffer_load_dwordx4 v[184:187], v5, s[8:11], s39 offen offset:2048
    v_mfma_f32_16x16x32_bf16 v[64:67], v[240:243], v[80:83], v[64:67]
    v_mfma_f32_16x16x32_bf16 v[64:67], v[244:247], v[96:99], v[64:67]
    v_mfma_f32_16x16x32_bf16 v[68:71], v[240:243], v[84:87], v[68:71]
    v_mfma_f32_16x16x32_bf16 v[68:71], v[244:247], v[100:103], v[68:71]
    buffer_load_dwordx4 v[188:191], v5, s[8:11], s39 offen offset:3072
    s_waitcnt vmcnt(20)
    v_mfma_f32_16x16x32_bf16 v[40:43], v[104:107], a[0:3], v[16:19]
    v_mfma_f32_16x16x32_bf16 v[40:43], v[108:111], a[16:19], v[40:43]
    v_mfma_f32_16x16x32_bf16 v[44:47], v[104:107], a[4:7], v[16:19]
    v_mfma_f32_16x16x32_bf16 v[44:47], v[108:111], a[20:23], v[44:47]
    buffer_load_dwordx4 v[192:195], v6, s[8:11], s39 offen offset:0
    v_mfma_f32_16x16x32_bf16 v[48:51], v[104:107], a[8:11], v[16:19]
    v_mfma_f32_16x16x32_bf16 v[48:51], v[108:111], a[24:27], v[48:51]
    v_mfma_f32_16x16x32_bf16 v[52:55], v[104:107], a[12:15], v[16:19]
    v_mfma_f32_16x16x32_bf16 v[52:55], v[108:111], a[28:31], v[52:55]
    buffer_load_dwordx4 v[196:199], v6, s[8:11], s39 offen offset:1024
    s_waitcnt vmcnt(20)
    v_mfma_f32_16x16x32_bf16 v[40:43], v[112:115], a[32:35], v[40:43]
    s_lshr_b32 s63, s55, 1
    s_lshl_b32 s63, s63, 12
    s_and_b32 s62, s55, 1
    s_lshl_b32 s62, s62, 3
    s_add_u32 s62, s62, s63
    v_add_u32 v248, s62, v11
    v_mfma_f32_16x16x32_bf16 v[40:43], v[116:119], a[48:51], v[40:43]
    v_mul_f32 v56, v56, abs(v56)
    v_mfma_f32_16x16x32_bf16 v[44:47], v[112:115], a[36:39], v[44:47]
    v_mul_f32 v57, v57, abs(v57)
    v_mfma_f32_16x16x32_bf16 v[44:47], v[116:119], a[52:55], v[44:47]
    buffer_load_dwordx4 v[200:203], v6, s[8:11], s39 offen offset:2048
    v_mfma_f32_16x16x32_bf16 v[48:51], v[112:115], a[40:43], v[48:51]
    v_mul_f32 v58, v58, abs(v58)
    v_mfma_f32_16x16x32_bf16 v[48:51], v[116:119], a[56:59], v[48:51]
    v_mul_f32 v59, v59, abs(v59)
    v_mfma_f32_16x16x32_bf16 v[52:55], v[112:115], a[44:47], v[52:55]
    v_cvt_pk_bf16_f32 v56, v56, v57
    v_mfma_f32_16x16x32_bf16 v[52:55], v[116:119], a[60:63], v[52:55]
    buffer_load_dwordx4 v[204:207], v6, s[8:11], s39 offen offset:3072
    s_waitcnt vmcnt(20)
    v_mfma_f32_16x16x32_bf16 v[40:43], v[120:123], a[64:67], v[40:43]
    v_cvt_pk_bf16_f32 v57, v58, v59
    v_mfma_f32_16x16x32_bf16 v[40:43], v[124:127], a[80:83], v[40:43]
    v_pk_max_i16 v56, v56, 0
    v_mfma_f32_16x16x32_bf16 v[44:47], v[120:123], a[68:71], v[44:47]
    v_pk_max_i16 v57, v57, 0
    v_mfma_f32_16x16x32_bf16 v[44:47], v[124:127], a[84:87], v[44:47]
    buffer_load_dwordx4 v[208:211], v7, s[8:11], s39 offen offset:0
    v_mfma_f32_16x16x32_bf16 v[48:51], v[120:123], a[72:75], v[48:51]
    ds_write_b64 v248, v[56:57] offset:0
    v_mfma_f32_16x16x32_bf16 v[48:51], v[124:127], a[88:91], v[48:51]
    v_mul_f32 v60, v60, abs(v60)
    v_mfma_f32_16x16x32_bf16 v[52:55], v[120:123], a[76:79], v[52:55]
    v_mul_f32 v61, v61, abs(v61)
    v_mfma_f32_16x16x32_bf16 v[52:55], v[124:127], a[92:95], v[52:55]
    buffer_load_dwordx4 v[212:215], v7, s[8:11], s39 offen offset:1024
    s_waitcnt vmcnt(20)
    v_mfma_f32_16x16x32_bf16 v[40:43], v[128:131], a[96:99], v[40:43]
    v_mul_f32 v62, v62, abs(v62)
    v_mfma_f32_16x16x32_bf16 v[40:43], v[132:135], a[112:115], v[40:43]
    v_mul_f32 v63, v63, abs(v63)
    v_mfma_f32_16x16x32_bf16 v[44:47], v[128:131], a[100:103], v[44:47]
    v_cvt_pk_bf16_f32 v60, v60, v61
    v_mfma_f32_16x16x32_bf16 v[44:47], v[132:135], a[116:119], v[44:47]
    buffer_load_dwordx4 v[216:219], v7, s[8:11], s39 offen offset:2048
    v_mfma_f32_16x16x32_bf16 v[48:51], v[128:131], a[104:107], v[48:51]
    v_cvt_pk_bf16_f32 v61, v62, v63
    v_mfma_f32_16x16x32_bf16 v[48:51], v[132:135], a[120:123], v[48:51]
    v_pk_max_i16 v60, v60, 0
    v_mfma_f32_16x16x32_bf16 v[52:55], v[128:131], a[108:111], v[52:55]
    v_pk_max_i16 v61, v61, 0
    v_mfma_f32_16x16x32_bf16 v[52:55], v[132:135], a[124:127], v[52:55]
    buffer_load_dwordx4 v[220:223], v7, s[8:11], s39 offen offset:3072
    s_waitcnt vmcnt(20)
    v_mfma_f32_16x16x32_bf16 v[40:43], v[136:139], a[128:131], v[40:43]
    ds_write_b64 v248, v[60:61] offset:1024
    v_mfma_f32_16x16x32_bf16 v[40:43], v[140:143], a[144:147], v[40:43]
    v_mul_f32 v64, v64, abs(v64)
    v_mfma_f32_16x16x32_bf16 v[44:47], v[136:139], a[132:135], v[44:47]
    v_mul_f32 v65, v65, abs(v65)
    v_mfma_f32_16x16x32_bf16 v[44:47], v[140:143], a[148:151], v[44:47]
    buffer_load_dwordx4 v[224:227], v8, s[8:11], s39 offen offset:0
    v_mfma_f32_16x16x32_bf16 v[48:51], v[136:139], a[136:139], v[48:51]
    v_mul_f32 v66, v66, abs(v66)
    v_mfma_f32_16x16x32_bf16 v[48:51], v[140:143], a[152:155], v[48:51]
    v_mul_f32 v67, v67, abs(v67)
    v_mfma_f32_16x16x32_bf16 v[52:55], v[136:139], a[140:143], v[52:55]
    v_cvt_pk_bf16_f32 v64, v64, v65
    v_mfma_f32_16x16x32_bf16 v[52:55], v[140:143], a[156:159], v[52:55]
    buffer_load_dwordx4 v[228:231], v8, s[8:11], s39 offen offset:1024
    s_waitcnt vmcnt(20)
    v_mfma_f32_16x16x32_bf16 v[40:43], v[144:147], a[160:163], v[40:43]
    v_cvt_pk_bf16_f32 v65, v66, v67
    v_mfma_f32_16x16x32_bf16 v[40:43], v[148:151], a[176:179], v[40:43]
    v_pk_max_i16 v64, v64, 0
    v_mfma_f32_16x16x32_bf16 v[44:47], v[144:147], a[164:167], v[44:47]
    v_pk_max_i16 v65, v65, 0
    v_mfma_f32_16x16x32_bf16 v[44:47], v[148:151], a[180:183], v[44:47]
    buffer_load_dwordx4 v[232:235], v8, s[8:11], s39 offen offset:2048
    v_mfma_f32_16x16x32_bf16 v[48:51], v[144:147], a[168:171], v[48:51]
    ds_write_b64 v248, v[64:65] offset:2048
    v_mfma_f32_16x16x32_bf16 v[48:51], v[148:151], a[184:187], v[48:51]
    v_mul_f32 v68, v68, abs(v68)
    v_mfma_f32_16x16x32_bf16 v[52:55], v[144:147], a[172:175], v[52:55]
    v_mul_f32 v69, v69, abs(v69)
    v_mfma_f32_16x16x32_bf16 v[52:55], v[148:151], a[188:191], v[52:55]
    buffer_load_dwordx4 v[236:239], v8, s[8:11], s39 offen offset:3072
    s_waitcnt vmcnt(20)
    v_mfma_f32_16x16x32_bf16 v[40:43], v[152:155], a[192:195], v[40:43]
    v_mul_f32 v70, v70, abs(v70)
    v_mfma_f32_16x16x32_bf16 v[40:43], v[156:159], a[208:211], v[40:43]
    v_mul_f32 v71, v71, abs(v71)
    v_mfma_f32_16x16x32_bf16 v[44:47], v[152:155], a[196:199], v[44:47]
    v_cvt_pk_bf16_f32 v68, v68, v69
    v_mfma_f32_16x16x32_bf16 v[44:47], v[156:159], a[212:215], v[44:47]
    buffer_load_dwordx4 v[240:243], v9, s[8:11], s39 offen offset:0
    v_mfma_f32_16x16x32_bf16 v[48:51], v[152:155], a[200:203], v[48:51]
    v_cvt_pk_bf16_f32 v69, v70, v71
    v_mfma_f32_16x16x32_bf16 v[48:51], v[156:159], a[216:219], v[48:51]
    v_pk_max_i16 v68, v68, 0
    v_mfma_f32_16x16x32_bf16 v[52:55], v[152:155], a[204:207], v[52:55]
    v_pk_max_i16 v69, v69, 0
    v_mfma_f32_16x16x32_bf16 v[52:55], v[156:159], a[220:223], v[52:55]
    buffer_load_dwordx4 v[244:247], v9, s[8:11], s39 offen offset:1024
    s_waitcnt vmcnt(20)
    v_mfma_f32_16x16x32_bf16 v[40:43], v[160:163], a[224:227], v[40:43]
    ds_write_b64 v248, v[68:69] offset:3072
    v_mfma_f32_16x16x32_bf16 v[40:43], v[164:167], a[240:243], v[40:43]
    v_lshlrev_b32 v20, 16, v38
    v_mfma_f32_16x16x32_bf16 v[44:47], v[160:163], a[228:231], v[44:47]
    v_and_b32 v21, 0xffff0000, v38
    v_mfma_f32_16x16x32_bf16 v[44:47], v[164:167], a[244:247], v[44:47]
    buffer_load_dwordx4 v[104:107], v5, s[8:11], s40 offen offset:0
    v_mfma_f32_16x16x32_bf16 v[48:51], v[160:163], a[232:235], v[48:51]
    v_lshlrev_b32 v22, 16, v39
    v_mfma_f32_16x16x32_bf16 v[48:51], v[164:167], a[248:251], v[48:51]
    v_and_b32 v23, 0xffff0000, v39
    v_mfma_f32_16x16x32_bf16 v[52:55], v[160:163], a[236:239], v[52:55]
    v_mfma_f32_16x16x32_bf16 v[52:55], v[164:167], a[252:255], v[52:55]
    buffer_load_dwordx4 v[108:111], v5, s[8:11], s40 offen offset:1024
    s_waitcnt vmcnt(20)
    v_mfma_f32_16x16x32_bf16 v[40:43], v[168:171], v[72:75], v[40:43]
    v_mfma_f32_16x16x32_bf16 v[40:43], v[172:175], v[88:91], v[40:43]
    v_mfma_f32_16x16x32_bf16 v[44:47], v[168:171], v[76:79], v[44:47]
    v_mfma_f32_16x16x32_bf16 v[44:47], v[172:175], v[92:95], v[44:47]
    buffer_load_dwordx4 v[112:115], v5, s[8:11], s40 offen offset:2048
    v_mfma_f32_16x16x32_bf16 v[48:51], v[168:171], v[80:83], v[48:51]
    v_mfma_f32_16x16x32_bf16 v[48:51], v[172:175], v[96:99], v[48:51]
    v_mfma_f32_16x16x32_bf16 v[52:55], v[168:171], v[84:87], v[52:55]
    v_mfma_f32_16x16x32_bf16 v[52:55], v[172:175], v[100:103], v[52:55]
    buffer_load_dwordx4 v[116:119], v5, s[8:11], s40 offen offset:3072
    s_waitcnt vmcnt(20)
    v_mfma_f32_16x16x32_bf16 v[56:59], v[176:179], a[0:3], v[20:23]
    v_mfma_f32_16x16x32_bf16 v[56:59], v[180:183], a[16:19], v[56:59]
    v_mfma_f32_16x16x32_bf16 v[60:63], v[176:179], a[4:7], v[20:23]
    v_mfma_f32_16x16x32_bf16 v[60:63], v[180:183], a[20:23], v[60:63]
    buffer_load_dwordx4 v[120:123], v6, s[8:11], s40 offen offset:0
    v_mfma_f32_16x16x32_bf16 v[64:67], v[176:179], a[8:11], v[20:23]
    v_mfma_f32_16x16x32_bf16 v[64:67], v[180:183], a[24:27], v[64:67]
    v_mfma_f32_16x16x32_bf16 v[68:71], v[176:179], a[12:15], v[20:23]
    v_mfma_f32_16x16x32_bf16 v[68:71], v[180:183], a[28:31], v[68:71]
    buffer_load_dwordx4 v[124:127], v6, s[8:11], s40 offen offset:1024
    s_waitcnt vmcnt(20)
    v_mfma_f32_16x16x32_bf16 v[56:59], v[184:187], a[32:35], v[56:59]
    s_lshr_b32 s63, s56, 1
    s_lshl_b32 s63, s63, 12
    s_and_b32 s62, s56, 1
    s_lshl_b32 s62, s62, 3
    s_add_u32 s62, s62, s63
    v_add_u32 v248, s62, v11
    v_mfma_f32_16x16x32_bf16 v[56:59], v[188:191], a[48:51], v[56:59]
    v_mul_f32 v40, v40, abs(v40)
    v_mfma_f32_16x16x32_bf16 v[60:63], v[184:187], a[36:39], v[60:63]
    v_mul_f32 v41, v41, abs(v41)
    v_mfma_f32_16x16x32_bf16 v[60:63], v[188:191], a[52:55], v[60:63]
    buffer_load_dwordx4 v[128:131], v6, s[8:11], s40 offen offset:2048
    v_mfma_f32_16x16x32_bf16 v[64:67], v[184:187], a[40:43], v[64:67]
    v_mul_f32 v42, v42, abs(v42)
    v_mfma_f32_16x16x32_bf16 v[64:67], v[188:191], a[56:59], v[64:67]
    v_mul_f32 v43, v43, abs(v43)
    v_mfma_f32_16x16x32_bf16 v[68:71], v[184:187], a[44:47], v[68:71]
    v_cvt_pk_bf16_f32 v40, v40, v41
    v_mfma_f32_16x16x32_bf16 v[68:71], v[188:191], a[60:63], v[68:71]
    buffer_load_dwordx4 v[132:135], v6, s[8:11], s40 offen offset:3072
    s_waitcnt vmcnt(20)
    v_mfma_f32_16x16x32_bf16 v[56:59], v[192:195], a[64:67], v[56:59]
    v_cvt_pk_bf16_f32 v41, v42, v43
    v_mfma_f32_16x16x32_bf16 v[56:59], v[196:199], a[80:83], v[56:59]
    v_pk_max_i16 v40, v40, 0
    v_mfma_f32_16x16x32_bf16 v[60:63], v[192:195], a[68:71], v[60:63]
    v_pk_max_i16 v41, v41, 0
    v_mfma_f32_16x16x32_bf16 v[60:63], v[196:199], a[84:87], v[60:63]
    buffer_load_dwordx4 v[136:139], v7, s[8:11], s40 offen offset:0
    v_mfma_f32_16x16x32_bf16 v[64:67], v[192:195], a[72:75], v[64:67]
    ds_write_b64 v248, v[40:41] offset:0
    v_mfma_f32_16x16x32_bf16 v[64:67], v[196:199], a[88:91], v[64:67]
    v_mul_f32 v44, v44, abs(v44)
    v_mfma_f32_16x16x32_bf16 v[68:71], v[192:195], a[76:79], v[68:71]
    v_mul_f32 v45, v45, abs(v45)
    v_mfma_f32_16x16x32_bf16 v[68:71], v[196:199], a[92:95], v[68:71]
    buffer_load_dwordx4 v[140:143], v7, s[8:11], s40 offen offset:1024
    s_waitcnt vmcnt(20)
    v_mfma_f32_16x16x32_bf16 v[56:59], v[200:203], a[96:99], v[56:59]
    v_mul_f32 v46, v46, abs(v46)
    v_mfma_f32_16x16x32_bf16 v[56:59], v[204:207], a[112:115], v[56:59]
    v_mul_f32 v47, v47, abs(v47)
    v_mfma_f32_16x16x32_bf16 v[60:63], v[200:203], a[100:103], v[60:63]
    v_cvt_pk_bf16_f32 v44, v44, v45
    v_mfma_f32_16x16x32_bf16 v[60:63], v[204:207], a[116:119], v[60:63]
    buffer_load_dwordx4 v[144:147], v7, s[8:11], s40 offen offset:2048
    v_mfma_f32_16x16x32_bf16 v[64:67], v[200:203], a[104:107], v[64:67]
    v_cvt_pk_bf16_f32 v45, v46, v47
    v_mfma_f32_16x16x32_bf16 v[64:67], v[204:207], a[120:123], v[64:67]
    v_pk_max_i16 v44, v44, 0
    v_mfma_f32_16x16x32_bf16 v[68:71], v[200:203], a[108:111], v[68:71]
    v_pk_max_i16 v45, v45, 0
    v_mfma_f32_16x16x32_bf16 v[68:71], v[204:207], a[124:127], v[68:71]
    buffer_load_dwordx4 v[148:151], v7, s[8:11], s40 offen offset:3072
    s_waitcnt vmcnt(20)
    v_mfma_f32_16x16x32_bf16 v[56:59], v[208:211], a[128:131], v[56:59]
    ds_write_b64 v248, v[44:45] offset:1024
    v_mfma_f32_16x16x32_bf16 v[56:59], v[212:215], a[144:147], v[56:59]
    v_mul_f32 v48, v48, abs(v48)
    v_mfma_f32_16x16x32_bf16 v[60:63], v[208:211], a[132:135], v[60:63]
    v_mul_f32 v49, v49, abs(v49)
    v_mfma_f32_16x16x32_bf16 v[60:63], v[212:215], a[148:151], v[60:63]
    buffer_load_dwordx4 v[152:155], v8, s[8:11], s40 offen offset:0
    v_mfma_f32_16x16x32_bf16 v[64:67], v[208:211], a[136:139], v[64:67]
    v_mul_f32 v50, v50, abs(v50)
    v_mfma_f32_16x16x32_bf16 v[64:67], v[212:215], a[152:155], v[64:67]
    v_mul_f32 v51, v51, abs(v51)
    v_mfma_f32_16x16x32_bf16 v[68:71], v[208:211], a[140:143], v[68:71]
    v_cvt_pk_bf16_f32 v48, v48, v49
    v_mfma_f32_16x16x32_bf16 v[68:71], v[212:215], a[156:159], v[68:71]
    buffer_load_dwordx4 v[156:159], v8, s[8:11], s40 offen offset:1024
    s_waitcnt vmcnt(20)
    v_mfma_f32_16x16x32_bf16 v[56:59], v[216:219], a[160:163], v[56:59]
    v_cvt_pk_bf16_f32 v49, v50, v51
    v_mfma_f32_16x16x32_bf16 v[56:59], v[220:223], a[176:179], v[56:59]
    v_pk_max_i16 v48, v48, 0
    v_mfma_f32_16x16x32_bf16 v[60:63], v[216:219], a[164:167], v[60:63]
    v_pk_max_i16 v49, v49, 0
    v_mfma_f32_16x16x32_bf16 v[60:63], v[220:223], a[180:183], v[60:63]
    buffer_load_dwordx4 v[160:163], v8, s[8:11], s40 offen offset:2048
    v_mfma_f32_16x16x32_bf16 v[64:67], v[216:219], a[168:171], v[64:67]
    ds_write_b64 v248, v[48:49] offset:2048
    v_mfma_f32_16x16x32_bf16 v[64:67], v[220:223], a[184:187], v[64:67]
    v_mul_f32 v52, v52, abs(v52)
    v_mfma_f32_16x16x32_bf16 v[68:71], v[216:219], a[172:175], v[68:71]
    v_mul_f32 v53, v53, abs(v53)
    v_mfma_f32_16x16x32_bf16 v[68:71], v[220:223], a[188:191], v[68:71]
    buffer_load_dwordx4 v[164:167], v8, s[8:11], s40 offen offset:3072
    s_waitcnt vmcnt(20)
    v_mfma_f32_16x16x32_bf16 v[56:59], v[224:227], a[192:195], v[56:59]
    v_mul_f32 v54, v54, abs(v54)
    v_mfma_f32_16x16x32_bf16 v[56:59], v[228:231], a[208:211], v[56:59]
    v_mul_f32 v55, v55, abs(v55)
    v_mfma_f32_16x16x32_bf16 v[60:63], v[224:227], a[196:199], v[60:63]
    v_cvt_pk_bf16_f32 v52, v52, v53
    v_mfma_f32_16x16x32_bf16 v[60:63], v[228:231], a[212:215], v[60:63]
    buffer_load_dwordx4 v[168:171], v9, s[8:11], s40 offen offset:0
    v_mfma_f32_16x16x32_bf16 v[64:67], v[224:227], a[200:203], v[64:67]
    v_cvt_pk_bf16_f32 v53, v54, v55
    v_mfma_f32_16x16x32_bf16 v[64:67], v[228:231], a[216:219], v[64:67]
    v_pk_max_i16 v52, v52, 0
    v_mfma_f32_16x16x32_bf16 v[68:71], v[224:227], a[204:207], v[68:71]
    v_pk_max_i16 v53, v53, 0
    v_mfma_f32_16x16x32_bf16 v[68:71], v[228:231], a[220:223], v[68:71]
    buffer_load_dwordx4 v[172:175], v9, s[8:11], s40 offen offset:1024
    s_waitcnt vmcnt(20)
    v_mfma_f32_16x16x32_bf16 v[56:59], v[232:235], a[224:227], v[56:59]
    ds_write_b64 v248, v[52:53] offset:3072
    v_mfma_f32_16x16x32_bf16 v[56:59], v[236:239], a[240:243], v[56:59]
    v_lshlrev_b32 v16, 16, v14
    v_mfma_f32_16x16x32_bf16 v[60:63], v[232:235], a[228:231], v[60:63]
    v_and_b32 v17, 0xffff0000, v14
    v_mfma_f32_16x16x32_bf16 v[60:63], v[236:239], a[244:247], v[60:63]
    buffer_load_dwordx4 v[176:179], v5, s[8:11], s41 offen offset:0
    v_mfma_f32_16x16x32_bf16 v[64:67], v[232:235], a[232:235], v[64:67]
    v_lshlrev_b32 v18, 16, v15
    v_mfma_f32_16x16x32_bf16 v[64:67], v[236:239], a[248:251], v[64:67]
    v_and_b32 v19, 0xffff0000, v15
    v_mfma_f32_16x16x32_bf16 v[68:71], v[232:235], a[236:239], v[68:71]
    v_mfma_f32_16x16x32_bf16 v[68:71], v[236:239], a[252:255], v[68:71]
    buffer_load_dwordx4 v[180:183], v5, s[8:11], s41 offen offset:1024
    s_waitcnt vmcnt(20)
    v_mfma_f32_16x16x32_bf16 v[56:59], v[240:243], v[72:75], v[56:59]
    v_mfma_f32_16x16x32_bf16 v[56:59], v[244:247], v[88:91], v[56:59]
    v_mfma_f32_16x16x32_bf16 v[60:63], v[240:243], v[76:79], v[60:63]
    v_mfma_f32_16x16x32_bf16 v[60:63], v[244:247], v[92:95], v[60:63]
    buffer_load_dwordx4 v[184:187], v5, s[8:11], s41 offen offset:2048
    v_mfma_f32_16x16x32_bf16 v[64:67], v[240:243], v[80:83], v[64:67]
    v_mfma_f32_16x16x32_bf16 v[64:67], v[244:247], v[96:99], v[64:67]
    v_mfma_f32_16x16x32_bf16 v[68:71], v[240:243], v[84:87], v[68:71]
    v_mfma_f32_16x16x32_bf16 v[68:71], v[244:247], v[100:103], v[68:71]
    buffer_load_dwordx4 v[188:191], v5, s[8:11], s41 offen offset:3072
    s_waitcnt vmcnt(20)
    v_mfma_f32_16x16x32_bf16 v[40:43], v[104:107], a[0:3], v[16:19]
    v_mfma_f32_16x16x32_bf16 v[40:43], v[108:111], a[16:19], v[40:43]
    v_mfma_f32_16x16x32_bf16 v[44:47], v[104:107], a[4:7], v[16:19]
    v_mfma_f32_16x16x32_bf16 v[44:47], v[108:111], a[20:23], v[44:47]
    buffer_load_dwordx4 v[192:195], v6, s[8:11], s41 offen offset:0
    v_mfma_f32_16x16x32_bf16 v[48:51], v[104:107], a[8:11], v[16:19]
    v_mfma_f32_16x16x32_bf16 v[48:51], v[108:111], a[24:27], v[48:51]
    v_mfma_f32_16x16x32_bf16 v[52:55], v[104:107], a[12:15], v[16:19]
    v_mfma_f32_16x16x32_bf16 v[52:55], v[108:111], a[28:31], v[52:55]
    buffer_load_dwordx4 v[196:199], v6, s[8:11], s41 offen offset:1024
    s_waitcnt vmcnt(20)
    v_mfma_f32_16x16x32_bf16 v[40:43], v[112:115], a[32:35], v[40:43]
    s_lshr_b32 s63, s57, 1
    s_lshl_b32 s63, s63, 12
    s_and_b32 s62, s57, 1
    s_lshl_b32 s62, s62, 3
    s_add_u32 s62, s62, s63
    v_add_u32 v248, s62, v11
    v_mfma_f32_16x16x32_bf16 v[40:43], v[116:119], a[48:51], v[40:43]
    v_mul_f32 v56, v56, abs(v56)
    v_mfma_f32_16x16x32_bf16 v[44:47], v[112:115], a[36:39], v[44:47]
    v_mul_f32 v57, v57, abs(v57)
    v_mfma_f32_16x16x32_bf16 v[44:47], v[116:119], a[52:55], v[44:47]
    buffer_load_dwordx4 v[200:203], v6, s[8:11], s41 offen offset:2048
    v_mfma_f32_16x16x32_bf16 v[48:51], v[112:115], a[40:43], v[48:51]
    v_mul_f32 v58, v58, abs(v58)
    v_mfma_f32_16x16x32_bf16 v[48:51], v[116:119], a[56:59], v[48:51]
    v_mul_f32 v59, v59, abs(v59)
    v_mfma_f32_16x16x32_bf16 v[52:55], v[112:115], a[44:47], v[52:55]
    v_cvt_pk_bf16_f32 v56, v56, v57
    v_mfma_f32_16x16x32_bf16 v[52:55], v[116:119], a[60:63], v[52:55]
    buffer_load_dwordx4 v[204:207], v6, s[8:11], s41 offen offset:3072
    s_waitcnt vmcnt(20)
    v_mfma_f32_16x16x32_bf16 v[40:43], v[120:123], a[64:67], v[40:43]
    v_cvt_pk_bf16_f32 v57, v58, v59
    v_mfma_f32_16x16x32_bf16 v[40:43], v[124:127], a[80:83], v[40:43]
    v_pk_max_i16 v56, v56, 0
    v_mfma_f32_16x16x32_bf16 v[44:47], v[120:123], a[68:71], v[44:47]
    v_pk_max_i16 v57, v57, 0
    v_mfma_f32_16x16x32_bf16 v[44:47], v[124:127], a[84:87], v[44:47]
    buffer_load_dwordx4 v[208:211], v7, s[8:11], s41 offen offset:0
    v_mfma_f32_16x16x32_bf16 v[48:51], v[120:123], a[72:75], v[48:51]
    ds_write_b64 v248, v[56:57] offset:0
    v_mfma_f32_16x16x32_bf16 v[48:51], v[124:127], a[88:91], v[48:51]
    v_mul_f32 v60, v60, abs(v60)
    v_mfma_f32_16x16x32_bf16 v[52:55], v[120:123], a[76:79], v[52:55]
    v_mul_f32 v61, v61, abs(v61)
    v_mfma_f32_16x16x32_bf16 v[52:55], v[124:127], a[92:95], v[52:55]
    buffer_load_dwordx4 v[212:215], v7, s[8:11], s41 offen offset:1024
    s_waitcnt vmcnt(20)
    v_mfma_f32_16x16x32_bf16 v[40:43], v[128:131], a[96:99], v[40:43]
    v_mul_f32 v62, v62, abs(v62)
    v_mfma_f32_16x16x32_bf16 v[40:43], v[132:135], a[112:115], v[40:43]
    v_mul_f32 v63, v63, abs(v63)
    v_mfma_f32_16x16x32_bf16 v[44:47], v[128:131], a[100:103], v[44:47]
    v_cvt_pk_bf16_f32 v60, v60, v61
    v_mfma_f32_16x16x32_bf16 v[44:47], v[132:135], a[116:119], v[44:47]
    buffer_load_dwordx4 v[216:219], v7, s[8:11], s41 offen offset:2048
    v_mfma_f32_16x16x32_bf16 v[48:51], v[128:131], a[104:107], v[48:51]
    v_cvt_pk_bf16_f32 v61, v62, v63
    v_mfma_f32_16x16x32_bf16 v[48:51], v[132:135], a[120:123], v[48:51]
    v_pk_max_i16 v60, v60, 0
    v_mfma_f32_16x16x32_bf16 v[52:55], v[128:131], a[108:111], v[52:55]
    v_pk_max_i16 v61, v61, 0
    v_mfma_f32_16x16x32_bf16 v[52:55], v[132:135], a[124:127], v[52:55]
    buffer_load_dwordx4 v[220:223], v7, s[8:11], s41 offen offset:3072
    s_waitcnt vmcnt(20)
    v_mfma_f32_16x16x32_bf16 v[40:43], v[136:139], a[128:131], v[40:43]
    ds_write_b64 v248, v[60:61] offset:1024
    v_mfma_f32_16x16x32_bf16 v[40:43], v[140:143], a[144:147], v[40:43]
    v_mul_f32 v64, v64, abs(v64)
    v_mfma_f32_16x16x32_bf16 v[44:47], v[136:139], a[132:135], v[44:47]
    v_mul_f32 v65, v65, abs(v65)
    v_mfma_f32_16x16x32_bf16 v[44:47], v[140:143], a[148:151], v[44:47]
    buffer_load_dwordx4 v[224:227], v8, s[8:11], s41 offen offset:0
    v_mfma_f32_16x16x32_bf16 v[48:51], v[136:139], a[136:139], v[48:51]
    v_mul_f32 v66, v66, abs(v66)
    v_mfma_f32_16x16x32_bf16 v[48:51], v[140:143], a[152:155], v[48:51]
    v_mul_f32 v67, v67, abs(v67)
    v_mfma_f32_16x16x32_bf16 v[52:55], v[136:139], a[140:143], v[52:55]
    v_cvt_pk_bf16_f32 v64, v64, v65
    v_mfma_f32_16x16x32_bf16 v[52:55], v[140:143], a[156:159], v[52:55]
    buffer_load_dwordx4 v[228:231], v8, s[8:11], s41 offen offset:1024
    s_waitcnt vmcnt(20)
    v_mfma_f32_16x16x32_bf16 v[40:43], v[144:147], a[160:163], v[40:43]
    v_cvt_pk_bf16_f32 v65, v66, v67
    v_mfma_f32_16x16x32_bf16 v[40:43], v[148:151], a[176:179], v[40:43]
    v_pk_max_i16 v64, v64, 0
    v_mfma_f32_16x16x32_bf16 v[44:47], v[144:147], a[164:167], v[44:47]
    v_pk_max_i16 v65, v65, 0
    v_mfma_f32_16x16x32_bf16 v[44:47], v[148:151], a[180:183], v[44:47]
    buffer_load_dwordx4 v[232:235], v8, s[8:11], s41 offen offset:2048
    v_mfma_f32_16x16x32_bf16 v[48:51], v[144:147], a[168:171], v[48:51]
    ds_write_b64 v248, v[64:65] offset:2048
    v_mfma_f32_16x16x32_bf16 v[48:51], v[148:151], a[184:187], v[48:51]
    v_mul_f32 v68, v68, abs(v68)
    v_mfma_f32_16x16x32_bf16 v[52:55], v[144:147], a[172:175], v[52:55]
    v_mul_f32 v69, v69, abs(v69)
    v_mfma_f32_16x16x32_bf16 v[52:55], v[148:151], a[188:191], v[52:55]
    buffer_load_dwordx4 v[236:239], v8, s[8:11], s41 offen offset:3072
    s_waitcnt vmcnt(20)
    v_mfma_f32_16x16x32_bf16 v[40:43], v[152:155], a[192:195], v[40:43]
    v_mul_f32 v70, v70, abs(v70)
    v_mfma_f32_16x16x32_bf16 v[40:43], v[156:159], a[208:211], v[40:43]
    v_mul_f32 v71, v71, abs(v71)
    v_mfma_f32_16x16x32_bf16 v[44:47], v[152:155], a[196:199], v[44:47]
    v_cvt_pk_bf16_f32 v68, v68, v69
    v_mfma_f32_16x16x32_bf16 v[44:47], v[156:159], a[212:215], v[44:47]
    buffer_load_dwordx4 v[240:243], v9, s[8:11], s41 offen offset:0
    v_mfma_f32_16x16x32_bf16 v[48:51], v[152:155], a[200:203], v[48:51]
    v_cvt_pk_bf16_f32 v69, v70, v71
    v_mfma_f32_16x16x32_bf16 v[48:51], v[156:159], a[216:219], v[48:51]
    v_pk_max_i16 v68, v68, 0
    v_mfma_f32_16x16x32_bf16 v[52:55], v[152:155], a[204:207], v[52:55]
    v_pk_max_i16 v69, v69, 0
    v_mfma_f32_16x16x32_bf16 v[52:55], v[156:159], a[220:223], v[52:55]
    buffer_load_dwordx4 v[244:247], v9, s[8:11], s41 offen offset:1024
    s_waitcnt vmcnt(20)
    v_mfma_f32_16x16x32_bf16 v[40:43], v[160:163], a[224:227], v[40:43]
    ds_write_b64 v248, v[68:69] offset:3072
    v_mfma_f32_16x16x32_bf16 v[40:43], v[164:167], a[240:243], v[40:43]
    v_mfma_f32_16x16x32_bf16 v[44:47], v[160:163], a[228:231], v[44:47]
    v_mfma_f32_16x16x32_bf16 v[44:47], v[164:167], a[244:247], v[44:47]
    buffer_load_dwordx4 v[104:107], v5, s[8:11], s42 offen offset:0
    v_mfma_f32_16x16x32_bf16 v[48:51], v[160:163], a[232:235], v[48:51]
    v_mfma_f32_16x16x32_bf16 v[48:51], v[164:167], a[248:251], v[48:51]
    v_mfma_f32_16x16x32_bf16 v[52:55], v[160:163], a[236:239], v[52:55]
    v_mfma_f32_16x16x32_bf16 v[52:55], v[164:167], a[252:255], v[52:55]
    buffer_load_dwordx4 v[108:111], v5, s[8:11], s42 offen offset:1024
    s_waitcnt vmcnt(20)
    v_mfma_f32_16x16x32_bf16 v[40:43], v[168:171], v[72:75], v[40:43]
    v_mfma_f32_16x16x32_bf16 v[40:43], v[172:175], v[88:91], v[40:43]
    v_mfma_f32_16x16x32_bf16 v[44:47], v[168:171], v[76:79], v[44:47]
    v_mfma_f32_16x16x32_bf16 v[44:47], v[172:175], v[92:95], v[44:47]
    buffer_load_dwordx4 v[112:115], v5, s[8:11], s42 offen offset:2048
    v_mfma_f32_16x16x32_bf16 v[48:51], v[168:171], v[80:83], v[48:51]
    v_mfma_f32_16x16x32_bf16 v[48:51], v[172:175], v[96:99], v[48:51]
    v_mfma_f32_16x16x32_bf16 v[52:55], v[168:171], v[84:87], v[52:55]
    v_mfma_f32_16x16x32_bf16 v[52:55], v[172:175], v[100:103], v[52:55]
    buffer_load_dwordx4 v[116:119], v5, s[8:11], s42 offen offset:3072
    s_nop 7
    s_lshr_b32 s63, s58, 1
    s_lshl_b32 s63, s63, 12
    s_and_b32 s62, s58, 1
    s_lshl_b32 s62, s62, 3
    s_add_u32 s62, s62, s63
    v_add_u32 v248, s62, v11
    v_mul_f32 v40, v40, abs(v40)
    v_mul_f32 v41, v41, abs(v41)
    v_mul_f32 v42, v42, abs(v42)
    v_mul_f32 v43, v43, abs(v43)
    v_cvt_pk_bf16_f32 v40, v40, v41
    v_cvt_pk_bf16_f32 v41, v42, v43
    v_pk_max_i16 v40, v40, 0
    v_pk_max_i16 v41, v41, 0
    ds_write_b64 v248, v[40:41] offset:0
    v_mul_f32 v44, v44, abs(v44)
    v_mul_f32 v45, v45, abs(v45)
    v_mul_f32 v46, v46, abs(v46)
    v_mul_f32 v47, v47, abs(v47)
    v_cvt_pk_bf16_f32 v44, v44, v45
    v_cvt_pk_bf16_f32 v45, v46, v47
    v_pk_max_i16 v44, v44, 0
    v_pk_max_i16 v45, v45, 0
    ds_write_b64 v248, v[44:45] offset:1024
    v_mul_f32 v48, v48, abs(v48)
    v_mul_f32 v49, v49, abs(v49)
    v_mul_f32 v50, v50, abs(v50)
    v_mul_f32 v51, v51, abs(v51)
    v_cvt_pk_bf16_f32 v48, v48, v49
    v_cvt_pk_bf16_f32 v49, v50, v51
    v_pk_max_i16 v48, v48, 0
    v_pk_max_i16 v49, v49, 0
    ds_write_b64 v248, v[48:49] offset:2048
    v_mul_f32 v52, v52, abs(v52)
    v_mul_f32 v53, v53, abs(v53)
    v_mul_f32 v54, v54, abs(v54)
    v_mul_f32 v55, v55, abs(v55)
    v_cvt_pk_bf16_f32 v52, v52, v53
    v_cvt_pk_bf16_f32 v53, v54, v55
    v_pk_max_i16 v52, v52, 0
    v_pk_max_i16 v53, v53, 0
    ds_write_b64 v248, v[52:53] offset:3072
    s_waitcnt lgkmcnt(0)
    s_barrier
    ds_read_b128 a[0:3], v11 offset:0
    ds_read_b128 a[4:7], v11 offset:1024
    ds_read_b128 a[8:11], v11 offset:2048
    ds_read_b128 a[12:15], v11 offset:3072
    ds_read_b128 a[16:19], v11 offset:4096
    ds_read_b128 a[20:23], v11 offset:5120
    ds_read_b128 a[24:27], v11 offset:6144
    ds_read_b128 a[28:31], v11 offset:7168
    ds_read_b128 a[32:35], v11 offset:8192
    ds_read_b128 a[36:39], v11 offset:9216
    ds_read_b128 a[40:43], v11 offset:10240
    ds_read_b128 a[44:47], v11 offset:11264
    s_waitcnt vmcnt(21) lgkmcnt(8)
    v_mfma_f32_16x16x32_bf16 v[56:59], v[176:179], a[0:3], 0
    v_mfma_f32_16x16x32_bf16 v[60:63], v[176:179], a[4:7], 0
    v_mfma_f32_16x16x32_bf16 v[64:67], v[176:179], a[8:11], 0
    v_mfma_f32_16x16x32_bf16 v[68:71], v[176:179], a[12:15], 0
    buffer_load_dwordx4 v[120:123], v6, s[8:11], s42 offen offset:0
    ds_read_b128 a[48:51], v11 offset:12288
    ds_read_b128 a[52:55], v11 offset:13312
    ds_read_b128 a[56:59], v11 offset:14336
    ds_read_b128 a[60:63], v11 offset:15360
    s_waitcnt vmcnt(21) lgkmcnt(8)
    v_mfma_f32_16x16x32_bf16 v[56:59], v[180:183], a[16:19], v[56:59]
    v_mfma_f32_16x16x32_bf16 v[60:63], v[180:183], a[20:23], v[60:63]
    v_mfma_f32_16x16x32_bf16 v[64:67], v[180:183], a[24:27], v[64:67]
    v_mfma_f32_16x16x32_bf16 v[68:71], v[180:183], a[28:31], v[68:71]
    buffer_load_dwordx4 v[124:127], v6, s[8:11], s42 offen offset:1024
    ds_read_b128 a[64:67], v11 offset:16384
    ds_read_b128 a[68:71], v11 offset:17408
    ds_read_b128 a[72:75], v11 offset:18432
    ds_read_b128 a[76:79], v11 offset:19456
    s_waitcnt vmcnt(21) lgkmcnt(8)
    v_mfma_f32_16x16x32_bf16 v[56:59], v[184:187], a[32:35], v[56:59]
    v_mfma_f32_16x16x32_bf16 v[60:63], v[184:187], a[36:39], v[60:63]
    v_mfma_f32_16x16x32_bf16 v[64:67], v[184:187], a[40:43], v[64:67]
    v_mfma_f32_16x16x32_bf16 v[68:71], v[184:187], a[44:47], v[68:71]
    buffer_load_dwordx4 v[128:131], v6, s[8:11], s42 offen offset:2048
    buffer_load_dwordx2 v[14:15], v12, s[16:19], s82 offen
    s_lshl_b32 s62, s28, 13
    s_add_u32 s62, s62, s78
    v_lshrrev_b32 v2, 3, v3
    v_lshlrev_b32 v2, 8, v2
    v_lshl_add_u32 v2, v4, 6, v2
    v_and_b32 v10, 7, v3
    v_lshl_add_u32 v2, v10, 3, v2
    buffer_load_dwordx2 v[32:33], v2, s[8:11], s62 offen offset:0
    buffer_load_dwordx2 v[34:35], v2, s[8:11], s62 offen offset:512
    buffer_load_dwordx2 v[36:37], v2, s[8:11], s62 offen offset:1024
    buffer_load_dwordx2 v[38:39], v2, s[8:11], s62 offen offset:1536
    ds_read_b128 a[80:83], v11 offset:20480
    ds_read_b128 a[84:87], v11 offset:21504
    ds_read_b128 a[88:91], v11 offset:22528
    ds_read_b128 a[92:95], v11 offset:23552
    s_waitcnt vmcnt(26) lgkmcnt(8)
    v_mfma_f32_16x16x32_bf16 v[56:59], v[188:191], a[48:51], v[56:59]
    v_mfma_f32_16x16x32_bf16 v[60:63], v[188:191], a[52:55], v[60:63]
    v_mfma_f32_16x16x32_bf16 v[64:67], v[188:191], a[56:59], v[64:67]
    v_mfma_f32_16x16x32_bf16 v[68:71], v[188:191], a[60:63], v[68:71]
    buffer_load_dwordx4 v[132:135], v6, s[8:11], s42 offen offset:3072
    ds_read_b128 a[96:99], v11 offset:24576
    ds_read_b128 a[100:103], v11 offset:25600
    ds_read_b128 a[104:107], v11 offset:26624
    ds_read_b128 a[108:111], v11 offset:27648
    s_waitcnt vmcnt(26) lgkmcnt(8)
    v_mfma_f32_16x16x32_bf16 v[56:59], v[192:195], a[64:67], v[56:59]
    v_mfma_f32_16x16x32_bf16 v[60:63], v[192:195], a[68:71], v[60:63]
    v_mfma_f32_16x16x32_bf16 v[64:67], v[192:195], a[72:75], v[64:67]
    v_mfma_f32_16x16x32_bf16 v[68:71], v[192:195], a[76:79], v[68:71]
    buffer_load_dwordx4 v[136:139], v7, s[8:11], s42 offen offset:0
    ds_read_b128 a[112:115], v11 offset:28672
    ds_read_b128 a[116:119], v11 offset:29696
    ds_read_b128 a[120:123], v11 offset:30720
    ds_read_b128 a[124:127], v11 offset:31744
    s_waitcnt vmcnt(26) lgkmcnt(8)
    v_mfma_f32_16x16x32_bf16 v[56:59], v[196:199], a[80:83], v[56:59]
    v_mfma_f32_16x16x32_bf16 v[60:63], v[196:199], a[84:87], v[60:63]
    v_mfma_f32_16x16x32_bf16 v[64:67], v[196:199], a[88:91], v[64:67]
    v_mfma_f32_16x16x32_bf16 v[68:71], v[196:199], a[92:95], v[68:71]
    buffer_load_dwordx4 v[140:143], v7, s[8:11], s42 offen offset:1024
    ds_read_b128 a[128:131], v11 offset:32768
    ds_read_b128 a[132:135], v11 offset:33792
    ds_read_b128 a[136:139], v11 offset:34816
    ds_read_b128 a[140:143], v11 offset:35840
    s_waitcnt vmcnt(26) lgkmcnt(8)
    v_mfma_f32_16x16x32_bf16 v[56:59], v[200:203], a[96:99], v[56:59]
    v_mfma_f32_16x16x32_bf16 v[60:63], v[200:203], a[100:103], v[60:63]
    v_mfma_f32_16x16x32_bf16 v[64:67], v[200:203], a[104:107], v[64:67]
    v_mfma_f32_16x16x32_bf16 v[68:71], v[200:203], a[108:111], v[68:71]
    buffer_load_dwordx4 v[144:147], v7, s[8:11], s42 offen offset:2048
    ds_read_b128 a[144:147], v13 offset:0
    ds_read_b128 a[148:151], v13 offset:1024
    ds_read_b128 a[152:155], v13 offset:2048
    ds_read_b128 a[156:159], v13 offset:3072
    s_waitcnt vmcnt(26) lgkmcnt(8)
    v_mfma_f32_16x16x32_bf16 v[56:59], v[204:207], a[112:115], v[56:59]
    v_mfma_f32_16x16x32_bf16 v[60:63], v[204:207], a[116:119], v[60:63]
    v_mfma_f32_16x16x32_bf16 v[64:67], v[204:207], a[120:123], v[64:67]
    v_mfma_f32_16x16x32_bf16 v[68:71], v[204:207], a[124:127], v[68:71]
    buffer_load_dwordx4 v[148:151], v7, s[8:11], s42 offen offset:3072
    ds_read_b128 a[160:163], v13 offset:4096
    ds_read_b128 a[164:167], v13 offset:5120
    ds_read_b128 a[168:171], v13 offset:6144
    ds_read_b128 a[172:175], v13 offset:7168
    s_waitcnt vmcnt(26) lgkmcnt(8)
    v_mfma_f32_16x16x32_bf16 v[56:59], v[208:211], a[128:131], v[56:59]
    v_mfma_f32_16x16x32_bf16 v[60:63], v[208:211], a[132:135], v[60:63]
    v_mfma_f32_16x16x32_bf16 v[64:67], v[208:211], a[136:139], v[64:67]
    v_mfma_f32_16x16x32_bf16 v[68:71], v[208:211], a[140:143], v[68:71]
    buffer_load_dwordx4 v[152:155], v8, s[8:11], s42 offen offset:0
    ds_read_b128 a[176:179], v13 offset:8192
    ds_read_b128 a[180:183], v13 offset:9216
    ds_read_b128 a[184:187], v13 offset:10240
    ds_read_b128 a[188:191], v13 offset:11264
    s_waitcnt vmcnt(26) lgkmcnt(8)
    v_mfma_f32_16x16x32_bf16 v[56:59], v[212:215], a[144:147], v[56:59]
    v_mfma_f32_16x16x32_bf16 v[60:63], v[212:215], a[148:151], v[60:63]
    v_mfma_f32_16x16x32_bf16 v[64:67], v[212:215], a[152:155], v[64:67]
    v_mfma_f32_16x16x32_bf16 v[68:71], v[212:215], a[156:159], v[68:71]
    buffer_load_dwordx4 v[156:159], v8, s[8:11], s42 offen offset:1024
    ds_read_b128 a[192:195], v13 offset:12288
    ds_read_b128 a[196:199], v13 offset:13312
    ds_read_b128 a[200:203], v13 offset:14336
    ds_read_b128 a[204:207], v13 offset:15360
    s_waitcnt vmcnt(26) lgkmcnt(8)
    v_mfma_f32_16x16x32_bf16 v[56:59], v[216:219], a[160:163], v[56:59]
    v_mfma_f32_16x16x32_bf16 v[60:63], v[216:219], a[164:167], v[60:63]
    v_mfma_f32_16x16x32_bf16 v[64:67], v[216:219], a[168:171], v[64:67]
    v_mfma_f32_16x16x32_bf16 v[68:71], v[216:219], a[172:175], v[68:71]
    buffer_load_dwordx4 v[160:163], v8, s[8:11], s42 offen offset:2048
    ds_read_b128 a[208:211], v13 offset:16384
    ds_read_b128 a[212:215], v13 offset:17408
    ds_read_b128 a[216:219], v13 offset:18432
    ds_read_b128 a[220:223], v13 offset:19456
    s_waitcnt vmcnt(26) lgkmcnt(8)
    v_mfma_f32_16x16x32_bf16 v[56:59], v[220:223], a[176:179], v[56:59]
    v_mfma_f32_16x16x32_bf16 v[60:63], v[220:223], a[180:183], v[60:63]
    v_mfma_f32_16x16x32_bf16 v[64:67], v[220:223], a[184:187], v[64:67]
    v_mfma_f32_16x16x32_bf16 v[68:71], v[220:223], a[188:191], v[68:71]
    buffer_load_dwordx4 v[164:167], v8, s[8:11], s42 offen offset:3072
    ds_read_b128 a[224:227], v13 offset:20480
    ds_read_b128 a[228:231], v13 offset:21504
    ds_read_b128 a[232:235], v13 offset:22528
    ds_read_b128 a[236:239], v13 offset:23552
    s_waitcnt vmcnt(26) lgkmcnt(8)
    v_mfma_f32_16x16x32_bf16 v[56:59], v[224:227], a[192:195], v[56:59]
    v_mfma_f32_16x16x32_bf16 v[60:63], v[224:227], a[196:199], v[60:63]
    v_mfma_f32_16x16x32_bf16 v[64:67], v[224:227], a[200:203], v[64:67]
    v_mfma_f32_16x16x32_bf16 v[68:71], v[224:227], a[204:207], v[68:71]
    buffer_load_dwordx4 v[168:171], v9, s[8:11], s42 offen offset:0
    ds_read_b128 a[240:243], v13 offset:24576
    ds_read_b128 a[244:247], v13 offset:25600
    ds_read_b128 a[248:251], v13 offset:26624
    ds_read_b128 a[252:255], v13 offset:27648
    s_waitcnt vmcnt(26) lgkmcnt(8)
    v_mfma_f32_16x16x32_bf16 v[56:59], v[228:231], a[208:211], v[56:59]
    v_mfma_f32_16x16x32_bf16 v[60:63], v[228:231], a[212:215], v[60:63]
    v_mfma_f32_16x16x32_bf16 v[64:67], v[228:231], a[216:219], v[64:67]
    v_mfma_f32_16x16x32_bf16 v[68:71], v[228:231], a[220:223], v[68:71]
    buffer_load_dwordx4 v[172:175], v9, s[8:11], s42 offen offset:1024
    ds_read_b128 v[72:75], v13 offset:28672
    ds_read_b128 v[76:79], v13 offset:29696
    ds_read_b128 v[80:83], v13 offset:30720
    ds_read_b128 v[84:87], v13 offset:31744
    s_waitcnt vmcnt(26) lgkmcnt(8)
    v_mfma_f32_16x16x32_bf16 v[56:59], v[232:235], a[224:227], v[56:59]
    v_mfma_f32_16x16x32_bf16 v[60:63], v[232:235], a[228:231], v[60:63]
    v_mfma_f32_16x16x32_bf16 v[64:67], v[232:235], a[232:235], v[64:67]
    v_mfma_f32_16x16x32_bf16 v[68:71], v[232:235], a[236:239], v[68:71]
    buffer_load_dwordx4 v[176:179], v5, s[8:11], s43 offen offset:0
    ds_read_b128 v[88:91], v13 offset:32768
    ds_read_b128 v[92:95], v13 offset:33792
    ds_read_b128 v[96:99], v13 offset:34816
    ds_read_b128 v[100:103], v13 offset:35840
    s_waitcnt vmcnt(26) lgkmcnt(8)
    v_mfma_f32_16x16x32_bf16 v[56:59], v[236:239], a[240:243], v[56:59]
    v_mfma_f32_16x16x32_bf16 v[60:63], v[236:239], a[244:247], v[60:63]
    v_mfma_f32_16x16x32_bf16 v[64:67], v[236:239], a[248:251], v[64:67]
    v_mfma_f32_16x16x32_bf16 v[68:71], v[236:239], a[252:255], v[68:71]
    buffer_load_dwordx4 v[180:183], v5, s[8:11], s43 offen offset:1024
    s_waitcnt vmcnt(26) lgkmcnt(4)
    v_mfma_f32_16x16x32_bf16 v[56:59], v[240:243], v[72:75], v[56:59]
    v_mfma_f32_16x16x32_bf16 v[60:63], v[240:243], v[76:79], v[60:63]
    v_mfma_f32_16x16x32_bf16 v[64:67], v[240:243], v[80:83], v[64:67]
    v_mfma_f32_16x16x32_bf16 v[68:71], v[240:243], v[84:87], v[68:71]
    buffer_load_dwordx4 v[184:187], v5, s[8:11], s43 offen offset:2048
    s_waitcnt vmcnt(26) lgkmcnt(0)
    v_mfma_f32_16x16x32_bf16 v[56:59], v[244:247], v[88:91], v[56:59]
    v_mfma_f32_16x16x32_bf16 v[60:63], v[244:247], v[92:95], v[60:63]
    v_mfma_f32_16x16x32_bf16 v[64:67], v[244:247], v[96:99], v[64:67]
    v_mfma_f32_16x16x32_bf16 v[68:71], v[244:247], v[100:103], v[68:71]
    buffer_load_dwordx4 v[188:191], v5, s[8:11], s43 offen offset:3072
    s_waitcnt vmcnt(25)
    v_mfma_f32_16x16x32_bf16 v[40:43], v[104:107], a[0:3], 0
    v_mfma_f32_16x16x32_bf16 v[40:43], v[108:111], a[16:19], v[40:43]
    v_mfma_f32_16x16x32_bf16 v[44:47], v[104:107], a[4:7], 0
    v_mfma_f32_16x16x32_bf16 v[44:47], v[108:111], a[20:23], v[44:47]
    buffer_load_dwordx4 v[192:195], v6, s[8:11], s43 offen offset:0
    v_mfma_f32_16x16x32_bf16 v[48:51], v[104:107], a[8:11], 0
    v_mfma_f32_16x16x32_bf16 v[48:51], v[108:111], a[24:27], v[48:51]
    v_mfma_f32_16x16x32_bf16 v[52:55], v[104:107], a[12:15], 0
    v_mfma_f32_16x16x32_bf16 v[52:55], v[108:111], a[28:31], v[52:55]
    s_lshl_b32 s62, s64, 16
    s_add_u32 s62, s62, s79
    v_cvt_pk_bf16_f32 v248, v56, v57
    buffer_load_dwordx4 v[196:199], v6, s[8:11], s43 offen offset:1024
    s_waitcnt vmcnt(25)
    v_mfma_f32_16x16x32_bf16 v[40:43], v[112:115], a[32:35], v[40:43]
    v_cvt_pk_bf16_f32 v249, v58, v59
    v_mfma_f32_16x16x32_bf16 v[40:43], v[116:119], a[48:51], v[40:43]
    v_cvt_pk_bf16_f32 v250, v60, v61
    v_mfma_f32_16x16x32_bf16 v[44:47], v[112:115], a[36:39], v[44:47]
    v_cvt_pk_bf16_f32 v251, v62, v63
    v_mfma_f32_16x16x32_bf16 v[44:47], v[116:119], a[52:55], v[44:47]
    buffer_load_dwordx4 v[200:203], v6, s[8:11], s43 offen offset:2048
    v_mfma_f32_16x16x32_bf16 v[48:51], v[112:115], a[40:43], v[48:51]
    buffer_store_dwordx4 v[248:251], v5, s[8:11], s62 offen offset:0 sc1
    v_mfma_f32_16x16x32_bf16 v[48:51], v[116:119], a[56:59], v[48:51]
    v_cvt_pk_bf16_f32 v252, v64, v65
    v_mfma_f32_16x16x32_bf16 v[52:55], v[112:115], a[44:47], v[52:55]
    v_cvt_pk_bf16_f32 v253, v66, v67
    v_mfma_f32_16x16x32_bf16 v[52:55], v[116:119], a[60:63], v[52:55]
    buffer_load_dwordx4 v[204:207], v6, s[8:11], s43 offen offset:3072
    s_waitcnt vmcnt(26)
    v_mfma_f32_16x16x32_bf16 v[40:43], v[120:123], a[64:67], v[40:43]
    v_cvt_pk_bf16_f32 v254, v68, v69
    v_mfma_f32_16x16x32_bf16 v[40:43], v[124:127], a[80:83], v[40:43]
    v_cvt_pk_bf16_f32 v255, v70, v71
    v_mfma_f32_16x16x32_bf16 v[44:47], v[120:123], a[68:71], v[44:47]
    buffer_store_dwordx4 v[252:255], v5, s[8:11], s62 offen offset:1024 sc1
    v_mfma_f32_16x16x32_bf16 v[44:47], v[124:127], a[84:87], v[44:47]
    buffer_load_dwordx4 v[208:211], v7, s[8:11], s43 offen offset:0
    v_mfma_f32_16x16x32_bf16 v[48:51], v[120:123], a[72:75], v[48:51]
    v_mfma_f32_16x16x32_bf16 v[48:51], v[124:127], a[88:91], v[48:51]
    v_mfma_f32_16x16x32_bf16 v[52:55], v[120:123], a[76:79], v[52:55]
    v_mfma_f32_16x16x32_bf16 v[52:55], v[124:127], a[92:95], v[52:55]
    buffer_load_dwordx4 v[212:215], v7, s[8:11], s43 offen offset:1024
    s_waitcnt vmcnt(22)
    v_mfma_f32_16x16x32_bf16 v[40:43], v[128:131], a[96:99], v[40:43]
    v_mfma_f32_16x16x32_bf16 v[40:43], v[132:135], a[112:115], v[40:43]
    v_mfma_f32_16x16x32_bf16 v[44:47], v[128:131], a[100:103], v[44:47]
    v_mfma_f32_16x16x32_bf16 v[44:47], v[132:135], a[116:119], v[44:47]
    buffer_load_dwordx4 v[216:219], v7, s[8:11], s43 offen offset:2048
    v_mfma_f32_16x16x32_bf16 v[48:51], v[128:131], a[104:107], v[48:51]
    v_mfma_f32_16x16x32_bf16 v[48:51], v[132:135], a[120:123], v[48:51]
    v_mfma_f32_16x16x32_bf16 v[52:55], v[128:131], a[108:111], v[52:55]
    v_mfma_f32_16x16x32_bf16 v[52:55], v[132:135], a[124:127], v[52:55]
    buffer_load_dwordx4 v[220:223], v7, s[8:11], s43 offen offset:3072
    s_waitcnt vmcnt(22)
    v_mfma_f32_16x16x32_bf16 v[40:43], v[136:139], a[128:131], v[40:43]
    v_mfma_f32_16x16x32_bf16 v[40:43], v[140:143], a[144:147], v[40:43]
    v_mfma_f32_16x16x32_bf16 v[44:47], v[136:139], a[132:135], v[44:47]
    v_mfma_f32_16x16x32_bf16 v[44:47], v[140:143], a[148:151], v[44:47]
    buffer_load_dwordx4 v[224:227], v8, s[8:11], s43 offen offset:0
    v_mfma_f32_16x16x32_bf16 v[48:51], v[136:139], a[136:139], v[48:51]
    v_mfma_f32_16x16x32_bf16 v[48:51], v[140:143], a[152:155], v[48:51]
    v_mfma_f32_16x16x32_bf16 v[52:55], v[136:139], a[140:143], v[52:55]
    v_mfma_f32_16x16x32_bf16 v[52:55], v[140:143], a[156:159], v[52:55]
    buffer_load_dwordx4 v[228:231], v8, s[8:11], s43 offen offset:1024
    s_waitcnt vmcnt(22)
    v_mfma_f32_16x16x32_bf16 v[40:43], v[144:147], a[160:163], v[40:43]
    v_mfma_f32_16x16x32_bf16 v[40:43], v[148:151], a[176:179], v[40:43]
    v_mfma_f32_16x16x32_bf16 v[44:47], v[144:147], a[164:167], v[44:47]
    v_mfma_f32_16x16x32_bf16 v[44:47], v[148:151], a[180:183], v[44:47]
    buffer_load_dwordx4 v[232:235], v8, s[8:11], s43 offen offset:2048
    v_mfma_f32_16x16x32_bf16 v[48:51], v[144:147], a[168:171], v[48:51]
    v_mfma_f32_16x16x32_bf16 v[48:51], v[148:151], a[184:187], v[48:51]
    v_mfma_f32_16x16x32_bf16 v[52:55], v[144:147], a[172:175], v[52:55]
    v_mfma_f32_16x16x32_bf16 v[52:55], v[148:151], a[188:191], v[52:55]
    buffer_load_dwordx4 v[236:239], v8, s[8:11], s43 offen offset:3072
    s_waitcnt vmcnt(22)
    v_mfma_f32_16x16x32_bf16 v[40:43], v[152:155], a[192:195], v[40:43]
    v_mfma_f32_16x16x32_bf16 v[40:43], v[156:159], a[208:211], v[40:43]
    v_mfma_f32_16x16x32_bf16 v[44:47], v[152:155], a[196:199], v[44:47]
    v_mfma_f32_16x16x32_bf16 v[44:47], v[156:159], a[212:215], v[44:47]
    buffer_load_dwordx4 v[240:243], v9, s[8:11], s43 offen offset:0
    v_mfma_f32_16x16x32_bf16 v[48:51], v[152:155], a[200:203], v[48:51]
    v_mfma_f32_16x16x32_bf16 v[48:51], v[156:159], a[216:219], v[48:51]
    v_mfma_f32_16x16x32_bf16 v[52:55], v[152:155], a[204:207], v[52:55]
    v_mfma_f32_16x16x32_bf16 v[52:55], v[156:159], a[220:223], v[52:55]
    buffer_load_dwordx4 v[244:247], v9, s[8:11], s43 offen offset:1024
    s_waitcnt vmcnt(22)
    v_mfma_f32_16x16x32_bf16 v[40:43], v[160:163], a[224:227], v[40:43]
    v_mfma_f32_16x16x32_bf16 v[40:43], v[164:167], a[240:243], v[40:43]
    v_mfma_f32_16x16x32_bf16 v[44:47], v[160:163], a[228:231], v[44:47]
    v_mfma_f32_16x16x32_bf16 v[44:47], v[164:167], a[244:247], v[44:47]
    buffer_load_dwordx4 v[104:107], v5, s[8:11], s44 offen offset:0
    v_mfma_f32_16x16x32_bf16 v[48:51], v[160:163], a[232:235], v[48:51]
    v_mfma_f32_16x16x32_bf16 v[48:51], v[164:167], a[248:251], v[48:51]
    v_mfma_f32_16x16x32_bf16 v[52:55], v[160:163], a[236:239], v[52:55]
    v_mfma_f32_16x16x32_bf16 v[52:55], v[164:167], a[252:255], v[52:55]
    buffer_load_dwordx4 v[108:111], v5, s[8:11], s44 offen offset:1024
    s_waitcnt vmcnt(22)
    v_mfma_f32_16x16x32_bf16 v[40:43], v[168:171], v[72:75], v[40:43]
    v_mfma_f32_16x16x32_bf16 v[40:43], v[172:175], v[88:91], v[40:43]
    v_mfma_f32_16x16x32_bf16 v[44:47], v[168:171], v[76:79], v[44:47]
    v_mfma_f32_16x16x32_bf16 v[44:47], v[172:175], v[92:95], v[44:47]
    buffer_load_dwordx4 v[112:115], v5, s[8:11], s44 offen offset:2048
    v_mfma_f32_16x16x32_bf16 v[48:51], v[168:171], v[80:83], v[48:51]
    v_mfma_f32_16x16x32_bf16 v[48:51], v[172:175], v[96:99], v[48:51]
    v_mfma_f32_16x16x32_bf16 v[52:55], v[168:171], v[84:87], v[52:55]
    v_mfma_f32_16x16x32_bf16 v[52:55], v[172:175], v[100:103], v[52:55]
    buffer_load_dwordx4 v[116:119], v5, s[8:11], s44 offen offset:3072
    s_waitcnt vmcnt(22)
    v_mfma_f32_16x16x32_bf16 v[56:59], v[176:179], a[0:3], 0
    v_mfma_f32_16x16x32_bf16 v[56:59], v[180:183], a[16:19], v[56:59]
    v_mfma_f32_16x16x32_bf16 v[60:63], v[176:179], a[4:7], 0
    v_mfma_f32_16x16x32_bf16 v[60:63], v[180:183], a[20:23], v[60:63]
    buffer_load_dwordx4 v[120:123], v6, s[8:11], s44 offen offset:0
    v_mfma_f32_16x16x32_bf16 v[64:67], v[176:179], a[8:11], 0
    v_mfma_f32_16x16x32_bf16 v[64:67], v[180:183], a[24:27], v[64:67]
    v_mfma_f32_16x16x32_bf16 v[68:71], v[176:179], a[12:15], 0
    v_mfma_f32_16x16x32_bf16 v[68:71], v[180:183], a[28:31], v[68:71]
    s_lshl_b32 s62, s65, 16
    s_add_u32 s62, s62, s79
    v_cvt_pk_bf16_f32 v248, v40, v41
    buffer_load_dwordx4 v[124:127], v6, s[8:11], s44 offen offset:1024
    s_waitcnt vmcnt(22)
    v_mfma_f32_16x16x32_bf16 v[56:59], v[184:187], a[32:35], v[56:59]
    v_cvt_pk_bf16_f32 v249, v42, v43
    v_mfma_f32_16x16x32_bf16 v[56:59], v[188:191], a[48:51], v[56:59]
    v_cvt_pk_bf16_f32 v250, v44, v45
    v_mfma_f32_16x16x32_bf16 v[60:63], v[184:187], a[36:39], v[60:63]
    v_cvt_pk_bf16_f32 v251, v46, v47
    v_mfma_f32_16x16x32_bf16 v[60:63], v[188:191], a[52:55], v[60:63]
    buffer_load_dwordx4 v[128:131], v6, s[8:11], s44 offen offset:2048
    v_mfma_f32_16x16x32_bf16 v[64:67], v[184:187], a[40:43], v[64:67]
    buffer_store_dwordx4 v[248:251], v5, s[8:11], s62 offen offset:0 sc1
    v_mfma_f32_16x16x32_bf16 v[64:67], v[188:191], a[56:59], v[64:67]
    v_cvt_pk_bf16_f32 v252, v48, v49
    v_mfma_f32_16x16x32_bf16 v[68:71], v[184:187], a[44:47], v[68:71]
    v_cvt_pk_bf16_f32 v253, v50, v51
    v_mfma_f32_16x16x32_bf16 v[68:71], v[188:191], a[60:63], v[68:71]
    buffer_load_dwordx4 v[132:135], v6, s[8:11], s44 offen offset:3072
    s_waitcnt vmcnt(23)
    v_mfma_f32_16x16x32_bf16 v[56:59], v[192:195], a[64:67], v[56:59]
    v_cvt_pk_bf16_f32 v254, v52, v53
    v_mfma_f32_16x16x32_bf16 v[56:59], v[196:199], a[80:83], v[56:59]
    v_cvt_pk_bf16_f32 v255, v54, v55
    v_mfma_f32_16x16x32_bf16 v[60:63], v[192:195], a[68:71], v[60:63]
    buffer_store_dwordx4 v[252:255], v5, s[8:11], s62 offen offset:1024 sc1
    v_mfma_f32_16x16x32_bf16 v[60:63], v[196:199], a[84:87], v[60:63]
    buffer_load_dwordx4 v[136:139], v7, s[8:11], s44 offen offset:0
    v_mfma_f32_16x16x32_bf16 v[64:67], v[192:195], a[72:75], v[64:67]
    s_waitcnt vmcnt(42)
    v_mfma_f32_16x16x32_bf16 v[64:67], v[196:199], a[88:91], v[64:67]
    v_lshlrev_b32 v10, 16, v14
    v_mfma_f32_16x16x32_bf16 v[68:71], v[192:195], a[76:79], v[68:71]
    v_and_b32 v11, 0xffff0000, v14
    v_mfma_f32_16x16x32_bf16 v[68:71], v[196:199], a[92:95], v[68:71]
    buffer_load_dwordx4 v[140:143], v7, s[8:11], s44 offen offset:1024
    s_waitcnt vmcnt(23)
    v_mfma_f32_16x16x32_bf16 v[56:59], v[200:203], a[96:99], v[56:59]
    v_lshlrev_b32 v12, 16, v15
    v_mfma_f32_16x16x32_bf16 v[56:59], v[204:207], a[112:115], v[56:59]
    v_and_b32 v13, 0xffff0000, v15
    v_mfma_f32_16x16x32_bf16 v[60:63], v[200:203], a[100:103], v[60:63]
    v_lshlrev_b32 v16, 16, v32
    v_mfma_f32_16x16x32_bf16 v[60:63], v[204:207], a[116:119], v[60:63]
    buffer_load_dwordx4 v[144:147], v7, s[8:11], s44 offen offset:2048
    v_mfma_f32_16x16x32_bf16 v[64:67], v[200:203], a[104:107], v[64:67]
    v_and_b32 v17, 0xffff0000, v32
    v_mfma_f32_16x16x32_bf16 v[64:67], v[204:207], a[120:123], v[64:67]
    v_lshlrev_b32 v18, 16, v33
    v_mfma_f32_16x16x32_bf16 v[68:71], v[200:203], a[108:111], v[68:71]
    v_and_b32 v19, 0xffff0000, v33
    v_mfma_f32_16x16x32_bf16 v[68:71], v[204:207], a[124:127], v[68:71]
    buffer_load_dwordx4 v[148:151], v7, s[8:11], s44 offen offset:3072
    s_waitcnt vmcnt(22)
    v_mfma_f32_16x16x32_bf16 v[56:59], v[208:211], a[128:131], v[56:59]
    v_lshlrev_b32 v20, 16, v34
    v_mfma_f32_16x16x32_bf16 v[56:59], v[212:215], a[144:147], v[56:59]
    v_and_b32 v21, 0xffff0000, v34
    v_mfma_f32_16x16x32_bf16 v[60:63], v[208:211], a[132:135], v[60:63]
    v_lshlrev_b32 v22, 16, v35
    v_mfma_f32_16x16x32_bf16 v[60:63], v[212:215], a[148:151], v[60:63]
    buffer_load_dwordx4 v[152:155], v8, s[8:11], s44 offen offset:0
    v_mfma_f32_16x16x32_bf16 v[64:67], v[208:211], a[136:139], v[64:67]
    v_and_b32 v23, 0xffff0000, v35
    v_mfma_f32_16x16x32_bf16 v[64:67], v[212:215], a[152:155], v[64:67]
    v_lshlrev_b32 v24, 16, v36
    v_mfma_f32_16x16x32_bf16 v[68:71], v[208:211], a[140:143], v[68:71]
    v_and_b32 v25, 0xffff0000, v36
    v_mfma_f32_16x16x32_bf16 v[68:71], v[212:215], a[156:159], v[68:71]
    buffer_load_dwordx4 v[156:159], v8, s[8:11], s44 offen offset:1024
    s_waitcnt vmcnt(22)
    v_mfma_f32_16x16x32_bf16 v[56:59], v[216:219], a[160:163], v[56:59]
    v_lshlrev_b32 v26, 16, v37
    v_mfma_f32_16x16x32_bf16 v[56:59], v[220:223], a[176:179], v[56:59]
    v_and_b32 v27, 0xffff0000, v37
    v_mfma_f32_16x16x32_bf16 v[60:63], v[216:219], a[164:167], v[60:63]
    v_lshlrev_b32 v28, 16, v38
    v_mfma_f32_16x16x32_bf16 v[60:63], v[220:223], a[180:183], v[60:63]
    buffer_load_dwordx4 v[160:163], v8, s[8:11], s44 offen offset:2048
    v_mfma_f32_16x16x32_bf16 v[64:67], v[216:219], a[168:171], v[64:67]
    v_and_b32 v29, 0xffff0000, v38
    v_mfma_f32_16x16x32_bf16 v[64:67], v[220:223], a[184:187], v[64:67]
    v_lshlrev_b32 v30, 16, v39
    v_mfma_f32_16x16x32_bf16 v[68:71], v[216:219], a[172:175], v[68:71]
    v_and_b32 v31, 0xffff0000, v39
    v_mfma_f32_16x16x32_bf16 v[68:71], v[220:223], a[188:191], v[68:71]
    buffer_load_dwordx4 v[164:167], v8, s[8:11], s44 offen offset:3072
    s_waitcnt vmcnt(22)
    v_mfma_f32_16x16x32_bf16 v[56:59], v[224:227], a[192:195], v[56:59]
    v_mfma_f32_16x16x32_bf16 v[56:59], v[228:231], a[208:211], v[56:59]
    v_mfma_f32_16x16x32_bf16 v[60:63], v[224:227], a[196:199], v[60:63]
    v_mfma_f32_16x16x32_bf16 v[60:63], v[228:231], a[212:215], v[60:63]
    buffer_load_dwordx4 v[168:171], v9, s[8:11], s44 offen offset:0
    v_mfma_f32_16x16x32_bf16 v[64:67], v[224:227], a[200:203], v[64:67]
    v_mfma_f32_16x16x32_bf16 v[64:67], v[228:231], a[216:219], v[64:67]
    v_mfma_f32_16x16x32_bf16 v[68:71], v[224:227], a[204:207], v[68:71]
    v_mfma_f32_16x16x32_bf16 v[68:71], v[228:231], a[220:223], v[68:71]
    buffer_load_dwordx4 v[172:175], v9, s[8:11], s44 offen offset:1024
    s_waitcnt vmcnt(22)
    v_mfma_f32_16x16x32_bf16 v[56:59], v[232:235], a[224:227], v[56:59]
    v_mfma_f32_16x16x32_bf16 v[56:59], v[236:239], a[240:243], v[56:59]
    v_mfma_f32_16x16x32_bf16 v[60:63], v[232:235], a[228:231], v[60:63]
    v_mfma_f32_16x16x32_bf16 v[60:63], v[236:239], a[244:247], v[60:63]
    buffer_load_dwordx4 v[176:179], v5, s[8:11], s45 offen offset:0
    v_mfma_f32_16x16x32_bf16 v[64:67], v[232:235], a[232:235], v[64:67]
    v_mfma_f32_16x16x32_bf16 v[64:67], v[236:239], a[248:251], v[64:67]
    v_mfma_f32_16x16x32_bf16 v[68:71], v[232:235], a[236:239], v[68:71]
    v_mfma_f32_16x16x32_bf16 v[68:71], v[236:239], a[252:255], v[68:71]
    buffer_load_dwordx4 v[180:183], v5, s[8:11], s45 offen offset:1024
    s_waitcnt vmcnt(22)
    v_mfma_f32_16x16x32_bf16 v[56:59], v[240:243], v[72:75], v[56:59]
    v_mfma_f32_16x16x32_bf16 v[56:59], v[244:247], v[88:91], v[56:59]
    v_mfma_f32_16x16x32_bf16 v[60:63], v[240:243], v[76:79], v[60:63]
    v_mfma_f32_16x16x32_bf16 v[60:63], v[244:247], v[92:95], v[60:63]
    buffer_load_dwordx4 v[184:187], v5, s[8:11], s45 offen offset:2048
    v_mfma_f32_16x16x32_bf16 v[64:67], v[240:243], v[80:83], v[64:67]
    v_mfma_f32_16x16x32_bf16 v[64:67], v[244:247], v[96:99], v[64:67]
    v_mfma_f32_16x16x32_bf16 v[68:71], v[240:243], v[84:87], v[68:71]
    v_mfma_f32_16x16x32_bf16 v[68:71], v[244:247], v[100:103], v[68:71]
    buffer_load_dwordx4 v[188:191], v5, s[8:11], s45 offen offset:3072
    s_waitcnt vmcnt(22)
    v_mfma_f32_16x16x32_bf16 v[40:43], v[104:107], a[0:3], 0
    v_mfma_f32_16x16x32_bf16 v[40:43], v[108:111], a[16:19], v[40:43]
    v_mfma_f32_16x16x32_bf16 v[44:47], v[104:107], a[4:7], 0
    v_mfma_f32_16x16x32_bf16 v[44:47], v[108:111], a[20:23], v[44:47]
    buffer_load_dwordx4 v[192:195], v6, s[8:11], s45 offen offset:0
    v_mfma_f32_16x16x32_bf16 v[48:51], v[104:107], a[8:11], 0
    v_mfma_f32_16x16x32_bf16 v[48:51], v[108:111], a[24:27], v[48:51]
    v_mfma_f32_16x16x32_bf16 v[52:55], v[104:107], a[12:15], 0
    v_mfma_f32_16x16x32_bf16 v[52:55], v[108:111], a[28:31], v[52:55]
    s_lshl_b32 s62, s66, 16
    s_add_u32 s62, s62, s79
    v_cvt_pk_bf16_f32 v248, v56, v57
    buffer_load_dwordx4 v[196:199], v6, s[8:11], s45 offen offset:1024
    s_waitcnt vmcnt(22)
    v_mfma_f32_16x16x32_bf16 v[40:43], v[112:115], a[32:35], v[40:43]
    v_cvt_pk_bf16_f32 v249, v58, v59
    v_mfma_f32_16x16x32_bf16 v[40:43], v[116:119], a[48:51], v[40:43]
    v_cvt_pk_bf16_f32 v250, v60, v61
    v_mfma_f32_16x16x32_bf16 v[44:47], v[112:115], a[36:39], v[44:47]
    v_cvt_pk_bf16_f32 v251, v62, v63
    v_mfma_f32_16x16x32_bf16 v[44:47], v[116:119], a[52:55], v[44:47]
    buffer_load_dwordx4 v[200:203], v6, s[8:11], s45 offen offset:2048
    v_mfma_f32_16x16x32_bf16 v[48:51], v[112:115], a[40:43], v[48:51]
    buffer_store_dwordx4 v[248:251], v5, s[8:11], s62 offen offset:0 sc1
    v_mfma_f32_16x16x32_bf16 v[48:51], v[116:119], a[56:59], v[48:51]
    v_cvt_pk_bf16_f32 v252, v64, v65
    v_mfma_f32_16x16x32_bf16 v[52:55], v[112:115], a[44:47], v[52:55]
    v_cvt_pk_bf16_f32 v253, v66, v67
    v_mfma_f32_16x16x32_bf16 v[52:55], v[116:119], a[60:63], v[52:55]
    buffer_load_dwordx4 v[204:207], v6, s[8:11], s45 offen offset:3072
    s_waitcnt vmcnt(23)
    v_mfma_f32_16x16x32_bf16 v[40:43], v[120:123], a[64:67], v[40:43]
    v_cvt_pk_bf16_f32 v254, v68, v69
    v_mfma_f32_16x16x32_bf16 v[40:43], v[124:127], a[80:83], v[40:43]
    v_cvt_pk_bf16_f32 v255, v70, v71
    v_mfma_f32_16x16x32_bf16 v[44:47], v[120:123], a[68:71], v[44:47]
    buffer_store_dwordx4 v[252:255], v5, s[8:11], s62 offen offset:1024 sc1
    v_mfma_f32_16x16x32_bf16 v[44:47], v[124:127], a[84:87], v[44:47]
    buffer_load_dwordx4 v[208:211], v7, s[8:11], s45 offen offset:0
    v_mfma_f32_16x16x32_bf16 v[48:51], v[120:123], a[72:75], v[48:51]
    v_add_f32 v16, v16, v10
    v_mfma_f32_16x16x32_bf16 v[48:51], v[124:127], a[88:91], v[48:51]
    v_add_f32 v17, v17, v11
    v_mfma_f32_16x16x32_bf16 v[52:55], v[120:123], a[76:79], v[52:55]
    v_add_f32 v18, v18, v12
    v_mfma_f32_16x16x32_bf16 v[52:55], v[124:127], a[92:95], v[52:55]
    buffer_load_dwordx4 v[212:215], v7, s[8:11], s45 offen offset:1024
    s_waitcnt vmcnt(23)
    v_mfma_f32_16x16x32_bf16 v[40:43], v[128:131], a[96:99], v[40:43]
    v_add_f32 v19, v19, v13
    v_mfma_f32_16x16x32_bf16 v[40:43], v[132:135], a[112:115], v[40:43]
    v_add_f32 v20, v20, v10
    v_mfma_f32_16x16x32_bf16 v[44:47], v[128:131], a[100:103], v[44:47]
    v_add_f32 v21, v21, v11
    v_mfma_f32_16x16x32_bf16 v[44:47], v[132:135], a[116:119], v[44:47]
    buffer_load_dwordx4 v[216:219], v7, s[8:11], s45 offen offset:2048
    v_mfma_f32_16x16x32_bf16 v[48:51], v[128:131], a[104:107], v[48:51]
    v_add_f32 v22, v22, v12
    v_mfma_f32_16x16x32_bf16 v[48:51], v[132:135], a[120:123], v[48:51]
    v_add_f32 v23, v23, v13
    v_mfma_f32_16x16x32_bf16 v[52:55], v[128:131], a[108:111], v[52:55]
    v_add_f32 v24, v24, v10
    v_mfma_f32_16x16x32_bf16 v[52:55], v[132:135], a[124:127], v[52:55]
    buffer_load_dwordx4 v[220:223], v7, s[8:11], s45 offen offset:3072
    s_waitcnt vmcnt(22)
    v_mfma_f32_16x16x32_bf16 v[40:43], v[136:139], a[128:131], v[40:43]
    v_add_f32 v25, v25, v11
    v_mfma_f32_16x16x32_bf16 v[40:43], v[140:143], a[144:147], v[40:43]
    v_add_f32 v26, v26, v12
    v_mfma_f32_16x16x32_bf16 v[44:47], v[136:139], a[132:135], v[44:47]
    v_add_f32 v27, v27, v13
    v_mfma_f32_16x16x32_bf16 v[44:47], v[140:143], a[148:151], v[44:47]
    buffer_load_dwordx4 v[224:227], v8, s[8:11], s45 offen offset:0
    v_mfma_f32_16x16x32_bf16 v[48:51], v[136:139], a[136:139], v[48:51]
    v_add_f32 v28, v28, v10
    v_mfma_f32_16x16x32_bf16 v[48:51], v[140:143], a[152:155], v[48:51]
    v_add_f32 v29, v29, v11
    v_mfma_f32_16x16x32_bf16 v[52:55], v[136:139], a[140:143], v[52:55]
    v_add_f32 v30, v30, v12
    v_mfma_f32_16x16x32_bf16 v[52:55], v[140:143], a[156:159], v[52:55]
    buffer_load_dwordx4 v[228:231], v8, s[8:11], s45 offen offset:1024
    s_waitcnt vmcnt(22)
    v_mfma_f32_16x16x32_bf16 v[40:43], v[144:147], a[160:163], v[40:43]
    v_add_f32 v31, v31, v13
    v_mfma_f32_16x16x32_bf16 v[40:43], v[148:151], a[176:179], v[40:43]
    v_mfma_f32_16x16x32_bf16 v[44:47], v[144:147], a[164:167], v[44:47]
    v_mfma_f32_16x16x32_bf16 v[44:47], v[148:151], a[180:183], v[44:47]
    buffer_load_dwordx4 v[232:235], v8, s[8:11], s45 offen offset:2048
    v_mfma_f32_16x16x32_bf16 v[48:51], v[144:147], a[168:171], v[48:51]
    v_mfma_f32_16x16x32_bf16 v[48:51], v[148:151], a[184:187], v[48:51]
    v_mfma_f32_16x16x32_bf16 v[52:55], v[144:147], a[172:175], v[52:55]
    v_mfma_f32_16x16x32_bf16 v[52:55], v[148:151], a[188:191], v[52:55]
    buffer_load_dwordx4 v[236:239], v8, s[8:11], s45 offen offset:3072
    s_waitcnt vmcnt(22)
    v_mfma_f32_16x16x32_bf16 v[40:43], v[152:155], a[192:195], v[40:43]
    v_mfma_f32_16x16x32_bf16 v[40:43], v[156:159], a[208:211], v[40:43]
    v_mfma_f32_16x16x32_bf16 v[44:47], v[152:155], a[196:199], v[44:47]
    v_mfma_f32_16x16x32_bf16 v[44:47], v[156:159], a[212:215], v[44:47]
    buffer_load_dwordx4 v[240:243], v9, s[8:11], s45 offen offset:0
    v_mfma_f32_16x16x32_bf16 v[48:51], v[152:155], a[200:203], v[48:51]
    v_mfma_f32_16x16x32_bf16 v[48:51], v[156:159], a[216:219], v[48:51]
    v_mfma_f32_16x16x32_bf16 v[52:55], v[152:155], a[204:207], v[52:55]
    v_mfma_f32_16x16x32_bf16 v[52:55], v[156:159], a[220:223], v[52:55]
    buffer_load_dwordx4 v[244:247], v9, s[8:11], s45 offen offset:1024
    s_waitcnt vmcnt(22)
    v_mfma_f32_16x16x32_bf16 v[40:43], v[160:163], a[224:227], v[40:43]
    v_mfma_f32_16x16x32_bf16 v[40:43], v[164:167], a[240:243], v[40:43]
    v_mfma_f32_16x16x32_bf16 v[44:47], v[160:163], a[228:231], v[44:47]
    v_mfma_f32_16x16x32_bf16 v[44:47], v[164:167], a[244:247], v[44:47]
    buffer_load_dwordx4 v[104:107], v5, s[8:11], s46 offen offset:0
    v_mfma_f32_16x16x32_bf16 v[48:51], v[160:163], a[232:235], v[48:51]
    v_mfma_f32_16x16x32_bf16 v[48:51], v[164:167], a[248:251], v[48:51]
    v_mfma_f32_16x16x32_bf16 v[52:55], v[160:163], a[236:239], v[52:55]
    v_mfma_f32_16x16x32_bf16 v[52:55], v[164:167], a[252:255], v[52:55]
    buffer_load_dwordx4 v[108:111], v5, s[8:11], s46 offen offset:1024
    s_waitcnt vmcnt(22)
    v_mfma_f32_16x16x32_bf16 v[40:43], v[168:171], v[72:75], v[40:43]
    v_mfma_f32_16x16x32_bf16 v[40:43], v[172:175], v[88:91], v[40:43]
    v_mfma_f32_16x16x32_bf16 v[44:47], v[168:171], v[76:79], v[44:47]
    v_mfma_f32_16x16x32_bf16 v[44:47], v[172:175], v[92:95], v[44:47]
    buffer_load_dwordx4 v[112:115], v5, s[8:11], s46 offen offset:2048
    v_mfma_f32_16x16x32_bf16 v[48:51], v[168:171], v[80:83], v[48:51]
    v_mfma_f32_16x16x32_bf16 v[48:51], v[172:175], v[96:99], v[48:51]
    v_mfma_f32_16x16x32_bf16 v[52:55], v[168:171], v[84:87], v[52:55]
    v_mfma_f32_16x16x32_bf16 v[52:55], v[172:175], v[100:103], v[52:55]
    buffer_load_dwordx4 v[116:119], v5, s[8:11], s46 offen offset:3072
    s_waitcnt vmcnt(22)
    v_mfma_f32_16x16x32_bf16 v[56:59], v[176:179], a[0:3], 0
    v_mfma_f32_16x16x32_bf16 v[56:59], v[180:183], a[16:19], v[56:59]
    v_mfma_f32_16x16x32_bf16 v[60:63], v[176:179], a[4:7], 0
    v_mfma_f32_16x16x32_bf16 v[60:63], v[180:183], a[20:23], v[60:63]
    buffer_load_dwordx4 v[120:123], v6, s[8:11], s46 offen offset:0
    s_mul_i32 s31, s3, 18432
    v_add_u32 v12, s31, v5
    v_mfma_f32_16x16x32_bf16 v[64:67], v[176:179], a[8:11], 0
    v_mfma_f32_16x16x32_bf16 v[64:67], v[180:183], a[24:27], v[64:67]
    v_mfma_f32_16x16x32_bf16 v[68:71], v[176:179], a[12:15], 0
    v_mfma_f32_16x16x32_bf16 v[68:71], v[180:183], a[28:31], v[68:71]
    s_lshl_b32 s62, s67, 16
    s_add_u32 s62, s62, s79
    v_cvt_pk_bf16_f32 v248, v40, v41
    buffer_load_dwordx4 v[124:127], v6, s[8:11], s46 offen offset:1024
    s_waitcnt vmcnt(22)
    v_mfma_f32_16x16x32_bf16 v[56:59], v[184:187], a[32:35], v[56:59]
    v_cvt_pk_bf16_f32 v249, v42, v43
    v_mfma_f32_16x16x32_bf16 v[56:59], v[188:191], a[48:51], v[56:59]
    v_cvt_pk_bf16_f32 v250, v44, v45
    v_mfma_f32_16x16x32_bf16 v[60:63], v[184:187], a[36:39], v[60:63]
    v_cvt_pk_bf16_f32 v251, v46, v47
    v_mfma_f32_16x16x32_bf16 v[60:63], v[188:191], a[52:55], v[60:63]
    buffer_load_dwordx4 v[128:131], v6, s[8:11], s46 offen offset:2048
    v_mfma_f32_16x16x32_bf16 v[64:67], v[184:187], a[40:43], v[64:67]
    buffer_store_dwordx4 v[248:251], v5, s[8:11], s62 offen offset:0 sc1
    v_mfma_f32_16x16x32_bf16 v[64:67], v[188:191], a[56:59], v[64:67]
    v_cvt_pk_bf16_f32 v252, v48, v49
    v_mfma_f32_16x16x32_bf16 v[68:71], v[184:187], a[44:47], v[68:71]
    v_cvt_pk_bf16_f32 v253, v50, v51
    v_mfma_f32_16x16x32_bf16 v[68:71], v[188:191], a[60:63], v[68:71]
    buffer_load_dwordx4 v[132:135], v6, s[8:11], s46 offen offset:3072
    s_waitcnt vmcnt(23)
    v_mfma_f32_16x16x32_bf16 v[56:59], v[192:195], a[64:67], v[56:59]
    v_cvt_pk_bf16_f32 v254, v52, v53
    v_mfma_f32_16x16x32_bf16 v[56:59], v[196:199], a[80:83], v[56:59]
    v_cvt_pk_bf16_f32 v255, v54, v55
    v_mfma_f32_16x16x32_bf16 v[60:63], v[192:195], a[68:71], v[60:63]
    buffer_store_dwordx4 v[252:255], v5, s[8:11], s62 offen offset:1024 sc1
    v_mfma_f32_16x16x32_bf16 v[60:63], v[196:199], a[84:87], v[60:63]
    buffer_load_dwordx4 v[136:139], v7, s[8:11], s46 offen offset:0
    v_mfma_f32_16x16x32_bf16 v[64:67], v[192:195], a[72:75], v[64:67]
    v_mfma_f32_16x16x32_bf16 v[64:67], v[196:199], a[88:91], v[64:67]
    v_mfma_f32_16x16x32_bf16 v[68:71], v[192:195], a[76:79], v[68:71]
    v_mfma_f32_16x16x32_bf16 v[68:71], v[196:199], a[92:95], v[68:71]
    buffer_load_dwordx4 v[140:143], v7, s[8:11], s46 offen offset:1024
    s_waitcnt vmcnt(23)
    v_mfma_f32_16x16x32_bf16 v[56:59], v[200:203], a[96:99], v[56:59]
    v_mfma_f32_16x16x32_bf16 v[56:59], v[204:207], a[112:115], v[56:59]
    v_mfma_f32_16x16x32_bf16 v[60:63], v[200:203], a[100:103], v[60:63]
    v_mfma_f32_16x16x32_bf16 v[60:63], v[204:207], a[116:119], v[60:63]
    buffer_load_dwordx4 v[144:147], v7, s[8:11], s46 offen offset:2048
    v_mfma_f32_16x16x32_bf16 v[64:67], v[200:203], a[104:107], v[64:67]
    v_mfma_f32_16x16x32_bf16 v[64:67], v[204:207], a[120:123], v[64:67]
    v_mfma_f32_16x16x32_bf16 v[68:71], v[200:203], a[108:111], v[68:71]
    v_mfma_f32_16x16x32_bf16 v[68:71], v[204:207], a[124:127], v[68:71]
    buffer_load_dwordx4 v[148:151], v7, s[8:11], s46 offen offset:3072
    s_waitcnt vmcnt(22)
    v_mfma_f32_16x16x32_bf16 v[56:59], v[208:211], a[128:131], v[56:59]
    v_mfma_f32_16x16x32_bf16 v[56:59], v[212:215], a[144:147], v[56:59]
    v_mfma_f32_16x16x32_bf16 v[60:63], v[208:211], a[132:135], v[60:63]
    v_mfma_f32_16x16x32_bf16 v[60:63], v[212:215], a[148:151], v[60:63]
    buffer_load_dwordx4 v[152:155], v8, s[8:11], s46 offen offset:0
    v_mfma_f32_16x16x32_bf16 v[64:67], v[208:211], a[136:139], v[64:67]
    v_mfma_f32_16x16x32_bf16 v[64:67], v[212:215], a[152:155], v[64:67]
    v_mfma_f32_16x16x32_bf16 v[68:71], v[208:211], a[140:143], v[68:71]
    v_mfma_f32_16x16x32_bf16 v[68:71], v[212:215], a[156:159], v[68:71]
    buffer_load_dwordx4 v[156:159], v8, s[8:11], s46 offen offset:1024
    s_waitcnt vmcnt(22)
    v_mfma_f32_16x16x32_bf16 v[56:59], v[216:219], a[160:163], v[56:59]
    v_mfma_f32_16x16x32_bf16 v[56:59], v[220:223], a[176:179], v[56:59]
    v_mfma_f32_16x16x32_bf16 v[60:63], v[216:219], a[164:167], v[60:63]
    v_mfma_f32_16x16x32_bf16 v[60:63], v[220:223], a[180:183], v[60:63]
    buffer_load_dwordx4 v[160:163], v8, s[8:11], s46 offen offset:2048
    v_mfma_f32_16x16x32_bf16 v[64:67], v[216:219], a[168:171], v[64:67]
    v_mfma_f32_16x16x32_bf16 v[64:67], v[220:223], a[184:187], v[64:67]
    v_mfma_f32_16x16x32_bf16 v[68:71], v[216:219], a[172:175], v[68:71]
    v_mfma_f32_16x16x32_bf16 v[68:71], v[220:223], a[188:191], v[68:71]
    buffer_load_dwordx4 v[164:167], v8, s[8:11], s46 offen offset:3072
    s_waitcnt vmcnt(22)
    v_mfma_f32_16x16x32_bf16 v[56:59], v[224:227], a[192:195], v[56:59]
    v_mfma_f32_16x16x32_bf16 v[56:59], v[228:231], a[208:211], v[56:59]
    v_mfma_f32_16x16x32_bf16 v[60:63], v[224:227], a[196:199], v[60:63]
    v_mfma_f32_16x16x32_bf16 v[60:63], v[228:231], a[212:215], v[60:63]
    buffer_load_dwordx4 v[168:171], v9, s[8:11], s46 offen offset:0
    v_mfma_f32_16x16x32_bf16 v[64:67], v[224:227], a[200:203], v[64:67]
    v_mfma_f32_16x16x32_bf16 v[64:67], v[228:231], a[216:219], v[64:67]
    v_mfma_f32_16x16x32_bf16 v[68:71], v[224:227], a[204:207], v[68:71]
    v_mfma_f32_16x16x32_bf16 v[68:71], v[228:231], a[220:223], v[68:71]
    buffer_load_dwordx4 v[172:175], v9, s[8:11], s46 offen offset:1024
    s_waitcnt vmcnt(22)
    v_mfma_f32_16x16x32_bf16 v[56:59], v[232:235], a[224:227], v[56:59]
    v_mfma_f32_16x16x32_bf16 v[56:59], v[236:239], a[240:243], v[56:59]
    v_mfma_f32_16x16x32_bf16 v[60:63], v[232:235], a[228:231], v[60:63]
    v_mfma_f32_16x16x32_bf16 v[60:63], v[236:239], a[244:247], v[60:63]
    buffer_load_dwordx4 v[176:179], v5, s[8:11], s47 offen offset:0
    v_mfma_f32_16x16x32_bf16 v[64:67], v[232:235], a[232:235], v[64:67]
    v_mfma_f32_16x16x32_bf16 v[64:67], v[236:239], a[248:251], v[64:67]
    v_mfma_f32_16x16x32_bf16 v[68:71], v[232:235], a[236:239], v[68:71]
    v_mfma_f32_16x16x32_bf16 v[68:71], v[236:239], a[252:255], v[68:71]
    buffer_load_dwordx4 v[180:183], v5, s[8:11], s47 offen offset:1024
    s_waitcnt vmcnt(22)
    v_mfma_f32_16x16x32_bf16 v[56:59], v[240:243], v[72:75], v[56:59]
    v_mfma_f32_16x16x32_bf16 v[56:59], v[244:247], v[88:91], v[56:59]
    v_mfma_f32_16x16x32_bf16 v[60:63], v[240:243], v[76:79], v[60:63]
    v_mfma_f32_16x16x32_bf16 v[60:63], v[244:247], v[92:95], v[60:63]
    buffer_load_dwordx4 v[184:187], v5, s[8:11], s47 offen offset:2048
    s_cmp_eq_u32 s80, 0
    s_cbranch_scc1 K3_nosh0
    s_add_u32 s63, s85, 0
    s_add_u32 s30, s31, 10240
    s_mov_b32 m0, s30
    s_nop 0
    buffer_load_dwordx4 v5, s[8:11], s63 offen sc1 lds
    s_add_u32 s63, s85, 2048
    s_add_u32 s30, s31, 11264
    s_mov_b32 m0, s30
    s_nop 0
    buffer_load_dwordx4 v5, s[8:11], s63 offen sc1 lds
    s_add_u32 s63, s85, 4096
    s_add_u32 s30, s31, 12288
    s_mov_b32 m0, s30
    s_nop 0
    buffer_load_dwordx4 v5, s[8:11], s63 offen sc1 lds
    s_add_u32 s63, s85, 6144
    s_add_u32 s30, s31, 13312
    s_mov_b32 m0, s30
    s_nop 0
    buffer_load_dwordx4 v5, s[8:11], s63 offen sc1 lds
    s_add_u32 s63, s85, 8192
    s_add_u32 s30, s31, 14336
    s_mov_b32 m0, s30
    s_nop 0
    buffer_load_dwordx4 v5, s[8:11], s63 offen sc1 lds
    s_add_u32 s63, s85, 10240
    s_add_u32 s30, s31, 15360
    s_mov_b32 m0, s30
    s_nop 0
    buffer_load_dwordx4 v5, s[8:11], s63 offen sc1 lds
    s_add_u32 s63, s85, 12288
    s_add_u32 s30, s31, 16384
    s_mov_b32 m0, s30
    s_nop 0
    buffer_load_dwordx4 v5, s[8:11], s63 offen sc1 lds
    s_add_u32 s63, s85, 14336
    s_add_u32 s30, s31, 17408
    s_mov_b32 m0, s30
    s_nop 0
    buffer_load_dwordx4 v5, s[8:11], s63 offen sc1 lds
K3_nosh0:
    s_lshl_b32 s63, s71, 11
    s_add_u32 s63, s63, s84
    s_add_u32 s30, s31, 0
    s_mov_b32 m0, s30
    s_nop 0
    buffer_load_dwordx4 v5, s[8:11], s63 offen offset:0 sc1 lds
    buffer_load_dwordx4 v5, s[8:11], s63 offen offset:1024 sc1 lds
    v_mfma_f32_16x16x32_bf16 v[64:67], v[240:243], v[80:83], v[64:67]
    v_mfma_f32_16x16x32_bf16 v[64:67], v[244:247], v[96:99], v[64:67]
    v_mfma_f32_16x16x32_bf16 v[68:71], v[240:243], v[84:87], v[68:71]
    v_mfma_f32_16x16x32_bf16 v[68:71], v[244:247], v[100:103], v[68:71]
    buffer_load_dwordx4 v[188:191], v5, s[8:11], s47 offen offset:3072
    s_waitcnt vmcnt(24)
    v_mfma_f32_16x16x32_bf16 v[40:43], v[104:107], a[0:3], 0
    v_mfma_f32_16x16x32_bf16 v[40:43], v[108:111], a[16:19], v[40:43]
    v_mfma_f32_16x16x32_bf16 v[44:47], v[104:107], a[4:7], 0
    v_mfma_f32_16x16x32_bf16 v[44:47], v[108:111], a[20:23], v[44:47]
    buffer_load_dwordx4 v[192:195], v6, s[8:11], s47 offen offset:0
    v_mfma_f32_16x16x32_bf16 v[48:51], v[104:107], a[8:11], 0
    v_mfma_f32_16x16x32_bf16 v[48:51], v[108:111], a[24:27], v[48:51]
    v_mfma_f32_16x16x32_bf16 v[52:55], v[104:107], a[12:15], 0
    v_mfma_f32_16x16x32_bf16 v[52:55], v[108:111], a[28:31], v[52:55]
    s_lshl_b32 s62, s68, 16
    s_add_u32 s62, s62, s79
    v_cvt_pk_bf16_f32 v248, v56, v57
    buffer_load_dwordx4 v[196:199], v6, s[8:11], s47 offen offset:1024
    s_waitcnt vmcnt(24)
    v_mfma_f32_16x16x32_bf16 v[40:43], v[112:115], a[32:35], v[40:43]
    v_cvt_pk_bf16_f32 v249, v58, v59
    v_mfma_f32_16x16x32_bf16 v[40:43], v[116:119], a[48:51], v[40:43]
    v_cvt_pk_bf16_f32 v250, v60, v61
    v_mfma_f32_16x16x32_bf16 v[44:47], v[112:115], a[36:39], v[44:47]
    v_cvt_pk_bf16_f32 v251, v62, v63
    v_mfma_f32_16x16x32_bf16 v[44:47], v[116:119], a[52:55], v[44:47]
    buffer_load_dwordx4 v[200:203], v6, s[8:11], s47 offen offset:2048
    v_mfma_f32_16x16x32_bf16 v[48:51], v[112:115], a[40:43], v[48:51]
    buffer_store_dwordx4 v[248:251], v5, s[8:11], s62 offen offset:0 sc1
    v_mfma_f32_16x16x32_bf16 v[48:51], v[116:119], a[56:59], v[48:51]
    v_cvt_pk_bf16_f32 v252, v64, v65
    v_mfma_f32_16x16x32_bf16 v[52:55], v[112:115], a[44:47], v[52:55]
    v_cvt_pk_bf16_f32 v253, v66, v67
    v_mfma_f32_16x16x32_bf16 v[52:55], v[116:119], a[60:63], v[52:55]
    buffer_load_dwordx4 v[204:207], v6, s[8:11], s47 offen offset:3072
    s_waitcnt vmcnt(25)
    v_mfma_f32_16x16x32_bf16 v[40:43], v[120:123], a[64:67], v[40:43]
    v_cvt_pk_bf16_f32 v254, v68, v69
    v_mfma_f32_16x16x32_bf16 v[40:43], v[124:127], a[80:83], v[40:43]
    v_cvt_pk_bf16_f32 v255, v70, v71
    v_mfma_f32_16x16x32_bf16 v[44:47], v[120:123], a[68:71], v[44:47]
    buffer_store_dwordx4 v[252:255], v5, s[8:11], s62 offen offset:1024 sc1
    v_mfma_f32_16x16x32_bf16 v[44:47], v[124:127], a[84:87], v[44:47]
    buffer_load_dwordx4 v[208:211], v7, s[8:11], s47 offen offset:0
    v_mfma_f32_16x16x32_bf16 v[48:51], v[120:123], a[72:75], v[48:51]
    v_mfma_f32_16x16x32_bf16 v[48:51], v[124:127], a[88:91], v[48:51]
    v_mfma_f32_16x16x32_bf16 v[52:55], v[120:123], a[76:79], v[52:55]
    v_mfma_f32_16x16x32_bf16 v[52:55], v[124:127], a[92:95], v[52:55]
    buffer_load_dwordx4 v[212:215], v7, s[8:11], s47 offen offset:1024
    s_waitcnt vmcnt(25)
    v_mfma_f32_16x16x32_bf16 v[40:43], v[128:131], a[96:99], v[40:43]
    v_mfma_f32_16x16x32_bf16 v[40:43], v[132:135], a[112:115], v[40:43]
    v_mfma_f32_16x16x32_bf16 v[44:47], v[128:131], a[100:103], v[44:47]
    v_mfma_f32_16x16x32_bf16 v[44:47], v[132:135], a[116:119], v[44:47]
    buffer_load_dwordx4 v[216:219], v7, s[8:11], s47 offen offset:2048
    v_mfma_f32_16x16x32_bf16 v[48:51], v[128:131], a[104:107], v[48:51]
    v_mfma_f32_16x16x32_bf16 v[48:51], v[132:135], a[120:123], v[48:51]
    v_mfma_f32_16x16x32_bf16 v[52:55], v[128:131], a[108:111], v[52:55]
    v_mfma_f32_16x16x32_bf16 v[52:55], v[132:135], a[124:127], v[52:55]
    buffer_load_dwordx4 v[220:223], v7, s[8:11], s47 offen offset:3072
    s_waitcnt vmcnt(24)
    v_mfma_f32_16x16x32_bf16 v[40:43], v[136:139], a[128:131], v[40:43]
    v_mfma_f32_16x16x32_bf16 v[40:43], v[140:143], a[144:147], v[40:43]
    v_mfma_f32_16x16x32_bf16 v[44:47], v[136:139], a[132:135], v[44:47]
    v_mfma_f32_16x16x32_bf16 v[44:47], v[140:143], a[148:151], v[44:47]
    buffer_load_dwordx4 v[224:227], v8, s[8:11], s47 offen offset:0
    v_mfma_f32_16x16x32_bf16 v[48:51], v[136:139], a[136:139], v[48:51]
    v_mfma_f32_16x16x32_bf16 v[48:51], v[140:143], a[152:155], v[48:51]
    v_mfma_f32_16x16x32_bf16 v[52:55], v[136:139], a[140:143], v[52:55]
    v_mfma_f32_16x16x32_bf16 v[52:55], v[140:143], a[156:159], v[52:55]
    buffer_load_dwordx4 v[228:231], v8, s[8:11], s47 offen offset:1024
    s_waitcnt vmcnt(24)
    v_mfma_f32_16x16x32_bf16 v[40:43], v[144:147], a[160:163], v[40:43]
    v_mfma_f32_16x16x32_bf16 v[40:43], v[148:151], a[176:179], v[40:43]
    v_mfma_f32_16x16x32_bf16 v[44:47], v[144:147], a[164:167], v[44:47]
    v_mfma_f32_16x16x32_bf16 v[44:47], v[148:151], a[180:183], v[44:47]
    buffer_load_dwordx4 v[232:235], v8, s[8:11], s47 offen offset:2048
    v_mfma_f32_16x16x32_bf16 v[48:51], v[144:147], a[168:171], v[48:51]
    v_mfma_f32_16x16x32_bf16 v[48:51], v[148:151], a[184:187], v[48:51]
    v_mfma_f32_16x16x32_bf16 v[52:55], v[144:147], a[172:175], v[52:55]
    v_mfma_f32_16x16x32_bf16 v[52:55], v[148:151], a[188:191], v[52:55]
    buffer_load_dwordx4 v[236:239], v8, s[8:11], s47 offen offset:3072
    s_waitcnt vmcnt(24)
    v_mfma_f32_16x16x32_bf16 v[40:43], v[152:155], a[192:195], v[40:43]
    v_mfma_f32_16x16x32_bf16 v[40:43], v[156:159], a[208:211], v[40:43]
    v_mfma_f32_16x16x32_bf16 v[44:47], v[152:155], a[196:199], v[44:47]
    v_mfma_f32_16x16x32_bf16 v[44:47], v[156:159], a[212:215], v[44:47]
    buffer_load_dwordx4 v[240:243], v9, s[8:11], s47 offen offset:0
    v_mfma_f32_16x16x32_bf16 v[48:51], v[152:155], a[200:203], v[48:51]
    v_mfma_f32_16x16x32_bf16 v[48:51], v[156:159], a[216:219], v[48:51]
    v_mfma_f32_16x16x32_bf16 v[52:55], v[152:155], a[204:207], v[52:55]
    v_mfma_f32_16x16x32_bf16 v[52:55], v[156:159], a[220:223], v[52:55]
    buffer_load_dwordx4 v[244:247], v9, s[8:11], s47 offen offset:1024
    s_waitcnt vmcnt(24)
    v_mfma_f32_16x16x32_bf16 v[40:43], v[160:163], a[224:227], v[40:43]
    v_mfma_f32_16x16x32_bf16 v[40:43], v[164:167], a[240:243], v[40:43]
    v_mfma_f32_16x16x32_bf16 v[44:47], v[160:163], a[228:231], v[44:47]
    v_mfma_f32_16x16x32_bf16 v[44:47], v[164:167], a[244:247], v[44:47]
    buffer_load_dwordx4 v[104:107], v5, s[8:11], s48 offen offset:0
    v_mfma_f32_16x16x32_bf16 v[48:51], v[160:163], a[232:235], v[48:51]
    v_mfma_f32_16x16x32_bf16 v[48:51], v[164:167], a[248:251], v[48:51]
    v_mfma_f32_16x16x32_bf16 v[52:55], v[160:163], a[236:239], v[52:55]
    v_mfma_f32_16x16x32_bf16 v[52:55], v[164:167], a[252:255], v[52:55]
    buffer_load_dwordx4 v[108:111], v5, s[8:11], s48 offen offset:1024
    s_waitcnt vmcnt(24)
    v_mfma_f32_16x16x32_bf16 v[40:43], v[168:171], v[72:75], v[40:43]
    v_mfma_f32_16x16x32_bf16 v[40:43], v[172:175], v[88:91], v[40:43]
    v_mfma_f32_16x16x32_bf16 v[44:47], v[168:171], v[76:79], v[44:47]
    v_mfma_f32_16x16x32_bf16 v[44:47], v[172:175], v[92:95], v[44:47]
    buffer_load_dwordx4 v[112:115], v5, s[8:11], s48 offen offset:2048
    s_lshl_b32 s63, s70, 11
    s_add_u32 s63, s63, s84
    s_add_u32 s30, s31, 2048
    s_mov_b32 m0, s30
    s_nop 0
    buffer_load_dwordx4 v5, s[8:11], s63 offen offset:0 sc1 lds
    buffer_load_dwordx4 v5, s[8:11], s63 offen offset:1024 sc1 lds
    v_mfma_f32_16x16x32_bf16 v[48:51], v[168:171], v[80:83], v[48:51]
    v_mfma_f32_16x16x32_bf16 v[48:51], v[172:175], v[96:99], v[48:51]
    v_mfma_f32_16x16x32_bf16 v[52:55], v[168:171], v[84:87], v[52:55]
    v_mfma_f32_16x16x32_bf16 v[52:55], v[172:175], v[100:103], v[52:55]
    buffer_load_dwordx4 v[116:119], v5, s[8:11], s48 offen offset:3072
    s_waitcnt vmcnt(26)
    v_mfma_f32_16x16x32_bf16 v[56:59], v[176:179], a[0:3], 0
    v_mfma_f32_16x16x32_bf16 v[56:59], v[180:183], a[16:19], v[56:59]
    v_mfma_f32_16x16x32_bf16 v[60:63], v[176:179], a[4:7], 0
    v_mfma_f32_16x16x32_bf16 v[60:63], v[180:183], a[20:23], v[60:63]
    buffer_load_dwordx4 v[120:123], v6, s[8:11], s48 offen offset:0
    v_mfma_f32_16x16x32_bf16 v[64:67], v[176:179], a[8:11], 0
    v_mfma_f32_16x16x32_bf16 v[64:67], v[180:183], a[24:27], v[64:67]
    v_mfma_f32_16x16x32_bf16 v[68:71], v[176:179], a[12:15], 0
    v_mfma_f32_16x16x32_bf16 v[68:71], v[180:183], a[28:31], v[68:71]
    s_lshl_b32 s62, s69, 16
    s_add_u32 s62, s62, s79
    v_cvt_pk_bf16_f32 v248, v40, v41
    buffer_load_dwordx4 v[124:127], v6, s[8:11], s48 offen offset:1024
    s_waitcnt vmcnt(24)
    v_mfma_f32_16x16x32_bf16 v[56:59], v[184:187], a[32:35], v[56:59]
    v_cvt_pk_bf16_f32 v249, v42, v43
    v_mfma_f32_16x16x32_bf16 v[56:59], v[188:191], a[48:51], v[56:59]
    v_cvt_pk_bf16_f32 v250, v44, v45
    v_mfma_f32_16x16x32_bf16 v[60:63], v[184:187], a[36:39], v[60:63]
    v_cvt_pk_bf16_f32 v251, v46, v47
    v_mfma_f32_16x16x32_bf16 v[60:63], v[188:191], a[52:55], v[60:63]
    buffer_load_dwordx4 v[128:131], v6, s[8:11], s48 offen offset:2048
    v_mfma_f32_16x16x32_bf16 v[64:67], v[184:187], a[40:43], v[64:67]
    buffer_store_dwordx4 v[248:251], v5, s[8:11], s62 offen offset:0 sc1
    v_mfma_f32_16x16x32_bf16 v[64:67], v[188:191], a[56:59], v[64:67]
    v_cvt_pk_bf16_f32 v252, v48, v49
    v_mfma_f32_16x16x32_bf16 v[68:71], v[184:187], a[44:47], v[68:71]
    v_cvt_pk_bf16_f32 v253, v50, v51
    v_mfma_f32_16x16x32_bf16 v[68:71], v[188:191], a[60:63], v[68:71]
    buffer_load_dwordx4 v[132:135], v6, s[8:11], s48 offen offset:3072
    s_waitcnt vmcnt(25)
    v_mfma_f32_16x16x32_bf16 v[56:59], v[192:195], a[64:67], v[56:59]
    v_cvt_pk_bf16_f32 v254, v52, v53
    v_mfma_f32_16x16x32_bf16 v[56:59], v[196:199], a[80:83], v[56:59]
    v_cvt_pk_bf16_f32 v255, v54, v55
    v_mfma_f32_16x16x32_bf16 v[60:63], v[192:195], a[68:71], v[60:63]
    buffer_store_dwordx4 v[252:255], v5, s[8:11], s62 offen offset:1024 sc1
    v_mfma_f32_16x16x32_bf16 v[60:63], v[196:199], a[84:87], v[60:63]
    buffer_load_dwordx4 v[136:139], v7, s[8:11], s48 offen offset:0
    v_mfma_f32_16x16x32_bf16 v[64:67], v[192:195], a[72:75], v[64:67]
    v_mfma_f32_16x16x32_bf16 v[64:67], v[196:199], a[88:91], v[64:67]
    v_mfma_f32_16x16x32_bf16 v[68:71], v[192:195], a[76:79], v[68:71]
    v_mfma_f32_16x16x32_bf16 v[68:71], v[196:199], a[92:95], v[68:71]
    buffer_load_dwordx4 v[140:143], v7, s[8:11], s48 offen offset:1024
    s_waitcnt vmcnt(25)
    v_mfma_f32_16x16x32_bf16 v[56:59], v[200:203], a[96:99], v[56:59]
    v_mfma_f32_16x16x32_bf16 v[56:59], v[204:207], a[112:115], v[56:59]
    v_mfma_f32_16x16x32_bf16 v[60:63], v[200:203], a[100:103], v[60:63]
    v_mfma_f32_16x16x32_bf16 v[60:63], v[204:207], a[116:119], v[60:63]
    buffer_load_dwordx4 v[144:147], v7, s[8:11], s48 offen offset:2048
    v_mfma_f32_16x16x32_bf16 v[64:67], v[200:203], a[104:107], v[64:67]
    v_mfma_f32_16x16x32_bf16 v[64:67], v[204:207], a[120:123], v[64:67]
    v_mfma_f32_16x16x32_bf16 v[68:71], v[200:203], a[108:111], v[68:71]
    v_mfma_f32_16x16x32_bf16 v[68:71], v[204:207], a[124:127], v[68:71]
    buffer_load_dwordx4 v[148:151], v7, s[8:11], s48 offen offset:3072
    s_waitcnt vmcnt(24)
    v_mfma_f32_16x16x32_bf16 v[56:59], v[208:211], a[128:131], v[56:59]
    v_mfma_f32_16x16x32_bf16 v[56:59], v[212:215], a[144:147], v[56:59]
    v_mfma_f32_16x16x32_bf16 v[60:63], v[208:211], a[132:135], v[60:63]
    v_mfma_f32_16x16x32_bf16 v[60:63], v[212:215], a[148:151], v[60:63]
    buffer_load_dwordx4 v[152:155], v8, s[8:11], s48 offen offset:0
    v_mfma_f32_16x16x32_bf16 v[64:67], v[208:211], a[136:139], v[64:67]
    v_mfma_f32_16x16x32_bf16 v[64:67], v[212:215], a[152:155], v[64:67]
    v_mfma_f32_16x16x32_bf16 v[68:71], v[208:211], a[140:143], v[68:71]
    v_mfma_f32_16x16x32_bf16 v[68:71], v[212:215], a[156:159], v[68:71]
    buffer_load_dwordx4 v[156:159], v8, s[8:11], s48 offen offset:1024
    s_waitcnt vmcnt(24)
    v_mfma_f32_16x16x32_bf16 v[56:59], v[216:219], a[160:163], v[56:59]
    v_mfma_f32_16x16x32_bf16 v[56:59], v[220:223], a[176:179], v[56:59]
    v_mfma_f32_16x16x32_bf16 v[60:63], v[216:219], a[164:167], v[60:63]
    v_mfma_f32_16x16x32_bf16 v[60:63], v[220:223], a[180:183], v[60:63]
    buffer_load_dwordx4 v[160:163], v8, s[8:11], s48 offen offset:2048
    v_mfma_f32_16x16x32_bf16 v[64:67], v[216:219], a[168:171], v[64:67]
    v_mfma_f32_16x16x32_bf16 v[64:67], v[220:223], a[184:187], v[64:67]
    v_mfma_f32_16x16x32_bf16 v[68:71], v[216:219], a[172:175], v[68:71]
    v_mfma_f32_16x16x32_bf16 v[68:71], v[220:223], a[188:191], v[68:71]
    buffer_load_dwordx4 v[164:167], v8, s[8:11], s48 offen offset:3072
    s_waitcnt vmcnt(24)
    v_mfma_f32_16x16x32_bf16 v[56:59], v[224:227], a[192:195], v[56:59]
    v_mfma_f32_16x16x32_bf16 v[56:59], v[228:231], a[208:211], v[56:59]
    v_mfma_f32_16x16x32_bf16 v[60:63], v[224:227], a[196:199], v[60:63]
    v_mfma_f32_16x16x32_bf16 v[60:63], v[228:231], a[212:215], v[60:63]
    buffer_load_dwordx4 v[168:171], v9, s[8:11], s48 offen offset:0
    v_mfma_f32_16x16x32_bf16 v[64:67], v[224:227], a[200:203], v[64:67]
    v_mfma_f32_16x16x32_bf16 v[64:67], v[228:231], a[216:219], v[64:67]
    v_mfma_f32_16x16x32_bf16 v[68:71], v[224:227], a[204:207], v[68:71]
    v_mfma_f32_16x16x32_bf16 v[68:71], v[228:231], a[220:223], v[68:71]
    buffer_load_dwordx4 v[172:175], v9, s[8:11], s48 offen offset:1024
    s_waitcnt vmcnt(24)
    v_mfma_f32_16x16x32_bf16 v[56:59], v[232:235], a[224:227], v[56:59]
    v_mfma_f32_16x16x32_bf16 v[56:59], v[236:239], a[240:243], v[56:59]
    v_mfma_f32_16x16x32_bf16 v[60:63], v[232:235], a[228:231], v[60:63]
    v_mfma_f32_16x16x32_bf16 v[60:63], v[236:239], a[244:247], v[60:63]
    buffer_load_dwordx4 v[176:179], v5, s[8:11], s49 offen offset:0
    v_mfma_f32_16x16x32_bf16 v[64:67], v[232:235], a[232:235], v[64:67]
    v_mfma_f32_16x16x32_bf16 v[64:67], v[236:239], a[248:251], v[64:67]
    v_mfma_f32_16x16x32_bf16 v[68:71], v[232:235], a[236:239], v[68:71]
    v_mfma_f32_16x16x32_bf16 v[68:71], v[236:239], a[252:255], v[68:71]
    buffer_load_dwordx4 v[180:183], v5, s[8:11], s49 offen offset:1024
    s_waitcnt vmcnt(24)
    v_mfma_f32_16x16x32_bf16 v[56:59], v[240:243], v[72:75], v[56:59]
    v_mfma_f32_16x16x32_bf16 v[56:59], v[244:247], v[88:91], v[56:59]
    v_mfma_f32_16x16x32_bf16 v[60:63], v[240:243], v[76:79], v[60:63]
    v_mfma_f32_16x16x32_bf16 v[60:63], v[244:247], v[92:95], v[60:63]
    buffer_load_dwordx4 v[184:187], v5, s[8:11], s49 offen offset:2048
    s_lshl_b32 s63, s69, 11
    s_add_u32 s63, s63, s84
    s_add_u32 s30, s31, 4096
    s_mov_b32 m0, s30
    s_nop 0
    buffer_load_dwordx4 v5, s[8:11], s63 offen offset:0 sc1 lds
    buffer_load_dwordx4 v5, s[8:11], s63 offen offset:1024 sc1 lds
    v_mfma_f32_16x16x32_bf16 v[64:67], v[240:243], v[80:83], v[64:67]
    v_mfma_f32_16x16x32_bf16 v[64:67], v[244:247], v[96:99], v[64:67]
    v_mfma_f32_16x16x32_bf16 v[68:71], v[240:243], v[84:87], v[68:71]
    v_mfma_f32_16x16x32_bf16 v[68:71], v[244:247], v[100:103], v[68:71]
    buffer_load_dwordx4 v[188:191], v5, s[8:11], s49 offen offset:3072
    s_waitcnt vmcnt(26)
    v_mfma_f32_16x16x32_bf16 v[40:43], v[104:107], a[0:3], 0
    v_mfma_f32_16x16x32_bf16 v[40:43], v[108:111], a[16:19], v[40:43]
    v_mfma_f32_16x16x32_bf16 v[44:47], v[104:107], a[4:7], 0
    v_mfma_f32_16x16x32_bf16 v[44:47], v[108:111], a[20:23], v[44:47]
    buffer_load_dwordx4 v[192:195], v6, s[8:11], s49 offen offset:0
    v_mfma_f32_16x16x32_bf16 v[48:51], v[104:107], a[8:11], 0
    v_mfma_f32_16x16x32_bf16 v[48:51], v[108:111], a[24:27], v[48:51]
    v_mfma_f32_16x16x32_bf16 v[52:55], v[104:107], a[12:15], 0
    v_mfma_f32_16x16x32_bf16 v[52:55], v[108:111], a[28:31], v[52:55]
    s_lshl_b32 s62, s70, 16
    s_add_u32 s62, s62, s79
    v_cvt_pk_bf16_f32 v248, v56, v57
    buffer_load_dwordx4 v[196:199], v6, s[8:11], s49 offen offset:1024
    s_waitcnt vmcnt(24)
    v_mfma_f32_16x16x32_bf16 v[40:43], v[112:115], a[32:35], v[40:43]
    v_cvt_pk_bf16_f32 v249, v58, v59
    v_mfma_f32_16x16x32_bf16 v[40:43], v[116:119], a[48:51], v[40:43]
    v_cvt_pk_bf16_f32 v250, v60, v61
    v_mfma_f32_16x16x32_bf16 v[44:47], v[112:115], a[36:39], v[44:47]
    v_cvt_pk_bf16_f32 v251, v62, v63
    v_mfma_f32_16x16x32_bf16 v[44:47], v[116:119], a[52:55], v[44:47]
    buffer_load_dwordx4 v[200:203], v6, s[8:11], s49 offen offset:2048
    v_mfma_f32_16x16x32_bf16 v[48:51], v[112:115], a[40:43], v[48:51]
    buffer_store_dwordx4 v[248:251], v5, s[8:11], s62 offen offset:0 sc1
    v_mfma_f32_16x16x32_bf16 v[48:51], v[116:119], a[56:59], v[48:51]
    v_cvt_pk_bf16_f32 v252, v64, v65
    v_mfma_f32_16x16x32_bf16 v[52:55], v[112:115], a[44:47], v[52:55]
    v_cvt_pk_bf16_f32 v253, v66, v67
    v_mfma_f32_16x16x32_bf16 v[52:55], v[116:119], a[60:63], v[52:55]
    buffer_load_dwordx4 v[204:207], v6, s[8:11], s49 offen offset:3072
    s_waitcnt vmcnt(25)
    v_mfma_f32_16x16x32_bf16 v[40:43], v[120:123], a[64:67], v[40:43]
    v_cvt_pk_bf16_f32 v254, v68, v69
    v_mfma_f32_16x16x32_bf16 v[40:43], v[124:127], a[80:83], v[40:43]
    v_cvt_pk_bf16_f32 v255, v70, v71
    v_mfma_f32_16x16x32_bf16 v[44:47], v[120:123], a[68:71], v[44:47]
    buffer_store_dwordx4 v[252:255], v5, s[8:11], s62 offen offset:1024 sc1
    v_mfma_f32_16x16x32_bf16 v[44:47], v[124:127], a[84:87], v[44:47]
    buffer_load_dwordx4 v[208:211], v7, s[8:11], s49 offen offset:0
    v_mfma_f32_16x16x32_bf16 v[48:51], v[120:123], a[72:75], v[48:51]
    s_waitcnt vmcnt(52)
    ds_read_b128 v[32:35], v12 offset:0
    v_mfma_f32_16x16x32_bf16 v[48:51], v[124:127], a[88:91], v[48:51]
    ds_read_b128 v[36:39], v12 offset:1024
    v_mfma_f32_16x16x32_bf16 v[52:55], v[120:123], a[76:79], v[52:55]
    v_mfma_f32_16x16x32_bf16 v[52:55], v[124:127], a[92:95], v[52:55]
    s_waitcnt lgkmcnt(0)
    v_max3_i32 v14, v32, v33, v34
    buffer_load_dwordx4 v[212:215], v7, s[8:11], s49 offen offset:1024
    s_waitcnt vmcnt(25)
    v_mfma_f32_16x16x32_bf16 v[40:43], v[128:131], a[96:99], v[40:43]
    v_max3_i32 v14, v14, v35, v36
    v_max3_i32 v14, v14, v37, v38
    v_mfma_f32_16x16x32_bf16 v[40:43], v[132:135], a[112:115], v[40:43]
    v_max_i32 v14, v14, v39
    v_cmp_eq_i32 vcc, 2139062143, v14
    v_mfma_f32_16x16x32_bf16 v[44:47], v[128:131], a[100:103], v[44:47]
    v_nop
    v_nop
    v_mfma_f32_16x16x32_bf16 v[44:47], v[132:135], a[116:119], v[44:47]
    s_cmp_eq_u64 vcc, 0
    s_cselect_b32 s86, s75, 0
    s_cselect_b32 s87, s76, 0
    s_cselect_b32 s62, 2, 0
    s_andn2_b32 s74, s74, s62
    v_lshlrev_b32 v10, 16, v32
    v_and_b32 v11, 0xffff0000, v32
    buffer_load_dwordx4 v[216:219], v7, s[8:11], s49 offen offset:2048
    v_mfma_f32_16x16x32_bf16 v[48:51], v[128:131], a[104:107], v[48:51]
    v_fmac_f32 v16, s87, v10
    v_fmac_f32 v17, s87, v11
    v_mfma_f32_16x16x32_bf16 v[48:51], v[132:135], a[120:123], v[48:51]
    v_lshlrev_b32 v10, 16, v33
    v_and_b32 v11, 0xffff0000, v33
    v_mfma_f32_16x16x32_bf16 v[52:55], v[128:131], a[108:111], v[52:55]
    v_fmac_f32 v18, s87, v10
    v_fmac_f32 v19, s87, v11
    v_mfma_f32_16x16x32_bf16 v[52:55], v[132:135], a[124:127], v[52:55]
    v_lshlrev_b32 v10, 16, v34
    v_and_b32 v11, 0xffff0000, v34
    buffer_load_dwordx4 v[220:223], v7, s[8:11], s49 offen offset:3072
    s_waitcnt vmcnt(24)
    v_mfma_f32_16x16x32_bf16 v[40:43], v[136:139], a[128:131], v[40:43]
    v_fmac_f32 v20, s87, v10
    v_fmac_f32 v21, s87, v11
    v_mfma_f32_16x16x32_bf16 v[40:43], v[140:143], a[144:147], v[40:43]
    v_lshlrev_b32 v10, 16, v35
    v_and_b32 v11, 0xffff0000, v35
    v_mfma_f32_16x16x32_bf16 v[44:47], v[136:139], a[132:135], v[44:47]
    v_fmac_f32 v22, s87, v10
    v_fmac_f32 v23, s87, v11
    v_mfma_f32_16x16x32_bf16 v[44:47], v[140:143], a[148:151], v[44:47]
    v_lshlrev_b32 v10, 16, v36
    v_and_b32 v11, 0xffff0000, v36
    buffer_load_dwordx4 v[224:227], v8, s[8:11], s49 offen offset:0
    v_mfma_f32_16x16x32_bf16 v[48:51], v[136:139], a[136:139], v[48:51]
    v_fmac_f32 v24, s87, v10
    v_fmac_f32 v25, s87, v11
    v_mfma_f32_16x16x32_bf16 v[48:51], v[140:143], a[152:155], v[48:51]
    v_lshlrev_b32 v10, 16, v37
    v_and_b32 v11, 0xffff0000, v37
    v_mfma_f32_16x16x32_bf16 v[52:55], v[136:139], a[140:143], v[52:55]
    v_fmac_f32 v26, s87, v10
    v_fmac_f32 v27, s87, v11
    v_mfma_f32_16x16x32_bf16 v[52:55], v[140:143], a[156:159], v[52:55]
    v_lshlrev_b32 v10, 16, v38
    v_and_b32 v11, 0xffff0000, v38
    buffer_load_dwordx4 v[228:231], v8, s[8:11], s49 offen offset:1024
    s_waitcnt vmcnt(24)
    v_mfma_f32_16x16x32_bf16 v[40:43], v[144:147], a[160:163], v[40:43]
    v_fmac_f32 v28, s87, v10
    v_fmac_f32 v29, s87, v11
    v_mfma_f32_16x16x32_bf16 v[40:43], v[148:151], a[176:179], v[40:43]
    v_lshlrev_b32 v10, 16, v39
    v_and_b32 v11, 0xffff0000, v39
    v_mfma_f32_16x16x32_bf16 v[44:47], v[144:147], a[164:167], v[44:47]
    v_fmac_f32 v30, s87, v10
    v_fmac_f32 v31, s87, v11
    v_mfma_f32_16x16x32_bf16 v[44:47], v[148:151], a[180:183], v[44:47]
    buffer_load_dwordx4 v[232:235], v8, s[8:11], s49 offen offset:2048
    v_mfma_f32_16x16x32_bf16 v[48:51], v[144:147], a[168:171], v[48:51]
    v_mfma_f32_16x16x32_bf16 v[48:51], v[148:151], a[184:187], v[48:51]
    v_mfma_f32_16x16x32_bf16 v[52:55], v[144:147], a[172:175], v[52:55]
    v_mfma_f32_16x16x32_bf16 v[52:55], v[148:151], a[188:191], v[52:55]
    buffer_load_dwordx4 v[236:239], v8, s[8:11], s49 offen offset:3072
    s_waitcnt vmcnt(24)
    v_mfma_f32_16x16x32_bf16 v[40:43], v[152:155], a[192:195], v[40:43]
    v_mfma_f32_16x16x32_bf16 v[40:43], v[156:159], a[208:211], v[40:43]
    v_mfma_f32_16x16x32_bf16 v[44:47], v[152:155], a[196:199], v[44:47]
    v_mfma_f32_16x16x32_bf16 v[44:47], v[156:159], a[212:215], v[44:47]
    buffer_load_dwordx4 v[240:243], v9, s[8:11], s49 offen offset:0
    v_mfma_f32_16x16x32_bf16 v[48:51], v[152:155], a[200:203], v[48:51]
    v_mfma_f32_16x16x32_bf16 v[48:51], v[156:159], a[216:219], v[48:51]
    v_mfma_f32_16x16x32_bf16 v[52:55], v[152:155], a[204:207], v[52:55]
    v_mfma_f32_16x16x32_bf16 v[52:55], v[156:159], a[220:223], v[52:55]
    buffer_load_dwordx4 v[244:247], v9, s[8:11], s49 offen offset:1024
    s_waitcnt vmcnt(24)
    v_mfma_f32_16x16x32_bf16 v[40:43], v[160:163], a[224:227], v[40:43]
    v_mfma_f32_16x16x32_bf16 v[40:43], v[164:167], a[240:243], v[40:43]
    v_mfma_f32_16x16x32_bf16 v[44:47], v[160:163], a[228:231], v[44:47]
    v_mfma_f32_16x16x32_bf16 v[44:47], v[164:167], a[244:247], v[44:47]
    v_mfma_f32_16x16x32_bf16 v[48:51], v[160:163], a[232:235], v[48:51]
    v_mfma_f32_16x16x32_bf16 v[48:51], v[164:167], a[248:251], v[48:51]
    v_mfma_f32_16x16x32_bf16 v[52:55], v[160:163], a[236:239], v[52:55]
    v_mfma_f32_16x16x32_bf16 v[52:55], v[164:167], a[252:255], v[52:55]
    v_lshlrev_b32 v3, 3, v4
    s_add_u32 s62, s78, s73
    s_add_u32 s62, s62, 65536
    buffer_load_dwordx2 v[112:113], v2, s[8:11], s62 offen
    buffer_load_dwordx2 v[114:115], v2, s[8:11], s62 offen offset:512
    buffer_load_dwordx2 v[116:117], v3, s[16:19], s83 offen
    s_waitcnt vmcnt(25)
    v_mfma_f32_16x16x32_bf16 v[40:43], v[168:171], v[72:75], v[40:43]
    v_mfma_f32_16x16x32_bf16 v[40:43], v[172:175], v[88:91], v[40:43]
    v_mfma_f32_16x16x32_bf16 v[44:47], v[168:171], v[76:79], v[44:47]
    v_mfma_f32_16x16x32_bf16 v[44:47], v[172:175], v[92:95], v[44:47]
    s_lshl_b32 s63, s68, 11
    s_add_u32 s63, s63, s84
    s_add_u32 s30, s31, 6144
    s_mov_b32 m0, s30
    s_nop 0
    buffer_load_dwordx4 v5, s[8:11], s63 offen offset:0 sc1 lds
    buffer_load_dwordx4 v5, s[8:11], s63 offen offset:1024 sc1 lds
    v_mfma_f32_16x16x32_bf16 v[48:51], v[168:171], v[80:83], v[48:51]
    v_mfma_f32_16x16x32_bf16 v[48:51], v[172:175], v[96:99], v[48:51]
    v_mfma_f32_16x16x32_bf16 v[52:55], v[168:171], v[84:87], v[52:55]
    v_mfma_f32_16x16x32_bf16 v[52:55], v[172:175], v[100:103], v[52:55]
    s_waitcnt vmcnt(25)
    v_mfma_f32_16x16x32_bf16 v[56:59], v[176:179], a[0:3], 0
    v_mfma_f32_16x16x32_bf16 v[56:59], v[180:183], a[16:19], v[56:59]
    v_mfma_f32_16x16x32_bf16 v[60:63], v[176:179], a[4:7], 0
    v_mfma_f32_16x16x32_bf16 v[60:63], v[180:183], a[20:23], v[60:63]
    v_mfma_f32_16x16x32_bf16 v[64:67], v[176:179], a[8:11], 0
    v_mfma_f32_16x16x32_bf16 v[64:67], v[180:183], a[24:27], v[64:67]
    v_mfma_f32_16x16x32_bf16 v[68:71], v[176:179], a[12:15], 0
    v_mfma_f32_16x16x32_bf16 v[68:71], v[180:183], a[28:31], v[68:71]
    s_lshl_b32 s62, s71, 16
    s_add_u32 s62, s62, s79
    v_cvt_pk_bf16_f32 v248, v40, v41
    s_waitcnt vmcnt(21)
    v_mfma_f32_16x16x32_bf16 v[56:59], v[184:187], a[32:35], v[56:59]
    v_cvt_pk_bf16_f32 v249, v42, v43
    v_mfma_f32_16x16x32_bf16 v[56:59], v[188:191], a[48:51], v[56:59]
    v_cvt_pk_bf16_f32 v250, v44, v45
    v_mfma_f32_16x16x32_bf16 v[60:63], v[184:187], a[36:39], v[60:63]
    v_cvt_pk_bf16_f32 v251, v46, v47
    v_mfma_f32_16x16x32_bf16 v[60:63], v[188:191], a[52:55], v[60:63]
    v_mfma_f32_16x16x32_bf16 v[64:67], v[184:187], a[40:43], v[64:67]
    buffer_store_dwordx4 v[248:251], v5, s[8:11], s62 offen offset:0 sc1
    v_mfma_f32_16x16x32_bf16 v[64:67], v[188:191], a[56:59], v[64:67]
    v_cvt_pk_bf16_f32 v252, v48, v49
    v_mfma_f32_16x16x32_bf16 v[68:71], v[184:187], a[44:47], v[68:71]
    v_cvt_pk_bf16_f32 v253, v50, v51
    v_mfma_f32_16x16x32_bf16 v[68:71], v[188:191], a[60:63], v[68:71]
    s_waitcnt vmcnt(20)
    v_mfma_f32_16x16x32_bf16 v[56:59], v[192:195], a[64:67], v[56:59]
    v_cvt_pk_bf16_f32 v254, v52, v53
    v_mfma_f32_16x16x32_bf16 v[56:59], v[196:199], a[80:83], v[56:59]
    v_cvt_pk_bf16_f32 v255, v54, v55
    v_mfma_f32_16x16x32_bf16 v[60:63], v[192:195], a[68:71], v[60:63]
    buffer_store_dwordx4 v[252:255], v5, s[8:11], s62 offen offset:1024 sc1
    v_mfma_f32_16x16x32_bf16 v[60:63], v[196:199], a[84:87], v[60:63]
    v_mfma_f32_16x16x32_bf16 v[64:67], v[192:195], a[72:75], v[64:67]
    s_waitcnt vmcnt(46)
    ds_read_b128 v[32:35], v12 offset:2048
    v_mfma_f32_16x16x32_bf16 v[64:67], v[196:199], a[88:91], v[64:67]
    ds_read_b128 v[36:39], v12 offset:3072
    v_mfma_f32_16x16x32_bf16 v[68:71], v[192:195], a[76:79], v[68:71]
    v_mfma_f32_16x16x32_bf16 v[68:71], v[196:199], a[92:95], v[68:71]
    s_waitcnt lgkmcnt(0)
    v_max3_i32 v14, v32, v33, v34
    s_waitcnt vmcnt(18)
    v_mfma_f32_16x16x32_bf16 v[56:59], v[200:203], a[96:99], v[56:59]
    v_max3_i32 v14, v14, v35, v36
    v_max3_i32 v14, v14, v37, v38
    v_mfma_f32_16x16x32_bf16 v[56:59], v[204:207], a[112:115], v[56:59]
    v_max_i32 v14, v14, v39
    v_cmp_eq_i32 vcc, 2139062143, v14
    v_mfma_f32_16x16x32_bf16 v[60:63], v[200:203], a[100:103], v[60:63]
    v_nop
    v_nop
    v_mfma_f32_16x16x32_bf16 v[60:63], v[204:207], a[116:119], v[60:63]
    s_cmp_eq_u64 vcc, 0
    s_cselect_b32 s86, s75, 0
    s_cselect_b32 s87, s76, 0
    s_cselect_b32 s62, 4, 0
    s_andn2_b32 s74, s74, s62
    v_lshlrev_b32 v10, 16, v32
    v_and_b32 v11, 0xffff0000, v32
    v_mfma_f32_16x16x32_bf16 v[64:67], v[200:203], a[104:107], v[64:67]
    v_fmac_f32 v16, s87, v10
    v_fmac_f32 v17, s87, v11
    v_mfma_f32_16x16x32_bf16 v[64:67], v[204:207], a[120:123], v[64:67]
    v_lshlrev_b32 v10, 16, v33
    v_and_b32 v11, 0xffff0000, v33
    v_mfma_f32_16x16x32_bf16 v[68:71], v[200:203], a[108:111], v[68:71]
    v_fmac_f32 v18, s87, v10
    v_fmac_f32 v19, s87, v11
    v_mfma_f32_16x16x32_bf16 v[68:71], v[204:207], a[124:127], v[68:71]
    v_lshlrev_b32 v10, 16, v34
    v_and_b32 v11, 0xffff0000, v34
    s_waitcnt vmcnt(15)
    v_mfma_f32_16x16x32_bf16 v[56:59], v[208:211], a[128:131], v[56:59]
    v_fmac_f32 v20, s87, v10
    v_fmac_f32 v21, s87, v11
    v_mfma_f32_16x16x32_bf16 v[56:59], v[212:215], a[144:147], v[56:59]
    v_lshlrev_b32 v10, 16, v35
    v_and_b32 v11, 0xffff0000, v35
    v_mfma_f32_16x16x32_bf16 v[60:63], v[208:211], a[132:135], v[60:63]
    v_fmac_f32 v22, s87, v10
    v_fmac_f32 v23, s87, v11
    v_mfma_f32_16x16x32_bf16 v[60:63], v[212:215], a[148:151], v[60:63]
    v_lshlrev_b32 v10, 16, v36
    v_and_b32 v11, 0xffff0000, v36
    v_mfma_f32_16x16x32_bf16 v[64:67], v[208:211], a[136:139], v[64:67]
    v_fmac_f32 v24, s87, v10
    v_fmac_f32 v25, s87, v11
    v_mfma_f32_16x16x32_bf16 v[64:67], v[212:215], a[152:155], v[64:67]
    v_lshlrev_b32 v10, 16, v37
    v_and_b32 v11, 0xffff0000, v37
    v_mfma_f32_16x16x32_bf16 v[68:71], v[208:211], a[140:143], v[68:71]
    v_fmac_f32 v26, s87, v10
    v_fmac_f32 v27, s87, v11
    v_mfma_f32_16x16x32_bf16 v[68:71], v[212:215], a[156:159], v[68:71]
    v_lshlrev_b32 v10, 16, v38
    v_and_b32 v11, 0xffff0000, v38
    s_waitcnt vmcnt(13)
    v_mfma_f32_16x16x32_bf16 v[56:59], v[216:219], a[160:163], v[56:59]
    v_fmac_f32 v28, s87, v10
    v_fmac_f32 v29, s87, v11
    v_mfma_f32_16x16x32_bf16 v[56:59], v[220:223], a[176:179], v[56:59]
    v_lshlrev_b32 v10, 16, v39
    v_and_b32 v11, 0xffff0000, v39
    v_mfma_f32_16x16x32_bf16 v[60:63], v[216:219], a[164:167], v[60:63]
    v_fmac_f32 v30, s87, v10
    v_fmac_f32 v31, s87, v11
    v_mfma_f32_16x16x32_bf16 v[60:63], v[220:223], a[180:183], v[60:63]
    v_mfma_f32_16x16x32_bf16 v[64:67], v[216:219], a[168:171], v[64:67]
    v_mfma_f32_16x16x32_bf16 v[64:67], v[220:223], a[184:187], v[64:67]
    v_mfma_f32_16x16x32_bf16 v[68:71], v[216:219], a[172:175], v[68:71]
    v_mfma_f32_16x16x32_bf16 v[68:71], v[220:223], a[188:191], v[68:71]
    s_waitcnt vmcnt(24)
    ds_read_b128 v[104:107], v12 offset:4096
    s_waitcnt vmcnt(11)
    v_mfma_f32_16x16x32_bf16 v[56:59], v[224:227], a[192:195], v[56:59]
    ds_read_b128 v[108:111], v12 offset:5120
    v_mfma_f32_16x16x32_bf16 v[56:59], v[228:231], a[208:211], v[56:59]
    v_mfma_f32_16x16x32_bf16 v[60:63], v[224:227], a[196:199], v[60:63]
    s_waitcnt lgkmcnt(0)
    v_max3_i32 v14, v104, v105, v106
    v_mfma_f32_16x16x32_bf16 v[60:63], v[228:231], a[212:215], v[60:63]
    v_max3_i32 v14, v14, v107, v108
    v_max3_i32 v14, v14, v109, v110
    v_mfma_f32_16x16x32_bf16 v[64:67], v[224:227], a[200:203], v[64:67]
    v_max_i32 v14, v14, v111
    v_cmp_eq_i32 vcc, 2139062143, v14
    v_mfma_f32_16x16x32_bf16 v[64:67], v[228:231], a[216:219], v[64:67]
    v_nop
    v_nop
    v_mfma_f32_16x16x32_bf16 v[68:71], v[224:227], a[204:207], v[68:71]
    s_cmp_eq_u64 vcc, 0
    s_cselect_b32 s86, s75, 0
    s_cselect_b32 s87, s76, 0
    s_cselect_b32 s62, 8, 0
    s_andn2_b32 s74, s74, s62
    v_lshlrev_b32 v10, 16, v104
    v_and_b32 v11, 0xffff0000, v104
    v_mfma_f32_16x16x32_bf16 v[68:71], v[228:231], a[220:223], v[68:71]
    v_fmac_f32 v16, s87, v10
    v_fmac_f32 v17, s87, v11
    s_waitcnt vmcnt(9)
    v_mfma_f32_16x16x32_bf16 v[56:59], v[232:235], a[224:227], v[56:59]
    v_lshlrev_b32 v10, 16, v105
    v_and_b32 v11, 0xffff0000, v105
    v_mfma_f32_16x16x32_bf16 v[56:59], v[236:239], a[240:243], v[56:59]
    v_fmac_f32 v18, s87, v10
    v_fmac_f32 v19, s87, v11
    v_mfma_f32_16x16x32_bf16 v[60:63], v[232:235], a[228:231], v[60:63]
    v_lshlrev_b32 v10, 16, v106
    v_and_b32 v11, 0xffff0000, v106
    v_mfma_f32_16x16x32_bf16 v[60:63], v[236:239], a[244:247], v[60:63]
    v_fmac_f32 v20, s87, v10
    v_fmac_f32 v21, s87, v11
    v_mfma_f32_16x16x32_bf16 v[64:67], v[232:235], a[232:235], v[64:67]
    v_lshlrev_b32 v10, 16, v107
    v_and_b32 v11, 0xffff0000, v107
    v_mfma_f32_16x16x32_bf16 v[64:67], v[236:239], a[248:251], v[64:67]
    v_fmac_f32 v22, s87, v10
    v_fmac_f32 v23, s87, v11
    v_mfma_f32_16x16x32_bf16 v[68:71], v[232:235], a[236:239], v[68:71]
    v_lshlrev_b32 v10, 16, v108
    v_and_b32 v11, 0xffff0000, v108
    v_mfma_f32_16x16x32_bf16 v[68:71], v[236:239], a[252:255], v[68:71]
    v_fmac_f32 v24, s87, v10
    v_fmac_f32 v25, s87, v11
    s_waitcnt vmcnt(7)
    v_mfma_f32_16x16x32_bf16 v[56:59], v[240:243], v[72:75], v[56:59]
    v_lshlrev_b32 v10, 16, v109
    v_and_b32 v11, 0xffff0000, v109
    v_mfma_f32_16x16x32_bf16 v[56:59], v[244:247], v[88:91], v[56:59]
    v_fmac_f32 v26, s87, v10
    v_fmac_f32 v27, s87, v11
    v_mfma_f32_16x16x32_bf16 v[60:63], v[240:243], v[76:79], v[60:63]
    v_lshlrev_b32 v10, 16, v110
    v_and_b32 v11, 0xffff0000, v110
    v_mfma_f32_16x16x32_bf16 v[60:63], v[244:247], v[92:95], v[60:63]
    v_fmac_f32 v28, s87, v10
    v_fmac_f32 v29, s87, v11
    s_lshl_b32 s63, s67, 11
    s_add_u32 s63, s63, s84
    s_add_u32 s30, s31, 8192
    s_mov_b32 m0, s30
    s_nop 0
    buffer_load_dwordx4 v5, s[8:11], s63 offen offset:0 sc1 lds
    buffer_load_dwordx4 v5, s[8:11], s63 offen offset:1024 sc1 lds
    v_mfma_f32_16x16x32_bf16 v[64:67], v[240:243], v[80:83], v[64:67]
    v_lshlrev_b32 v10, 16, v111
    v_and_b32 v11, 0xffff0000, v111
    v_mfma_f32_16x16x32_bf16 v[64:67], v[244:247], v[96:99], v[64:67]
    v_fmac_f32 v30, s87, v10
    v_fmac_f32 v31, s87, v11
    v_mfma_f32_16x16x32_bf16 v[68:71], v[240:243], v[84:87], v[68:71]
    v_mfma_f32_16x16x32_bf16 v[68:71], v[244:247], v[100:103], v[68:71]
    s_lshl_b32 s63, s66, 11
    s_add_u32 s63, s63, s84
    buffer_load_dwordx4 v[152:155], v5, s[8:11], s63 offen offset:0 sc1
    buffer_load_dwordx4 v[156:159], v5, s[8:11], s63 offen offset:1024 sc1
    s_lshl_b32 s63, s65, 11
    s_add_u32 s63, s63, s84
    buffer_load_dwordx4 v[160:163], v5, s[8:11], s63 offen offset:0 sc1
    buffer_load_dwordx4 v[164:167], v5, s[8:11], s63 offen offset:1024 sc1
    v_and_b32 v3, 15, v0
    v_lshlrev_b32 v11, 5, v3
    v_lshl_add_u32 v11, v4, 3, v11
    v_add_u32 v11, s31, v11
    v_bfe_u32 v10, v0, 1, 5
    v_mul_u32_u24 v10, 1152, v10
    v_and_b32 v13, 1, v0
    v_lshl_add_u32 v10, v13, 4, v10
    v_mul_u32_u24 v6, 144, v3
    v_lshl_add_u32 v6, v4, 3, v6
    s_lshl_b32 s62, s3, 5
    s_add_u32 s62, s62, 73728
    v_add_u32 v6, s62, v6
    v_bfe_u32 v8, v0, 3, 3
    v_and_b32 v9, 7, v0
    v_mul_u32_u24 v7, 144, v8
    v_lshl_add_u32 v7, v9, 4, v7
    s_mul_i32 s62, s3, 2304
    s_add_u32 s62, s62, 73728
    v_add_u32 v7, s62, v7
    v_mul_u32_u24 v8, 1152, v8
    v_lshl_add_u32 v8, v9, 4, v8
    s_mul_i32 s30, s29, 73728
    s_mul_i32 s81, s3, 18432
    s_add_u32 s81, s81, s30
    s_lshl_b32 s62, s28, 7
    s_add_u32 s81, s81, s62
    s_add_u32 s82, s30, s82
    s_and_b32 s62, s28, 1
    s_mul_i32 s62, s62, 36864
    s_add_u32 s62, s62, s30
    s_add_u32 s83, s83, s62
    s_waitcnt vmcnt(8)
    ds_read_b128 v[136:139], v12 offset:6144
    ds_read_b128 v[140:143], v12 offset:7168
    s_cmp_eq_u32 s80, 0
    s_cbranch_scc1 K3_nosh1
    ds_read_b128 v[176:179], v12 offset:10240
    ds_read_b128 v[180:183], v12 offset:11264
    ds_read_b128 v[184:187], v12 offset:12288
    ds_read_b128 v[188:191], v12 offset:13312
    ds_read_b128 v[192:195], v12 offset:14336
    ds_read_b128 v[196:199], v12 offset:15360
    ds_read_b128 v[200:203], v12 offset:16384
    ds_read_b128 v[204:207], v12 offset:17408
    v_lshlrev_b32 v120, 16, v116
    v_and_b32 v121, 0xffff0000, v116
    v_lshlrev_b32 v122, 16, v117
    v_and_b32 v123, 0xffff0000, v117
    v_lshlrev_b32 v124, 16, v116
    v_and_b32 v125, 0xffff0000, v116
    v_lshlrev_b32 v126, 16, v117
    v_and_b32 v127, 0xffff0000, v117
    v_dot2_f32_bf16 v120, v112, s75, v120
    v_dot2_f32_bf16 v121, v112, s76, v121
    v_dot2_f32_bf16 v122, v113, s75, v122
    v_dot2_f32_bf16 v123, v113, s76, v123
    v_dot2_f32_bf16 v124, v114, s75, v124
    v_dot2_f32_bf16 v125, v114, s76, v125
    v_dot2_f32_bf16 v126, v115, s75, v126
    v_dot2_f32_bf16 v127, v115, s76, v127
    s_waitcnt lgkmcnt(0)
    v_max3_i32 v14, v176, v177, v178
    v_max3_i32 v14, v14, v179, v180
    v_max3_i32 v14, v14, v181, v182
    v_max3_i32 v14, v14, v183, v184
    v_max3_i32 v14, v14, v185, v186
    v_max3_i32 v14, v14, v187, v188
    v_max3_i32 v14, v14, v189, v190
    v_max3_i32 v14, v14, v191, v192
    v_max3_i32 v14, v14, v193, v194
    v_max3_i32 v14, v14, v195, v196
    v_max3_i32 v14, v14, v197, v198
    v_max3_i32 v14, v14, v199, v200
    v_max3_i32 v14, v14, v201, v202
    v_max3_i32 v14, v14, v203, v204
    v_max3_i32 v14, v14, v205, v206
    v_max_i32 v14, v14, v207
    v_cmp_eq_i32 vcc, 2139062143, v14
    v_nop
    v_nop
    s_cmp_eq_u64 vcc, 0
    s_cselect_b32 s86, s75, 0
    s_cselect_b32 s87, s76, 0
    s_cselect_b32 s62, 256, 0
    s_andn2_b32 s74, s74, s62
    v_dot2_f32_bf16 v120, v176, s86, v120
    v_dot2_f32_bf16 v121, v176, s87, v121
    v_dot2_f32_bf16 v122, v177, s86, v122
    v_dot2_f32_bf16 v123, v177, s87, v123
    v_dot2_f32_bf16 v124, v178, s86, v124
    v_dot2_f32_bf16 v125, v178, s87, v125
    v_dot2_f32_bf16 v126, v179, s86, v126
    v_dot2_f32_bf16 v127, v179, s87, v127
    v_dot2_f32_bf16 v120, v180, s86, v120
    v_dot2_f32_bf16 v121, v180, s87, v121
    v_dot2_f32_bf16 v122, v181, s86, v122
    v_dot2_f32_bf16 v123, v181, s87, v123
    v_dot2_f32_bf16 v124, v182, s86, v124
    v_dot2_f32_bf16 v125, v182, s87, v125
    v_dot2_f32_bf16 v126, v183, s86, v126
    v_dot2_f32_bf16 v127, v183, s87, v127
    v_dot2_f32_bf16 v120, v184, s86, v120
    v_dot2_f32_bf16 v121, v184, s87, v121
    v_dot2_f32_bf16 v122, v185, s86, v122
    v_dot2_f32_bf16 v123, v185, s87, v123
    v_dot2_f32_bf16 v124, v186, s86, v124
    v_dot2_f32_bf16 v125, v186, s87, v125
    v_dot2_f32_bf16 v126, v187, s86, v126
    v_dot2_f32_bf16 v127, v187, s87, v127
    v_dot2_f32_bf16 v120, v188, s86, v120
    v_dot2_f32_bf16 v121, v188, s87, v121
    v_dot2_f32_bf16 v122, v189, s86, v122
    v_dot2_f32_bf16 v123, v189, s87, v123
    v_dot2_f32_bf16 v124, v190, s86, v124
    v_dot2_f32_bf16 v125, v190, s87, v125
    v_dot2_f32_bf16 v126, v191, s86, v126
    v_dot2_f32_bf16 v127, v191, s87, v127
    v_dot2_f32_bf16 v120, v192, s86, v120
    v_dot2_f32_bf16 v121, v192, s87, v121
    v_dot2_f32_bf16 v122, v193, s86, v122
    v_dot2_f32_bf16 v123, v193, s87, v123
    v_dot2_f32_bf16 v124, v194, s86, v124
    v_dot2_f32_bf16 v125, v194, s87, v125
    v_dot2_f32_bf16 v126, v195, s86, v126
    v_dot2_f32_bf16 v127, v195, s87, v127
    v_dot2_f32_bf16 v120, v196, s86, v120
    v_dot2_f32_bf16 v121, v196, s87, v121
    v_dot2_f32_bf16 v122, v197, s86, v122
    v_dot2_f32_bf16 v123, v197, s87, v123
    v_dot2_f32_bf16 v124, v198, s86, v124
    v_dot2_f32_bf16 v125, v198, s87, v125
    v_dot2_f32_bf16 v126, v199, s86, v126
    v_dot2_f32_bf16 v127, v199, s87, v127
    v_dot2_f32_bf16 v120, v200, s86, v120
    v_dot2_f32_bf16 v121, v200, s87, v121
    v_dot2_f32_bf16 v122, v201, s86, v122
    v_dot2_f32_bf16 v123, v201, s87, v123
    v_dot2_f32_bf16 v124, v202, s86, v124
    v_dot2_f32_bf16 v125, v202, s87, v125
    v_dot2_f32_bf16 v126, v203, s86, v126
    v_dot2_f32_bf16 v127, v203, s87, v127
    v_dot2_f32_bf16 v120, v204, s86, v120
    v_dot2_f32_bf16 v121, v204, s87, v121
    v_dot2_f32_bf16 v122, v205, s86, v122
    v_dot2_f32_bf16 v123, v205, s87, v123
    v_dot2_f32_bf16 v124, v206, s86, v124
    v_dot2_f32_bf16 v125, v206, s87, v125
    v_dot2_f32_bf16 v126, v207, s86, v126
    v_dot2_f32_bf16 v127, v207, s87, v127
K3_nosh1:
    s_waitcnt lgkmcnt(0)
    v_max3_i32 v14, v136, v137, v138
    v_max3_i32 v14, v14, v139, v140
    v_max3_i32 v14, v14, v141, v142
    v_max_i32 v14, v14, v143
    v_cmp_eq_i32 vcc, 2139062143, v14
    v_nop
    v_nop
    s_cmp_eq_u64 vcc, 0
    s_cselect_b32 s86, s75, 0
    s_cselect_b32 s87, s76, 0
    s_cselect_b32 s62, 16, 0
    s_andn2_b32 s74, s74, s62
    v_dot2_f32_bf16 v16, v136, s86, v16
    v_dot2_f32_bf16 v17, v136, s87, v17
    v_dot2_f32_bf16 v18, v137, s86, v18
    v_dot2_f32_bf16 v19, v137, s87, v19
    v_dot2_f32_bf16 v20, v138, s86, v20
    v_dot2_f32_bf16 v21, v138, s87, v21
    v_dot2_f32_bf16 v22, v139, s86, v22
    v_dot2_f32_bf16 v23, v139, s87, v23
    v_dot2_f32_bf16 v24, v140, s86, v24
    v_dot2_f32_bf16 v25, v140, s87, v25
    v_dot2_f32_bf16 v26, v141, s86, v26
    v_dot2_f32_bf16 v27, v141, s87, v27
    v_dot2_f32_bf16 v28, v142, s86, v28
    v_dot2_f32_bf16 v29, v142, s87, v29
    v_dot2_f32_bf16 v30, v143, s86, v30
    v_dot2_f32_bf16 v31, v143, s87, v31
    s_waitcnt vmcnt(4)
    ds_read_b128 v[144:147], v12 offset:8192
    ds_read_b128 v[148:151], v12 offset:9216
    s_waitcnt vmcnt(2)
    v_max3_i32 v14, v152, v153, v154
    v_max3_i32 v14, v14, v155, v156
    v_max3_i32 v14, v14, v157, v158
    v_max_i32 v14, v14, v159
    v_cmp_eq_i32 vcc, 2139062143, v14
    v_nop
    v_nop
    s_cmp_eq_u64 vcc, 0
    s_cselect_b32 s86, s75, 0
    s_cselect_b32 s87, s76, 0
    s_cselect_b32 s62, 64, 0
    s_andn2_b32 s74, s74, s62
    v_dot2_f32_bf16 v16, v152, s86, v16
    v_dot2_f32_bf16 v17, v152, s87, v17
    v_dot2_f32_bf16 v18, v153, s86, v18
    v_dot2_f32_bf16 v19, v153, s87, v19
    v_dot2_f32_bf16 v20, v154, s86, v20
    v_dot2_f32_bf16 v21, v154, s87, v21
    v_dot2_f32_bf16 v22, v155, s86, v22
    v_dot2_f32_bf16 v23, v155, s87, v23
    v_dot2_f32_bf16 v24, v156, s86, v24
    v_dot2_f32_bf16 v25, v156, s87, v25
    v_dot2_f32_bf16 v26, v157, s86, v26
    v_dot2_f32_bf16 v27, v157, s87, v27
    v_dot2_f32_bf16 v28, v158, s86, v28
    v_dot2_f32_bf16 v29, v158, s87, v29
    v_dot2_f32_bf16 v30, v159, s86, v30
    v_dot2_f32_bf16 v31, v159, s87, v31
    s_waitcnt lgkmcnt(0)
    v_max3_i32 v14, v144, v145, v146
    v_max3_i32 v14, v14, v147, v148
    v_max3_i32 v14, v14, v149, v150
    v_max_i32 v14, v14, v151
    v_cmp_eq_i32 vcc, 2139062143, v14
    v_nop
    v_nop
    s_cmp_eq_u64 vcc, 0
    s_cselect_b32 s86, s75, 0
    s_cselect_b32 s87, s76, 0
    s_cselect_b32 s62, 32, 0
    s_andn2_b32 s74, s74, s62
    v_dot2_f32_bf16 v16, v144, s86, v16
    v_dot2_f32_bf16 v17, v144, s87, v17
    v_dot2_f32_bf16 v18, v145, s86, v18
    v_dot2_f32_bf16 v19, v145, s87, v19
    v_dot2_f32_bf16 v20, v146, s86, v20
    v_dot2_f32_bf16 v21, v146, s87, v21
    v_dot2_f32_bf16 v22, v147, s86, v22
    v_dot2_f32_bf16 v23, v147, s87, v23
    v_dot2_f32_bf16 v24, v148, s86, v24
    v_dot2_f32_bf16 v25, v148, s87, v25
    v_dot2_f32_bf16 v26, v149, s86, v26
    v_dot2_f32_bf16 v27, v149, s87, v27
    v_dot2_f32_bf16 v28, v150, s86, v28
    v_dot2_f32_bf16 v29, v150, s87, v29
    v_dot2_f32_bf16 v30, v151, s86, v30
    v_dot2_f32_bf16 v31, v151, s87, v31
    s_waitcnt vmcnt(0)
    v_max3_i32 v14, v160, v161, v162
    v_max3_i32 v14, v14, v163, v164
    v_max3_i32 v14, v14, v165, v166
    v_max_i32 v14, v14, v167
    v_cmp_eq_i32 vcc, 2139062143, v14
    v_nop
    v_nop
    s_cmp_eq_u64 vcc, 0
    s_cselect_b32 s86, s75, 0
    s_cselect_b32 s87, s76, 0
    s_cselect_b32 s62, 128, 0
    s_andn2_b32 s74, s74, s62
    v_dot2_f32_bf16 v16, v160, s86, v16
    v_dot2_f32_bf16 v17, v160, s87, v17
    v_dot2_f32_bf16 v18, v161, s86, v18
    v_dot2_f32_bf16 v19, v161, s87, v19
    v_dot2_f32_bf16 v20, v162, s86, v20
    v_dot2_f32_bf16 v21, v162, s87, v21
    v_dot2_f32_bf16 v22, v163, s86, v22
    v_dot2_f32_bf16 v23, v163, s87, v23
    v_dot2_f32_bf16 v24, v164, s86, v24
    v_dot2_f32_bf16 v25, v164, s87, v25
    v_dot2_f32_bf16 v26, v165, s86, v26
    v_dot2_f32_bf16 v27, v165, s87, v27
    v_dot2_f32_bf16 v28, v166, s86, v28
    v_dot2_f32_bf16 v29, v166, s87, v29
    v_dot2_f32_bf16 v30, v167, s86, v30
    v_dot2_f32_bf16 v31, v167, s87, v31
    s_mov_b32 s88, 0x100000
K3_poll:
    s_cmp_eq_u32 s74, 0
    s_cbranch_scc1 K3_done
    s_sub_u32 s88, s88, 1
    s_cmp_eq_u32 s88, 0
    s_cbranch_scc1 K3_done
    s_mov_b32 s31, s74
    s_bitcmp0_b32 s31, 1
    s_cbranch_scc1 K3_pf1
    s_lshl_b32 s63, s71, 11
    s_add_u32 s63, s63, s84
    buffer_load_dwordx4 v[168:171], v5, s[8:11], s63 offen offset:0 sc1
    buffer_load_dwordx4 v[172:175], v5, s[8:11], s63 offen offset:1024 sc1
K3_pf1:
    s_bitcmp0_b32 s31, 2
    s_cbranch_scc1 K3_pf2
    s_lshl_b32 s63, s70, 11
    s_add_u32 s63, s63, s84
    buffer_load_dwordx4 v[32:35], v5, s[8:11], s63 offen offset:0 sc1
    buffer_load_dwordx4 v[36:39], v5, s[8:11], s63 offen offset:1024 sc1
K3_pf2:
    s_bitcmp0_b32 s31, 3
    s_cbranch_scc1 K3_pf3
    s_lshl_b32 s63, s69, 11
    s_add_u32 s63, s63, s84
    buffer_load_dwordx4 v[104:107], v5, s[8:11], s63 offen offset:0 sc1
    buffer_load_dwordx4 v[108:111], v5, s[8:11], s63 offen offset:1024 sc1
K3_pf3:
    s_bitcmp0_b32 s31, 4
    s_cbranch_scc1 K3_pf4
    s_lshl_b32 s63, s68, 11
    s_add_u32 s63, s63, s84
    buffer_load_dwordx4 v[136:139], v5, s[8:11], s63 offen offset:0 sc1
    buffer_load_dwordx4 v[140:143], v5, s[8:11], s63 offen offset:1024 sc1
K3_pf4:
    s_bitcmp0_b32 s31, 5
    s_cbranch_scc1 K3_pf5
    s_lshl_b32 s63, s67, 11
    s_add_u32 s63, s63, s84
    buffer_load_dwordx4 v[144:147], v5, s[8:11], s63 offen offset:0 sc1
    buffer_load_dwordx4 v[148:151], v5, s[8:11], s63 offen offset:1024 sc1
K3_pf5:
    s_bitcmp0_b32 s31, 6
    s_cbranch_scc1 K3_pf6
    s_lshl_b32 s63, s66, 11
    s_add_u32 s63, s63, s84
    buffer_load_dwordx4 v[152:155], v5, s[8:11], s63 offen offset:0 sc1
    buffer_load_dwordx4 v[156:159], v5, s[8:11], s63 offen offset:1024 sc1
K3_pf6:
    s_bitcmp0_b32 s31, 7
    s_cbranch_scc1 K3_pf7
    s_lshl_b32 s63, s65, 11
    s_add_u32 s63, s63, s84
    buffer_load_dwordx4 v[160:163], v5, s[8:11], s63 offen offset:0 sc1
    buffer_load_dwordx4 v[164:167], v5, s[8:11], s63 offen offset:1024 sc1
K3_pf7:
    s_bitcmp0_b32 s31, 8
    s_cbranch_scc1 K3_pf8
    s_add_u32 s63, s85, 0
    buffer_load_dwordx4 v[176:179], v5, s[8:11], s63 offen sc1
    s_add_u32 s63, s85, 2048
    buffer_load_dwordx4 v[180:183], v5, s[8:11], s63 offen sc1
    s_add_u32 s63, s85, 4096
    buffer_load_dwordx4 v[184:187], v5, s[8:11], s63 offen sc1
    s_add_u32 s63, s85, 6144
    buffer_load_dwordx4 v[188:191], v5, s[8:11], s63 offen sc1
    s_add_u32 s63, s85, 8192
    buffer_load_dwordx4 v[192:195], v5, s[8:11], s63 offen sc1
    s_add_u32 s63, s85, 10240
    buffer_load_dwordx4 v[196:199], v5, s[8:11], s63 offen sc1
    s_add_u32 s63, s85, 12288
    buffer_load_dwordx4 v[200:203], v5, s[8:11], s63 offen sc1
    s_add_u32 s63, s85, 14336
    buffer_load_dwordx4 v[204:207], v5, s[8:11], s63 offen sc1
K3_pf8:
    s_waitcnt vmcnt(0)
    s_bitcmp0_b32 s31, 1
    s_cbranch_scc1 K3_pt1
    v_max3_i32 v14, v168, v169, v170
    v_max3_i32 v14, v14, v171, v172
    v_max3_i32 v14, v14, v173, v174
    v_max_i32 v14, v14, v175
    v_cmp_eq_i32 vcc, 2139062143, v14
    v_nop
    v_nop
    s_cmp_eq_u64 vcc, 0
    s_cselect_b32 s86, s75, 0
    s_cselect_b32 s87, s76, 0
    s_cselect_b32 s62, 2, 0
    s_andn2_b32 s74, s74, s62
    v_dot2_f32_bf16 v16, v168, s86, v16
    v_dot2_f32_bf16 v17, v168, s87, v17
    v_dot2_f32_bf16 v18, v169, s86, v18
    v_dot2_f32_bf16 v19, v169, s87, v19
    v_dot2_f32_bf16 v20, v170, s86, v20
    v_dot2_f32_bf16 v21, v170, s87, v21
    v_dot2_f32_bf16 v22, v171, s86, v22
    v_dot2_f32_bf16 v23, v171, s87, v23
    v_dot2_f32_bf16 v24, v172, s86, v24
    v_dot2_f32_bf16 v25, v172, s87, v25
    v_dot2_f32_bf16 v26, v173, s86, v26
    v_dot2_f32_bf16 v27, v173, s87, v27
    v_dot2_f32_bf16 v28, v174, s86, v28
    v_dot2_f32_bf16 v29, v174, s87, v29
    v_dot2_f32_bf16 v30, v175, s86, v30
    v_dot2_f32_bf16 v31, v175, s87, v31
K3_pt1:
    s_bitcmp0_b32 s31, 2
    s_cbranch_scc1 K3_pt2
    v_max3_i32 v14, v32, v33, v34
    v_max3_i32 v14, v14, v35, v36
    v_max3_i32 v14, v14, v37, v38
    v_max_i32 v14, v14, v39
    v_cmp_eq_i32 vcc, 2139062143, v14
    v_nop
    v_nop
    s_cmp_eq_u64 vcc, 0
    s_cselect_b32 s86, s75, 0
    s_cselect_b32 s87, s76, 0
    s_cselect_b32 s62, 4, 0
    s_andn2_b32 s74, s74, s62
    v_dot2_f32_bf16 v16, v32, s86, v16
    v_dot2_f32_bf16 v17, v32, s87, v17
    v_dot2_f32_bf16 v18, v33, s86, v18
    v_dot2_f32_bf16 v19, v33, s87, v19
    v_dot2_f32_bf16 v20, v34, s86, v20
    v_dot2_f32_bf16 v21, v34, s87, v21
    v_dot2_f32_bf16 v22, v35, s86, v22
    v_dot2_f32_bf16 v23, v35, s87, v23
    v_dot2_f32_bf16 v24, v36, s86, v24
    v_dot2_f32_bf16 v25, v36, s87, v25
    v_dot2_f32_bf16 v26, v37, s86, v26
    v_dot2_f32_bf16 v27, v37, s87, v27
    v_dot2_f32_bf16 v28, v38, s86, v28
    v_dot2_f32_bf16 v29, v38, s87, v29
    v_dot2_f32_bf16 v30, v39, s86, v30
    v_dot2_f32_bf16 v31, v39, s87, v31
K3_pt2:
    s_bitcmp0_b32 s31, 3
    s_cbranch_scc1 K3_pt3
    v_max3_i32 v14, v104, v105, v106
    v_max3_i32 v14, v14, v107, v108
    v_max3_i32 v14, v14, v109, v110
    v_max_i32 v14, v14, v111
    v_cmp_eq_i32 vcc, 2139062143, v14
    v_nop
    v_nop
    s_cmp_eq_u64 vcc, 0
    s_cselect_b32 s86, s75, 0
    s_cselect_b32 s87, s76, 0
    s_cselect_b32 s62, 8, 0
    s_andn2_b32 s74, s74, s62
    v_dot2_f32_bf16 v16, v104, s86, v16
    v_dot2_f32_bf16 v17, v104, s87, v17
    v_dot2_f32_bf16 v18, v105, s86, v18
    v_dot2_f32_bf16 v19, v105, s87, v19
    v_dot2_f32_bf16 v20, v106, s86, v20
    v_dot2_f32_bf16 v21, v106, s87, v21
    v_dot2_f32_bf16 v22, v107, s86, v22
    v_dot2_f32_bf16 v23, v107, s87, v23
    v_dot2_f32_bf16 v24, v108, s86, v24
    v_dot2_f32_bf16 v25, v108, s87, v25
    v_dot2_f32_bf16 v26, v109, s86, v26
    v_dot2_f32_bf16 v27, v109, s87, v27
    v_dot2_f32_bf16 v28, v110, s86, v28
    v_dot2_f32_bf16 v29, v110, s87, v29
    v_dot2_f32_bf16 v30, v111, s86, v30
    v_dot2_f32_bf16 v31, v111, s87, v31
K3_pt3:
    s_bitcmp0_b32 s31, 4
    s_cbranch_scc1 K3_pt4
    v_max3_i32 v14, v136, v137, v138
    v_max3_i32 v14, v14, v139, v140
    v_max3_i32 v14, v14, v141, v142
    v_max_i32 v14, v14, v143
    v_cmp_eq_i32 vcc, 2139062143, v14
    v_nop
    v_nop
    s_cmp_eq_u64 vcc, 0
    s_cselect_b32 s86, s75, 0
    s_cselect_b32 s87, s76, 0
    s_cselect_b32 s62, 16, 0
    s_andn2_b32 s74, s74, s62
    v_dot2_f32_bf16 v16, v136, s86, v16
    v_dot2_f32_bf16 v17, v136, s87, v17
    v_dot2_f32_bf16 v18, v137, s86, v18
    v_dot2_f32_bf16 v19, v137, s87, v19
    v_dot2_f32_bf16 v20, v138, s86, v20
    v_dot2_f32_bf16 v21, v138, s87, v21
    v_dot2_f32_bf16 v22, v139, s86, v22
    v_dot2_f32_bf16 v23, v139, s87, v23
    v_dot2_f32_bf16 v24, v140, s86, v24
    v_dot2_f32_bf16 v25, v140, s87, v25
    v_dot2_f32_bf16 v26, v141, s86, v26
    v_dot2_f32_bf16 v27, v141, s87, v27
    v_dot2_f32_bf16 v28, v142, s86, v28
    v_dot2_f32_bf16 v29, v142, s87, v29
    v_dot2_f32_bf16 v30, v143, s86, v30
    v_dot2_f32_bf16 v31, v143, s87, v31
K3_pt4:
    s_bitcmp0_b32 s31, 5
    s_cbranch_scc1 K3_pt5
    v_max3_i32 v14, v144, v145, v146
    v_max3_i32 v14, v14, v147, v148
    v_max3_i32 v14, v14, v149, v150
    v_max_i32 v14, v14, v151
    v_cmp_eq_i32 vcc, 2139062143, v14
    v_nop
    v_nop
    s_cmp_eq_u64 vcc, 0
    s_cselect_b32 s86, s75, 0
    s_cselect_b32 s87, s76, 0
    s_cselect_b32 s62, 32, 0
    s_andn2_b32 s74, s74, s62
    v_dot2_f32_bf16 v16, v144, s86, v16
    v_dot2_f32_bf16 v17, v144, s87, v17
    v_dot2_f32_bf16 v18, v145, s86, v18
    v_dot2_f32_bf16 v19, v145, s87, v19
    v_dot2_f32_bf16 v20, v146, s86, v20
    v_dot2_f32_bf16 v21, v146, s87, v21
    v_dot2_f32_bf16 v22, v147, s86, v22
    v_dot2_f32_bf16 v23, v147, s87, v23
    v_dot2_f32_bf16 v24, v148, s86, v24
    v_dot2_f32_bf16 v25, v148, s87, v25
    v_dot2_f32_bf16 v26, v149, s86, v26
    v_dot2_f32_bf16 v27, v149, s87, v27
    v_dot2_f32_bf16 v28, v150, s86, v28
    v_dot2_f32_bf16 v29, v150, s87, v29
    v_dot2_f32_bf16 v30, v151, s86, v30
    v_dot2_f32_bf16 v31, v151, s87, v31
K3_pt5:
    s_bitcmp0_b32 s31, 6
    s_cbranch_scc1 K3_pt6
    v_max3_i32 v14, v152, v153, v154
    v_max3_i32 v14, v14, v155, v156
    v_max3_i32 v14, v14, v157, v158
    v_max_i32 v14, v14, v159
    v_cmp_eq_i32 vcc, 2139062143, v14
    v_nop
    v_nop
    s_cmp_eq_u64 vcc, 0
    s_cselect_b32 s86, s75, 0
    s_cselect_b32 s87, s76, 0
    s_cselect_b32 s62, 64, 0
    s_andn2_b32 s74, s74, s62
    v_dot2_f32_bf16 v16, v152, s86, v16
    v_dot2_f32_bf16 v17, v152, s87, v17
    v_dot2_f32_bf16 v18, v153, s86, v18
    v_dot2_f32_bf16 v19, v153, s87, v19
    v_dot2_f32_bf16 v20, v154, s86, v20
    v_dot2_f32_bf16 v21, v154, s87, v21
    v_dot2_f32_bf16 v22, v155, s86, v22
    v_dot2_f32_bf16 v23, v155, s87, v23
    v_dot2_f32_bf16 v24, v156, s86, v24
    v_dot2_f32_bf16 v25, v156, s87, v25
    v_dot2_f32_bf16 v26, v157, s86, v26
    v_dot2_f32_bf16 v27, v157, s87, v27
    v_dot2_f32_bf16 v28, v158, s86, v28
    v_dot2_f32_bf16 v29, v158, s87, v29
    v_dot2_f32_bf16 v30, v159, s86, v30
    v_dot2_f32_bf16 v31, v159, s87, v31
K3_pt6:
    s_bitcmp0_b32 s31, 7
    s_cbranch_scc1 K3_pt7
    v_max3_i32 v14, v160, v161, v162
    v_max3_i32 v14, v14, v163, v164
    v_max3_i32 v14, v14, v165, v166
    v_max_i32 v14, v14, v167
    v_cmp_eq_i32 vcc, 2139062143, v14
    v_nop
    v_nop
    s_cmp_eq_u64 vcc, 0
    s_cselect_b32 s86, s75, 0
    s_cselect_b32 s87, s76, 0
    s_cselect_b32 s62, 128, 0
    s_andn2_b32 s74, s74, s62
    v_dot2_f32_bf16 v16, v160, s86, v16
    v_dot2_f32_bf16 v17, v160, s87, v17
    v_dot2_f32_bf16 v18, v161, s86, v18
    v_dot2_f32_bf16 v19, v161, s87, v19
    v_dot2_f32_bf16 v20, v162, s86, v20
    v_dot2_f32_bf16 v21, v162, s87, v21
    v_dot2_f32_bf16 v22, v163, s86, v22
    v_dot2_f32_bf16 v23, v163, s87, v23
    v_dot2_f32_bf16 v24, v164, s86, v24
    v_dot2_f32_bf16 v25, v164, s87, v25
    v_dot2_f32_bf16 v26, v165, s86, v26
    v_dot2_f32_bf16 v27, v165, s87, v27
    v_dot2_f32_bf16 v28, v166, s86, v28
    v_dot2_f32_bf16 v29, v166, s87, v29
    v_dot2_f32_bf16 v30, v167, s86, v30
    v_dot2_f32_bf16 v31, v167, s87, v31
K3_pt7:
    s_bitcmp0_b32 s31, 8
    s_cbranch_scc1 K3_pt8
    v_max3_i32 v14, v176, v177, v178
    v_max3_i32 v14, v14, v179, v180
    v_max3_i32 v14, v14, v181, v182
    v_max3_i32 v14, v14, v183, v184
    v_max3_i32 v14, v14, v185, v186
    v_max3_i32 v14, v14, v187, v188
    v_max3_i32 v14, v14, v189, v190
    v_max3_i32 v14, v14, v191, v192
    v_max3_i32 v14, v14, v193, v194
    v_max3_i32 v14, v14, v195, v196
    v_max3_i32 v14, v14, v197, v198
    v_max3_i32 v14, v14, v199, v200
    v_max3_i32 v14, v14, v201, v202
    v_max3_i32 v14, v14, v203, v204
    v_max3_i32 v14, v14, v205, v206
    v_max_i32 v14, v14, v207
    v_cmp_eq_i32 vcc, 2139062143, v14
    v_nop
    v_nop
    s_cmp_eq_u64 vcc, 0
    s_cselect_b32 s86, s75, 0
    s_cselect_b32 s87, s76, 0
    s_cselect_b32 s62, 256, 0
    s_andn2_b32 s74, s74, s62
    v_dot2_f32_bf16 v120, v176, s86, v120
    v_dot2_f32_bf16 v121, v176, s87, v121
    v_dot2_f32_bf16 v122, v177, s86, v122
    v_dot2_f32_bf16 v123, v177, s87, v123
    v_dot2_f32_bf16 v124, v178, s86, v124
    v_dot2_f32_bf16 v125, v178, s87, v125
    v_dot2_f32_bf16 v126, v179, s86, v126
    v_dot2_f32_bf16 v127, v179, s87, v127
    v_dot2_f32_bf16 v120, v180, s86, v120
    v_dot2_f32_bf16 v121, v180, s87, v121
    v_dot2_f32_bf16 v122, v181, s86, v122
    v_dot2_f32_bf16 v123, v181, s87, v123
    v_dot2_f32_bf16 v124, v182, s86, v124
    v_dot2_f32_bf16 v125, v182, s87, v125
    v_dot2_f32_bf16 v126, v183, s86, v126
    v_dot2_f32_bf16 v127, v183, s87, v127
    v_dot2_f32_bf16 v120, v184, s86, v120
    v_dot2_f32_bf16 v121, v184, s87, v121
    v_dot2_f32_bf16 v122, v185, s86, v122
    v_dot2_f32_bf16 v123, v185, s87, v123
    v_dot2_f32_bf16 v124, v186, s86, v124
    v_dot2_f32_bf16 v125, v186, s87, v125
    v_dot2_f32_bf16 v126, v187, s86, v126
    v_dot2_f32_bf16 v127, v187, s87, v127
    v_dot2_f32_bf16 v120, v188, s86, v120
    v_dot2_f32_bf16 v121, v188, s87, v121
    v_dot2_f32_bf16 v122, v189, s86, v122
    v_dot2_f32_bf16 v123, v189, s87, v123
    v_dot2_f32_bf16 v124, v190, s86, v124
    v_dot2_f32_bf16 v125, v190, s87, v125
    v_dot2_f32_bf16 v126, v191, s86, v126
    v_dot2_f32_bf16 v127, v191, s87, v127
    v_dot2_f32_bf16 v120, v192, s86, v120
    v_dot2_f32_bf16 v121, v192, s87, v121
    v_dot2_f32_bf16 v122, v193, s86, v122
    v_dot2_f32_bf16 v123, v193, s87, v123
    v_dot2_f32_bf16 v124, v194, s86, v124
    v_dot2_f32_bf16 v125, v194, s87, v125
    v_dot2_f32_bf16 v126, v195, s86, v126
    v_dot2_f32_bf16 v127, v195, s87, v127
    v_dot2_f32_bf16 v120, v196, s86, v120
    v_dot2_f32_bf16 v121, v196, s87, v121
    v_dot2_f32_bf16 v122, v197, s86, v122
    v_dot2_f32_bf16 v123, v197, s87, v123
    v_dot2_f32_bf16 v124, v198, s86, v124
    v_dot2_f32_bf16 v125, v198, s87, v125
    v_dot2_f32_bf16 v126, v199, s86, v126
    v_dot2_f32_bf16 v127, v199, s87, v127
    v_dot2_f32_bf16 v120, v200, s86, v120
    v_dot2_f32_bf16 v121, v200, s87, v121
    v_dot2_f32_bf16 v122, v201, s86, v122
    v_dot2_f32_bf16 v123, v201, s87, v123
    v_dot2_f32_bf16 v124, v202, s86, v124
    v_dot2_f32_bf16 v125, v202, s87, v125
    v_dot2_f32_bf16 v126, v203, s86, v126
    v_dot2_f32_bf16 v127, v203, s87, v127
    v_dot2_f32_bf16 v120, v204, s86, v120
    v_dot2_f32_bf16 v121, v204, s87, v121
    v_dot2_f32_bf16 v122, v205, s86, v122
    v_dot2_f32_bf16 v123, v205, s87, v123
    v_dot2_f32_bf16 v124, v206, s86, v124
    v_dot2_f32_bf16 v125, v206, s87, v125
    v_dot2_f32_bf16 v126, v207, s86, v126
    v_dot2_f32_bf16 v127, v207, s87, v127
K3_pt8:
    s_branch K3_poll
K3_done:
    s_nop 1
    v_pk_add_f32 v[56:57], v[56:57], v[16:17]
    v_pk_add_f32 v[58:59], v[58:59], v[18:19]
    v_cvt_pk_bf16_f32 v248, v56, v57
    v_cvt_pk_bf16_f32 v249, v58, v59
    ds_write_b64 v11, v[248:249] offset:0
    v_pk_add_f32 v[60:61], v[60:61], v[20:21]
    v_pk_add_f32 v[62:63], v[62:63], v[22:23]
    v_cvt_pk_bf16_f32 v250, v60, v61
    v_cvt_pk_bf16_f32 v251, v62, v63
    ds_write_b64 v11, v[250:251] offset:512
    ds_read_b128 v[32:35], v12 offset:0
    v_pk_add_f32 v[64:65], v[64:65], v[24:25]
    v_pk_add_f32 v[66:67], v[66:67], v[26:27]
    v_cvt_pk_bf16_f32 v252, v64, v65
    v_cvt_pk_bf16_f32 v253, v66, v67
    ds_write_b64 v11, v[252:253] offset:1024
    v_pk_add_f32 v[68:69], v[68:69], v[28:29]
    v_pk_add_f32 v[70:71], v[70:71], v[30:31]
    v_cvt_pk_bf16_f32 v254, v68, v69
    v_cvt_pk_bf16_f32 v255, v70, v71
    ds_write_b64 v11, v[254:255] offset:1536
    ds_read_b128 v[36:39], v12 offset:1024
    s_cmp_eq_u32 s80, 0
    s_cbranch_scc1 K3_nosh3
    v_cvt_pk_bf16_f32 v120, v120, v121
    v_cvt_pk_bf16_f32 v121, v122, v123
    ds_write_b64 v11, v[120:121] offset:2048
    v_cvt_pk_bf16_f32 v124, v124, v125
    v_cvt_pk_bf16_f32 v125, v126, v127
    ds_write_b64 v11, v[124:125] offset:2560
    ds_read_b128 v[112:115], v12 offset:2048
    s_waitcnt lgkmcnt(0)
    buffer_store_dwordx4 v[112:115], v10, s[20:23], s83 offen
K3_nosh3:
    s_add_u32 s83, s82, 36864
    s_waitcnt lgkmcnt(0)
    buffer_store_dwordx4 v[32:35], v10, s[20:23], s82 offen
    buffer_store_dwordx4 v[36:39], v10, s[20:23], s83 offen
    s_endpgm
K3_end:
    s_endpgm
.section .rodata,"a"
.p2align 6
.amdhsa_kernel k1_kernel
  .amdhsa_next_free_vgpr 248
  .amdhsa_next_free_sgpr 102
  .amdhsa_accum_offset 248
  .amdhsa_group_segment_fixed_size 0
  .amdhsa_kernarg_size 104
  .amdhsa_user_sgpr_count 2
  .amdhsa_user_sgpr_kernarg_segment_ptr 1
  .amdhsa_system_sgpr_workgroup_id_x 1
.end_amdhsa_kernel
.p2align 6
.amdhsa_kernel k2_kernel
  .amdhsa_next_free_vgpr 256
  .amdhsa_next_free_sgpr 102
  .amdhsa_accum_offset 256
  .amdhsa_group_segment_fixed_size 0
  .amdhsa_kernarg_size 104
  .amdhsa_user_sgpr_count 2
  .amdhsa_user_sgpr_kernarg_segment_ptr 1
  .amdhsa_system_sgpr_workgroup_id_x 1
.end_amdhsa_kernel
.p2align 6
.amdhsa_kernel k3_kernel
  .amdhsa_next_free_vgpr 512
  .amdhsa_next_free_sgpr 102
  .amdhsa_accum_offset 256
  .amdhsa_group_segment_fixed_size 0
  .amdhsa_kernarg_size 104
  .amdhsa_user_sgpr_count 2
  .amdhsa_user_sgpr_kernarg_segment_ptr 1
  .amdhsa_system_sgpr_workgroup_id_x 1
.end_amdhsa_kernel
```
